```python
import torch

def _softmax(x, axis=-1):
    return torch.softmax(x, dim=axis)
def _gelu(x):
    return torch.nn.functional.gelu(x, approximate="tanh")
def _silu(x):
    return torch.nn.functional.silu(x)
def _sigmoid(x):
    return torch.sigmoid(x)
def _layernorm(x, axis=-1, eps=1e-5):
    m = x.mean(dim=axis, keepdim=True)
    v = x.var(dim=axis, keepdim=True, unbiased=False)
    return (x - m) / torch.sqrt(v + eps)
def _scatter_add(tgt, idx, src, axis=0):
    return tgt.clone().index_add_(axis, idx, src)
def _segment_sum(src, seg, n):
    out = torch.zeros((n,) + src.shape[1:], dtype=src.dtype)
    return out.index_add_(0, seg, src)
def _pad(x, pw):
    flat = tuple(v for pair in reversed(pw) for v in pair)
    return torch.nn.functional.pad(x, flat)

kernel_name = 'parallel_sum__grouped_kv_mqa__dense_activation_squared_relu__prompt'

def setup_inputs():

    _w = (lambda a: (lambda t: t.to(torch.bfloat16) if t.is_floating_point() else t)(torch.as_tensor(a)))
    def _A_setup():
        B, S, D, H = 1, 2048, 640, 32
        Dh = D // H
        return {
            "x": _w((lambda *s: torch.randn(*s, dtype=torch.bfloat16) * 0.05)(B, S, D)),
            "wq": _w((lambda *s: torch.randn(*s, dtype=torch.bfloat16) * 0.2)(D, H * Dh)),
            "wk": _w((lambda *s: torch.randn(*s, dtype=torch.bfloat16) * 0.2)(D, Dh)),
            "wv": _w((lambda *s: torch.randn(*s, dtype=torch.bfloat16) * 0.1)(D, Dh)),
            "wo": _w((lambda *s: torch.randn(*s, dtype=torch.bfloat16) * 0.1)(H * Dh, D)),
        }
    _A_in = _A_setup()

    def _B_setup():
        B, S, D, F = 1, 2048, 640, 1536
        return {
            "x": _w((lambda *s: torch.randn(*s, dtype=torch.bfloat16) * 0.05)(B, S, D)),
            "w1": _w((lambda *s: torch.randn(*s, dtype=torch.bfloat16) * 0.1)(D, F)),
            "b1": _w((lambda *s: torch.randn(*s, dtype=torch.bfloat16) * 0.4)(F)),
            "w2": _w((lambda *s: torch.randn(*s, dtype=torch.bfloat16) * 0.1)(F, D)),
            "b2": _w((lambda *s: torch.randn(*s, dtype=torch.bfloat16) * 12.8)(D)),
        }
    _B_in = _B_setup()

    return {
        "A_x": _A_in["x"],
        "A_wq": _A_in["wq"],
        "A_wk": _A_in["wk"],
        "A_wv": _A_in["wv"],
        "A_wo": _A_in["wo"],
        "B_x": _B_in["x"],
        "B_w1": _B_in["w1"],
        "B_b1": _B_in["b1"],
        "B_w2": _B_in["w2"],
        "B_b2": _B_in["b2"],
    }

def reference(A_x, A_wq, A_wk, A_wv, A_wo, B_x, B_w1, B_b1, B_w2, B_b2):
    def _A_ref(x, wq, wk, wv, wo):
        B, S, D = x.shape
        H = 32
        Dh = D // H
        q = (lambda x, *d: x.permute(*d))((x @ wq).reshape(B, S, H, Dh), 0, 2, 1, 3)
        k = x @ wk
        v = x @ wv
        scores = torch.einsum("bhqd,bkd->bhqk", q, k) * (Dh ** -0.5)
        p = _softmax(scores, axis=-1)
        o = torch.einsum("bhqk,bkd->bhqd", p, v)
        return (lambda x, *d: x.permute(*d))(o, 0, 2, 1, 3).reshape(B, S, H * Dh) @ wo

    def _B_ref(x, w1, b1, w2, b2):
        h = torch.einsum("bsd,df->bsf", x, w1) + b1
        zero = torch.zeros_like(h)
        r = torch.where(h > zero, h, zero)
        h = r * r
        out = torch.einsum("bsf,fd->bsd", h, w2) + b2
        return out

    x = A_x
    xn = _layernorm(x, axis=-1)
    return x + _A_ref(xn, A_wq, A_wk, A_wv, A_wo) + _B_ref(xn, B_w1, B_b1, B_w2, B_b2)
```

```asm
; @launch grid=(256,1,1) block=(512,1,1) lds=163840
.amdgcn_target "amdgcn-amd-amdhsa--gfx950"
.text
.globl parallel_sum__grouped_kv_mqa__dense_activation_squared_relu__prompt_kernel
.p2align 8
.type parallel_sum__grouped_kv_mqa__dense_activation_squared_relu__prompt_kernel,@function
parallel_sum__grouped_kv_mqa__dense_activation_squared_relu__prompt_kernel:
    s_cmp_ge_u32 s2, 256
    s_cbranch_scc1 L_parallel_sum__grouped_kv_mqa__dense_activation_squared_relu__prompt_kernel_end
    s_load_dwordx4 s[44:47], s[0:1], 0
    s_load_dwordx4 s[48:51], s[0:1], 16
    s_load_dwordx2 s[52:53], s[0:1], 32
    s_load_dwordx4 s[56:59], s[0:1], 48
    s_load_dwordx4 s[60:63], s[0:1], 64
    s_load_dwordx4 s[64:67], s[0:1], 80
    s_load_dwordx2 s[68:69], s[0:1], 96
    s_and_b32 s39, s2, 7
    s_lshr_b32 s40, s2, 3
    s_lshr_b32 s41, s39, 2
    s_lshl_b32 s41, s41, 1
    s_and_b32 s42, s39, 1
    s_add_u32 s41, s41, s42
    s_lshl_b32 s36, s41, 3
    s_and_b32 s41, s40, 7
    s_add_u32 s36, s36, s41
    s_bfe_u32 s41, s39, 0x10001
    s_lshl_b32 s37, s41, 2
    s_lshr_b32 s79, s40, 3
    s_add_u32 s37, s37, s79
    s_xor_b32 s77, s41, 1
    v_lshrrev_b32 v2, 6, v0
    v_and_b32 v1, 63, v0
    v_readfirstlane_b32 s38, v2
    v_lshrrev_b32 v3, 4, v1
    v_and_b32 v4, 15, v1
    s_lshl_b32 s39, s38, 3
    v_add_u32 v5, s39, v3
    v_mul_u32_u24 v249, 1280, v5
    v_lshl_add_u32 v249, v4, 4, v249
    s_nop 2
    s_cmp_ge_u32 s38, 4
    s_cbranch_scc1 L_parallel_sum__grouped_kv_mqa__dense_activation_squared_relu__prompt_kernel_roleL
    v_lshrrev_b32 v17, 5, v1
    v_cmp_eq_u32 s[74:75], 0, v17
    v_and_b32 v16, 31, v1
    v_lshrrev_b32 v247, 4, v16
    v_mul_u32_u24 v247, 49152, v247
    v_and_b32 v15, 15, v16
    v_lshl_add_u32 v14, v17, 4, v15
    v_lshl_add_u32 v247, v14, 4, v247
    s_lshl_b32 s39, s36, 2
    s_and_b32 s41, s38, 1
    s_lshl_b32 s40, s41, 1
    s_add_u32 s39, s39, s40
    s_mul_i32 s39, s39, 48
    s_mul_i32 s40, s37, 6
    s_add_u32 s39, s39, s40
    s_lshr_b32 s40, s38, 1
    s_mul_i32 s40, s40, 3
    s_add_u32 s39, s39, s40
    s_lshl_b32 s39, s39, 10
    s_add_u32 s72, s39, 163840
    v_lshrrev_b32 v14, 4, v16
    v_mul_u32_u24 v14, 20480, v14
    v_lshl_add_u32 v14, v15, 4, v14
    s_lshl_b32 s43, s37, 2
    s_add_u32 s43, s43, s38
    s_mul_i32 s43, s43, 20
    v_lshlrev_b32 v13, 2, v17
    v_add_u32 v13, s43, v13
    v_add_u32 v12, 0, v13
    v_lshrrev_b32 v11, 5, v12
    v_lshlrev_b32 v11, 10, v11
    v_bfe_u32 v30, v12, 3, 2
    v_lshl_add_u32 v11, v30, 8, v11
    v_and_b32 v30, 7, v12
    v_lshl_add_u32 v11, v30, 1, v11
    v_add_u32 v244, v11, v14
    v_add_u32 v12, 8, v13
    v_lshrrev_b32 v11, 5, v12
    v_lshlrev_b32 v11, 10, v11
    v_bfe_u32 v30, v12, 3, 2
    v_lshl_add_u32 v11, v30, 8, v11
    v_and_b32 v30, 7, v12
    v_lshl_add_u32 v11, v30, 1, v11
    v_add_u32 v245, v11, v14
    v_add_u32 v12, 16, v13
    v_lshrrev_b32 v11, 5, v12
    v_lshlrev_b32 v11, 10, v11
    v_bfe_u32 v30, v12, 3, 2
    v_lshl_add_u32 v11, v30, 8, v11
    v_and_b32 v30, 7, v12
    v_lshl_add_u32 v11, v30, 1, v11
    v_add_u32 v246, v11, v14
    v_mov_b32 v30, 1073741824
    v_cndmask_b32 v246, v30, v246, s[74:75]
    s_and_b32 s39, s38, 1
    s_xor_b32 s39, s39, 0
    s_lshl_b32 s39, s39, 1
    s_lshl_b32 s40, s36, 2
    s_add_u32 s39, s39, s40
    s_mul_i32 s39, s39, 20480
    s_add_u32 s70, s39, 9240576
    s_and_b32 s39, s38, 1
    s_xor_b32 s39, s39, 1
    s_lshl_b32 s39, s39, 1
    s_lshl_b32 s40, s36, 2
    s_add_u32 s39, s39, s40
    s_mul_i32 s39, s39, 20480
    s_add_u32 s71, s39, 9240576
    v_mov_b32 v144, 0x3f803f80
    v_mov_b32 v146, 0
    v_mov_b32 v147, 0
    v_mov_b32 v148, 0
    v_mov_b32 v149, 0
    v_mov_b32 v150, 0
    v_mov_b32 v151, 0
    v_mov_b32 v152, 0
    v_mov_b32 v153, 0
    v_add_u32 v7, 0, v5
    v_and_b32 v8, 15, v7
    v_xor_b32 v8, v8, v4
    v_mul_u32_u24 v7, 1280, v7
    v_lshl_add_u32 v154, v8, 4, v7
    v_add_u32 v7, 4, v5
    v_and_b32 v8, 15, v7
    v_xor_b32 v8, v8, v4
    v_mul_u32_u24 v7, 1280, v7
    v_lshl_add_u32 v155, v8, 4, v7
    v_and_b32 v16, 31, v1
    v_lshrrev_b32 v17, 5, v1
    v_and_b32 v18, 15, v16
    v_xor_b32 v18, v18, v17
    v_mul_u32_u24 v19, 1280, v16
    v_lshl_add_u32 v19, v18, 4, v19
    v_xor_b32 v2, 0, v19
    v_xor_b32 v3, 32, v19
    v_xor_b32 v4, 64, v19
    v_xor_b32 v5, 96, v19
    v_xor_b32 v6, 128, v19
    v_xor_b32 v7, 160, v19
    v_xor_b32 v8, 192, v19
    v_xor_b32 v9, 224, v19
    s_and_b32 s41, s38, 1
    s_mul_i32 s42, s41, 40960
    s_sub_u32 s43, 40960, s42
    v_add_u32 v18, s43, v2
    v_add_u32 v19, s43, v3
    v_add_u32 v20, s43, v4
    v_add_u32 v21, s43, v5
    v_add_u32 v22, s43, v6
    v_add_u32 v23, s43, v7
    v_add_u32 v24, s43, v8
    v_add_u32 v25, s43, v9
    v_add_u32 v2, s42, v2
    v_add_u32 v3, s42, v3
    v_add_u32 v4, s42, v4
    v_add_u32 v5, s42, v5
    v_add_u32 v6, s42, v6
    v_add_u32 v7, s42, v7
    v_add_u32 v8, s42, v8
    v_add_u32 v9, s42, v9
    v_lshrrev_b32 v26, 5, v1
    v_bfe_u32 v28, v1, 2, 2
    v_lshl_add_u32 v26, v26, 3, v28
    v_bfe_u32 v27, v1, 4, 1
    v_lshlrev_b32 v27, 5, v27
    v_and_b32 v29, 3, v1
    v_lshl_add_u32 v27, v29, 3, v27
    v_mul_u32_u24 v10, 192, v26
    v_add_u32 v10, v10, v27
    s_mul_i32 s39, s38, 40
    s_add_u32 s39, s39, 94208
    v_add_u32 v10, s39, v10
    v_lshrrev_b32 v29, 1, v28
    s_lshr_b32 s40, s38, 1
    s_mul_i32 s40, s40, 3
    s_add_u32 s39, s40, 0
    v_xor_b32 v30, s39, v29
    v_mul_u32_u24 v11, 384, v26
    v_lshl_add_u32 v11, v30, 6, v11
    v_add_u32 v11, v11, v27
    v_add_u32 v11, 81920, v11
    s_add_u32 s39, s40, 1
    v_xor_b32 v30, s39, v29
    v_mul_u32_u24 v12, 384, v26
    v_lshl_add_u32 v12, v30, 6, v12
    v_add_u32 v12, v12, v27
    v_add_u32 v12, 81920, v12
    s_add_u32 s39, s40, 2
    v_xor_b32 v30, s39, v29
    v_mul_u32_u24 v13, 384, v26
    v_lshl_add_u32 v13, v30, 6, v13
    v_add_u32 v13, v13, v27
    v_add_u32 v13, 81920, v13
    s_waitcnt lgkmcnt(0)
    s_mov_b32 s8, s44
    s_mov_b32 s9, s45
    s_mov_b32 s10, 2621440
    s_mov_b32 s11, 0x00020000
    s_mov_b32 s12, s46
    s_mov_b32 s13, s47
    s_mov_b32 s14, 819200
    s_mov_b32 s15, 0x00020000
    s_mov_b32 s16, s56
    s_mov_b32 s17, s57
    s_mov_b32 s18, 1966080
    s_mov_b32 s19, 0x00020000
    s_mov_b32 s24, s68
    s_mov_b32 s25, s69
    s_mov_b32 s26, 13008896
    s_mov_b32 s27, 0x00020000
    s_mov_b32 s32, s58
    s_mov_b32 s33, s59
    s_mov_b32 s34, 3072
    s_mov_b32 s35, 0x00020000
    s_cmp_lt_u32 s79, 2
    s_cselect_b32 s20, s48, s50
    s_cselect_b32 s21, s49, s51
    s_mov_b32 s22, 25600
    s_mov_b32 s23, 0x00020000
    s_mul_i32 s39, s37, 384
    s_lshr_b32 s40, s38, 1
    s_mul_i32 s40, s40, 192
    s_add_u32 s39, s39, s40
    v_lshrrev_b32 v254, 5, v1
    v_lshlrev_b32 v254, 3, v254
    buffer_load_dwordx2 v[208:209], v254, s[32:35], s39 offen offset:0
    buffer_load_dwordx2 v[210:211], v254, s[32:35], s39 offen offset:16
    buffer_load_dwordx2 v[212:213], v254, s[32:35], s39 offen offset:32
    buffer_load_dwordx2 v[214:215], v254, s[32:35], s39 offen offset:48
    buffer_load_dwordx2 v[216:217], v254, s[32:35], s39 offen offset:64
    buffer_load_dwordx2 v[218:219], v254, s[32:35], s39 offen offset:80
    buffer_load_dwordx2 v[220:221], v254, s[32:35], s39 offen offset:96
    buffer_load_dwordx2 v[222:223], v254, s[32:35], s39 offen offset:112
    buffer_load_dwordx2 v[224:225], v254, s[32:35], s39 offen offset:128
    buffer_load_dwordx2 v[226:227], v254, s[32:35], s39 offen offset:144
    buffer_load_dwordx2 v[228:229], v254, s[32:35], s39 offen offset:160
    buffer_load_dwordx2 v[230:231], v254, s[32:35], s39 offen offset:176
    s_mul_i32 s39, s36, 81920
    s_add_u32 s40, s39, 5120
    buffer_load_dwordx4 v[80:83], v249, s[8:11], s39 offen offset:0
    buffer_load_dwordx4 v[84:87], v249, s[8:11], s39 offen offset:256
    buffer_load_dwordx4 v[88:91], v249, s[8:11], s39 offen offset:512
    buffer_load_dwordx4 v[92:95], v249, s[8:11], s39 offen offset:768
    buffer_load_dwordx4 v[96:99], v249, s[8:11], s39 offen offset:1024
    buffer_load_dwordx4 v[100:103], v249, s[8:11], s40 offen offset:0
    buffer_load_dwordx4 v[104:107], v249, s[8:11], s40 offen offset:256
    buffer_load_dwordx4 v[108:111], v249, s[8:11], s40 offen offset:512
    buffer_load_dwordx4 v[112:115], v249, s[8:11], s40 offen offset:768
    buffer_load_dwordx4 v[116:119], v249, s[8:11], s40 offen offset:1024
    s_cmp_eq_u32 s77, 0
    s_cbranch_scc1 L_nokvw_1
    v_lshlrev_b32 v255, 4, v1
    s_lshl_b32 s39, s38, 10
    s_add_u32 m0, s39, 137216
    s_add_u32 s40, s39, 0
    buffer_load_dwordx4 v255, s[20:23], s40 offen lds
    s_add_u32 m0, s39, 145408
    s_add_u32 s40, s39, 8192
    buffer_load_dwordx4 v255, s[20:23], s40 offen lds
    s_add_u32 m0, s39, 153600
    s_add_u32 s40, s39, 16384
    buffer_load_dwordx4 v255, s[20:23], s40 offen lds
    s_add_u32 m0, s39, 161792
    s_add_u32 s40, s39, 24576
    buffer_load_dwordx4 v255, s[20:23], s40 offen lds
L_nokvw_1:
    s_cmp_eq_u32 s77, 0
    s_cbranch_scc1 L_wx1_2
    s_waitcnt vmcnt(4)
    s_branch L_wx2_3
L_wx1_2:
    s_waitcnt vmcnt(0)
L_wx2_3:
    v_dot2_f32_bf16 v146, v80, v144, v146
    v_dot2_f32_bf16 v148, v80, v80, v148
    v_dot2_f32_bf16 v147, v81, v144, v147
    v_dot2_f32_bf16 v149, v81, v81, v149
    v_dot2_f32_bf16 v146, v82, v144, v146
    v_dot2_f32_bf16 v148, v82, v82, v148
    v_dot2_f32_bf16 v147, v83, v144, v147
    v_dot2_f32_bf16 v149, v83, v83, v149
    v_dot2_f32_bf16 v146, v84, v144, v146
    v_dot2_f32_bf16 v148, v84, v84, v148
    v_dot2_f32_bf16 v147, v85, v144, v147
    v_dot2_f32_bf16 v149, v85, v85, v149
    v_dot2_f32_bf16 v146, v86, v144, v146
    v_dot2_f32_bf16 v148, v86, v86, v148
    v_dot2_f32_bf16 v147, v87, v144, v147
    v_dot2_f32_bf16 v149, v87, v87, v149
    v_dot2_f32_bf16 v146, v88, v144, v146
    v_dot2_f32_bf16 v148, v88, v88, v148
    v_dot2_f32_bf16 v147, v89, v144, v147
    v_dot2_f32_bf16 v149, v89, v89, v149
    v_dot2_f32_bf16 v146, v90, v144, v146
    v_dot2_f32_bf16 v148, v90, v90, v148
    v_dot2_f32_bf16 v147, v91, v144, v147
    v_dot2_f32_bf16 v149, v91, v91, v149
    v_dot2_f32_bf16 v146, v92, v144, v146
    v_dot2_f32_bf16 v148, v92, v92, v148
    v_dot2_f32_bf16 v147, v93, v144, v147
    v_dot2_f32_bf16 v149, v93, v93, v149
    v_dot2_f32_bf16 v146, v94, v144, v146
    v_dot2_f32_bf16 v148, v94, v94, v148
    v_dot2_f32_bf16 v147, v95, v144, v147
    v_dot2_f32_bf16 v149, v95, v95, v149
    v_dot2_f32_bf16 v146, v96, v144, v146
    v_dot2_f32_bf16 v148, v96, v96, v148
    v_dot2_f32_bf16 v147, v97, v144, v147
    v_dot2_f32_bf16 v149, v97, v97, v149
    v_dot2_f32_bf16 v146, v98, v144, v146
    v_dot2_f32_bf16 v148, v98, v98, v148
    v_dot2_f32_bf16 v147, v99, v144, v147
    v_dot2_f32_bf16 v149, v99, v99, v149
    v_dot2_f32_bf16 v150, v100, v144, v150
    v_dot2_f32_bf16 v152, v100, v100, v152
    v_dot2_f32_bf16 v151, v101, v144, v151
    v_dot2_f32_bf16 v153, v101, v101, v153
    v_dot2_f32_bf16 v150, v102, v144, v150
    v_dot2_f32_bf16 v152, v102, v102, v152
    v_dot2_f32_bf16 v151, v103, v144, v151
    v_dot2_f32_bf16 v153, v103, v103, v153
    v_dot2_f32_bf16 v150, v104, v144, v150
    v_dot2_f32_bf16 v152, v104, v104, v152
    v_dot2_f32_bf16 v151, v105, v144, v151
    v_dot2_f32_bf16 v153, v105, v105, v153
    v_dot2_f32_bf16 v150, v106, v144, v150
    v_dot2_f32_bf16 v152, v106, v106, v152
    v_dot2_f32_bf16 v151, v107, v144, v151
    v_dot2_f32_bf16 v153, v107, v107, v153
    v_dot2_f32_bf16 v150, v108, v144, v150
    v_dot2_f32_bf16 v152, v108, v108, v152
    v_dot2_f32_bf16 v151, v109, v144, v151
    v_dot2_f32_bf16 v153, v109, v109, v153
    v_dot2_f32_bf16 v150, v110, v144, v150
    v_dot2_f32_bf16 v152, v110, v110, v152
    v_dot2_f32_bf16 v151, v111, v144, v151
    v_dot2_f32_bf16 v153, v111, v111, v153
    v_dot2_f32_bf16 v150, v112, v144, v150
    v_dot2_f32_bf16 v152, v112, v112, v152
    v_dot2_f32_bf16 v151, v113, v144, v151
    v_dot2_f32_bf16 v153, v113, v113, v153
    v_dot2_f32_bf16 v150, v114, v144, v150
    v_dot2_f32_bf16 v152, v114, v114, v152
    v_dot2_f32_bf16 v151, v115, v144, v151
    v_dot2_f32_bf16 v153, v115, v115, v153
    v_dot2_f32_bf16 v150, v116, v144, v150
    v_dot2_f32_bf16 v152, v116, v116, v152
    v_dot2_f32_bf16 v151, v117, v144, v151
    v_dot2_f32_bf16 v153, v117, v117, v153
    v_dot2_f32_bf16 v150, v118, v144, v150
    v_dot2_f32_bf16 v152, v118, v118, v152
    v_dot2_f32_bf16 v151, v119, v144, v151
    v_dot2_f32_bf16 v153, v119, v119, v153
    s_mov_b32 s39, 986500301
    s_mov_b32 s40, 925353388
    s_nop 1
    v_add_f32 v146, v146, v147
    v_add_f32 v148, v148, v149
    v_add_f32 v150, v150, v151
    v_add_f32 v152, v152, v153
    s_nop 0
    v_add_f32_dpp v146, v146, v146 row_ror:8 row_mask:0xf bank_mask:0xf
    v_add_f32_dpp v148, v148, v148 row_ror:8 row_mask:0xf bank_mask:0xf
    v_add_f32_dpp v150, v150, v150 row_ror:8 row_mask:0xf bank_mask:0xf
    v_add_f32_dpp v152, v152, v152 row_ror:8 row_mask:0xf bank_mask:0xf
    v_add_f32_dpp v146, v146, v146 row_ror:4 row_mask:0xf bank_mask:0xf
    v_add_f32_dpp v148, v148, v148 row_ror:4 row_mask:0xf bank_mask:0xf
    v_add_f32_dpp v150, v150, v150 row_ror:4 row_mask:0xf bank_mask:0xf
    v_add_f32_dpp v152, v152, v152 row_ror:4 row_mask:0xf bank_mask:0xf
    v_add_f32_dpp v146, v146, v146 row_ror:2 row_mask:0xf bank_mask:0xf
    v_add_f32_dpp v148, v148, v148 row_ror:2 row_mask:0xf bank_mask:0xf
    v_add_f32_dpp v150, v150, v150 row_ror:2 row_mask:0xf bank_mask:0xf
    v_add_f32_dpp v152, v152, v152 row_ror:2 row_mask:0xf bank_mask:0xf
    v_add_f32_dpp v146, v146, v146 row_ror:1 row_mask:0xf bank_mask:0xf
    v_add_f32_dpp v148, v148, v148 row_ror:1 row_mask:0xf bank_mask:0xf
    v_add_f32_dpp v150, v150, v150 row_ror:1 row_mask:0xf bank_mask:0xf
    v_add_f32_dpp v152, v152, v152 row_ror:1 row_mask:0xf bank_mask:0xf
    v_mul_f32 v146, s39, v146
    v_mul_f32 v148, s39, v148
    v_mul_f32 v150, s39, v150
    v_mul_f32 v152, s39, v152
    v_fma_f32 v148, -v146, v146, v148
    v_fma_f32 v152, -v150, v150, v152
    v_max_f32 v148, 0, v148
    v_max_f32 v152, 0, v152
    v_add_f32 v148, s40, v148
    v_add_f32 v152, s40, v152
    v_rsq_f32 v148, v148
    v_rsq_f32 v152, v152
    s_nop 0
    v_mul_f32 v149, -v146, v148
    v_mul_f32 v153, -v150, v152
    v_lshlrev_b32 v156, 16, v80
    v_and_b32 v157, 0xffff0000, v80
    v_pk_fma_f32 v[156:157], v[156:157], v[148:149], v[148:149] op_sel:[0,0,1] op_sel_hi:[1,0,1]
    v_cvt_pk_bf16_f32 v80, v156, v157
    v_lshlrev_b32 v158, 16, v81
    v_and_b32 v159, 0xffff0000, v81
    v_pk_fma_f32 v[158:159], v[158:159], v[148:149], v[148:149] op_sel:[0,0,1] op_sel_hi:[1,0,1]
    v_cvt_pk_bf16_f32 v81, v158, v159
    v_lshlrev_b32 v156, 16, v82
    v_and_b32 v157, 0xffff0000, v82
    v_pk_fma_f32 v[156:157], v[156:157], v[148:149], v[148:149] op_sel:[0,0,1] op_sel_hi:[1,0,1]
    v_cvt_pk_bf16_f32 v82, v156, v157
    v_lshlrev_b32 v158, 16, v83
    v_and_b32 v159, 0xffff0000, v83
    v_pk_fma_f32 v[158:159], v[158:159], v[148:149], v[148:149] op_sel:[0,0,1] op_sel_hi:[1,0,1]
    v_cvt_pk_bf16_f32 v83, v158, v159
    ds_write_b128 v154, v[80:83] offset:0
    v_lshlrev_b32 v156, 16, v84
    v_and_b32 v157, 0xffff0000, v84
    v_pk_fma_f32 v[156:157], v[156:157], v[148:149], v[148:149] op_sel:[0,0,1] op_sel_hi:[1,0,1]
    v_cvt_pk_bf16_f32 v84, v156, v157
    v_lshlrev_b32 v158, 16, v85
    v_and_b32 v159, 0xffff0000, v85
    v_pk_fma_f32 v[158:159], v[158:159], v[148:149], v[148:149] op_sel:[0,0,1] op_sel_hi:[1,0,1]
    v_cvt_pk_bf16_f32 v85, v158, v159
    v_lshlrev_b32 v156, 16, v86
    v_and_b32 v157, 0xffff0000, v86
    v_pk_fma_f32 v[156:157], v[156:157], v[148:149], v[148:149] op_sel:[0,0,1] op_sel_hi:[1,0,1]
    v_cvt_pk_bf16_f32 v86, v156, v157
    v_lshlrev_b32 v158, 16, v87
    v_and_b32 v159, 0xffff0000, v87
    v_pk_fma_f32 v[158:159], v[158:159], v[148:149], v[148:149] op_sel:[0,0,1] op_sel_hi:[1,0,1]
    v_cvt_pk_bf16_f32 v87, v158, v159
    ds_write_b128 v154, v[84:87] offset:256
    v_lshlrev_b32 v156, 16, v88
    v_and_b32 v157, 0xffff0000, v88
    v_pk_fma_f32 v[156:157], v[156:157], v[148:149], v[148:149] op_sel:[0,0,1] op_sel_hi:[1,0,1]
    v_cvt_pk_bf16_f32 v88, v156, v157
    v_lshlrev_b32 v158, 16, v89
    v_and_b32 v159, 0xffff0000, v89
    v_pk_fma_f32 v[158:159], v[158:159], v[148:149], v[148:149] op_sel:[0,0,1] op_sel_hi:[1,0,1]
    v_cvt_pk_bf16_f32 v89, v158, v159
    v_lshlrev_b32 v156, 16, v90
    v_and_b32 v157, 0xffff0000, v90
    v_pk_fma_f32 v[156:157], v[156:157], v[148:149], v[148:149] op_sel:[0,0,1] op_sel_hi:[1,0,1]
    v_cvt_pk_bf16_f32 v90, v156, v157
    v_lshlrev_b32 v158, 16, v91
    v_and_b32 v159, 0xffff0000, v91
    v_pk_fma_f32 v[158:159], v[158:159], v[148:149], v[148:149] op_sel:[0,0,1] op_sel_hi:[1,0,1]
    v_cvt_pk_bf16_f32 v91, v158, v159
    ds_write_b128 v154, v[88:91] offset:512
    v_lshlrev_b32 v156, 16, v92
    v_and_b32 v157, 0xffff0000, v92
    v_pk_fma_f32 v[156:157], v[156:157], v[148:149], v[148:149] op_sel:[0,0,1] op_sel_hi:[1,0,1]
    v_cvt_pk_bf16_f32 v92, v156, v157
    v_lshlrev_b32 v158, 16, v93
    v_and_b32 v159, 0xffff0000, v93
    v_pk_fma_f32 v[158:159], v[158:159], v[148:149], v[148:149] op_sel:[0,0,1] op_sel_hi:[1,0,1]
    v_cvt_pk_bf16_f32 v93, v158, v159
    v_lshlrev_b32 v156, 16, v94
    v_and_b32 v157, 0xffff0000, v94
    v_pk_fma_f32 v[156:157], v[156:157], v[148:149], v[148:149] op_sel:[0,0,1] op_sel_hi:[1,0,1]
    v_cvt_pk_bf16_f32 v94, v156, v157
    v_lshlrev_b32 v158, 16, v95
    v_and_b32 v159, 0xffff0000, v95
    v_pk_fma_f32 v[158:159], v[158:159], v[148:149], v[148:149] op_sel:[0,0,1] op_sel_hi:[1,0,1]
    v_cvt_pk_bf16_f32 v95, v158, v159
    ds_write_b128 v154, v[92:95] offset:768
    v_lshlrev_b32 v156, 16, v96
    v_and_b32 v157, 0xffff0000, v96
    v_pk_fma_f32 v[156:157], v[156:157], v[148:149], v[148:149] op_sel:[0,0,1] op_sel_hi:[1,0,1]
    v_cvt_pk_bf16_f32 v96, v156, v157
    v_lshlrev_b32 v158, 16, v97
    v_and_b32 v159, 0xffff0000, v97
    v_pk_fma_f32 v[158:159], v[158:159], v[148:149], v[148:149] op_sel:[0,0,1] op_sel_hi:[1,0,1]
    v_cvt_pk_bf16_f32 v97, v158, v159
    v_lshlrev_b32 v156, 16, v98
    v_and_b32 v157, 0xffff0000, v98
    v_pk_fma_f32 v[156:157], v[156:157], v[148:149], v[148:149] op_sel:[0,0,1] op_sel_hi:[1,0,1]
    v_cvt_pk_bf16_f32 v98, v156, v157
    v_lshlrev_b32 v158, 16, v99
    v_and_b32 v159, 0xffff0000, v99
    v_pk_fma_f32 v[158:159], v[158:159], v[148:149], v[148:149] op_sel:[0,0,1] op_sel_hi:[1,0,1]
    v_cvt_pk_bf16_f32 v99, v158, v159
    ds_write_b128 v154, v[96:99] offset:1024
    v_lshlrev_b32 v156, 16, v100
    v_and_b32 v157, 0xffff0000, v100
    v_pk_fma_f32 v[156:157], v[156:157], v[152:153], v[152:153] op_sel:[0,0,1] op_sel_hi:[1,0,1]
    v_cvt_pk_bf16_f32 v100, v156, v157
    v_lshlrev_b32 v158, 16, v101
    v_and_b32 v159, 0xffff0000, v101
    v_pk_fma_f32 v[158:159], v[158:159], v[152:153], v[152:153] op_sel:[0,0,1] op_sel_hi:[1,0,1]
    v_cvt_pk_bf16_f32 v101, v158, v159
    v_lshlrev_b32 v156, 16, v102
    v_and_b32 v157, 0xffff0000, v102
    v_pk_fma_f32 v[156:157], v[156:157], v[152:153], v[152:153] op_sel:[0,0,1] op_sel_hi:[1,0,1]
    v_cvt_pk_bf16_f32 v102, v156, v157
    v_lshlrev_b32 v158, 16, v103
    v_and_b32 v159, 0xffff0000, v103
    v_pk_fma_f32 v[158:159], v[158:159], v[152:153], v[152:153] op_sel:[0,0,1] op_sel_hi:[1,0,1]
    v_cvt_pk_bf16_f32 v103, v158, v159
    ds_write_b128 v155, v[100:103] offset:0
    v_lshlrev_b32 v156, 16, v104
    v_and_b32 v157, 0xffff0000, v104
    v_pk_fma_f32 v[156:157], v[156:157], v[152:153], v[152:153] op_sel:[0,0,1] op_sel_hi:[1,0,1]
    v_cvt_pk_bf16_f32 v104, v156, v157
    v_lshlrev_b32 v158, 16, v105
    v_and_b32 v159, 0xffff0000, v105
    v_pk_fma_f32 v[158:159], v[158:159], v[152:153], v[152:153] op_sel:[0,0,1] op_sel_hi:[1,0,1]
    v_cvt_pk_bf16_f32 v105, v158, v159
    v_lshlrev_b32 v156, 16, v106
    v_and_b32 v157, 0xffff0000, v106
    v_pk_fma_f32 v[156:157], v[156:157], v[152:153], v[152:153] op_sel:[0,0,1] op_sel_hi:[1,0,1]
    v_cvt_pk_bf16_f32 v106, v156, v157
    v_lshlrev_b32 v158, 16, v107
    v_and_b32 v159, 0xffff0000, v107
    v_pk_fma_f32 v[158:159], v[158:159], v[152:153], v[152:153] op_sel:[0,0,1] op_sel_hi:[1,0,1]
    v_cvt_pk_bf16_f32 v107, v158, v159
    ds_write_b128 v155, v[104:107] offset:256
    v_lshlrev_b32 v156, 16, v108
    v_and_b32 v157, 0xffff0000, v108
    v_pk_fma_f32 v[156:157], v[156:157], v[152:153], v[152:153] op_sel:[0,0,1] op_sel_hi:[1,0,1]
    v_cvt_pk_bf16_f32 v108, v156, v157
    v_lshlrev_b32 v158, 16, v109
    v_and_b32 v159, 0xffff0000, v109
    v_pk_fma_f32 v[158:159], v[158:159], v[152:153], v[152:153] op_sel:[0,0,1] op_sel_hi:[1,0,1]
    v_cvt_pk_bf16_f32 v109, v158, v159
    v_lshlrev_b32 v156, 16, v110
    v_and_b32 v157, 0xffff0000, v110
    v_pk_fma_f32 v[156:157], v[156:157], v[152:153], v[152:153] op_sel:[0,0,1] op_sel_hi:[1,0,1]
    v_cvt_pk_bf16_f32 v110, v156, v157
    v_lshlrev_b32 v158, 16, v111
    v_and_b32 v159, 0xffff0000, v111
    v_pk_fma_f32 v[158:159], v[158:159], v[152:153], v[152:153] op_sel:[0,0,1] op_sel_hi:[1,0,1]
    v_cvt_pk_bf16_f32 v111, v158, v159
    ds_write_b128 v155, v[108:111] offset:512
    v_lshlrev_b32 v156, 16, v112
    v_and_b32 v157, 0xffff0000, v112
    v_pk_fma_f32 v[156:157], v[156:157], v[152:153], v[152:153] op_sel:[0,0,1] op_sel_hi:[1,0,1]
    v_cvt_pk_bf16_f32 v112, v156, v157
    v_lshlrev_b32 v158, 16, v113
    v_and_b32 v159, 0xffff0000, v113
    v_pk_fma_f32 v[158:159], v[158:159], v[152:153], v[152:153] op_sel:[0,0,1] op_sel_hi:[1,0,1]
    v_cvt_pk_bf16_f32 v113, v158, v159
    v_lshlrev_b32 v156, 16, v114
    v_and_b32 v157, 0xffff0000, v114
    v_pk_fma_f32 v[156:157], v[156:157], v[152:153], v[152:153] op_sel:[0,0,1] op_sel_hi:[1,0,1]
    v_cvt_pk_bf16_f32 v114, v156, v157
    v_lshlrev_b32 v158, 16, v115
    v_and_b32 v159, 0xffff0000, v115
    v_pk_fma_f32 v[158:159], v[158:159], v[152:153], v[152:153] op_sel:[0,0,1] op_sel_hi:[1,0,1]
    v_cvt_pk_bf16_f32 v115, v158, v159
    ds_write_b128 v155, v[112:115] offset:768
    v_lshlrev_b32 v156, 16, v116
    v_and_b32 v157, 0xffff0000, v116
    v_pk_fma_f32 v[156:157], v[156:157], v[152:153], v[152:153] op_sel:[0,0,1] op_sel_hi:[1,0,1]
    v_cvt_pk_bf16_f32 v116, v156, v157
    v_lshlrev_b32 v158, 16, v117
    v_and_b32 v159, 0xffff0000, v117
    v_pk_fma_f32 v[158:159], v[158:159], v[152:153], v[152:153] op_sel:[0,0,1] op_sel_hi:[1,0,1]
    v_cvt_pk_bf16_f32 v117, v158, v159
    v_lshlrev_b32 v156, 16, v118
    v_and_b32 v157, 0xffff0000, v118
    v_pk_fma_f32 v[156:157], v[156:157], v[152:153], v[152:153] op_sel:[0,0,1] op_sel_hi:[1,0,1]
    v_cvt_pk_bf16_f32 v118, v156, v157
    v_lshlrev_b32 v158, 16, v119
    v_and_b32 v159, 0xffff0000, v119
    v_pk_fma_f32 v[158:159], v[158:159], v[152:153], v[152:153] op_sel:[0,0,1] op_sel_hi:[1,0,1]
    v_cvt_pk_bf16_f32 v119, v158, v159
    ds_write_b128 v155, v[116:119] offset:1024
    v_lshlrev_b32 v160, 16, v208
    v_and_b32 v161, 0xffff0000, v208
    v_lshlrev_b32 v162, 16, v209
    v_and_b32 v163, 0xffff0000, v209
    v_lshlrev_b32 v164, 16, v210
    v_and_b32 v165, 0xffff0000, v210
    v_lshlrev_b32 v166, 16, v211
    v_and_b32 v167, 0xffff0000, v211
    v_lshlrev_b32 v168, 16, v212
    v_and_b32 v169, 0xffff0000, v212
    v_lshlrev_b32 v170, 16, v213
    v_and_b32 v171, 0xffff0000, v213
    v_lshlrev_b32 v172, 16, v214
    v_and_b32 v173, 0xffff0000, v214
    v_lshlrev_b32 v174, 16, v215
    v_and_b32 v175, 0xffff0000, v215
    v_lshlrev_b32 v176, 16, v216
    v_and_b32 v177, 0xffff0000, v216
    v_lshlrev_b32 v178, 16, v217
    v_and_b32 v179, 0xffff0000, v217
    v_lshlrev_b32 v180, 16, v218
    v_and_b32 v181, 0xffff0000, v218
    v_lshlrev_b32 v182, 16, v219
    v_and_b32 v183, 0xffff0000, v219
    v_lshlrev_b32 v184, 16, v220
    v_and_b32 v185, 0xffff0000, v220
    v_lshlrev_b32 v186, 16, v221
    v_and_b32 v187, 0xffff0000, v221
    v_lshlrev_b32 v188, 16, v222
    v_and_b32 v189, 0xffff0000, v222
    v_lshlrev_b32 v190, 16, v223
    v_and_b32 v191, 0xffff0000, v223
    v_lshlrev_b32 v192, 16, v224
    v_and_b32 v193, 0xffff0000, v224
    v_lshlrev_b32 v194, 16, v225
    v_and_b32 v195, 0xffff0000, v225
    v_lshlrev_b32 v196, 16, v226
    v_and_b32 v197, 0xffff0000, v226
    v_lshlrev_b32 v198, 16, v227
    v_and_b32 v199, 0xffff0000, v227
    v_lshlrev_b32 v200, 16, v228
    v_and_b32 v201, 0xffff0000, v228
    v_lshlrev_b32 v202, 16, v229
    v_and_b32 v203, 0xffff0000, v229
    v_lshlrev_b32 v204, 16, v230
    v_and_b32 v205, 0xffff0000, v230
    v_lshlrev_b32 v206, 16, v231
    v_and_b32 v207, 0xffff0000, v231
    v_mov_b32 v128, 0
    v_mov_b32 v129, 0
    v_mov_b32 v130, 0
    v_mov_b32 v131, 0
    v_mov_b32 v132, 0
    v_mov_b32 v133, 0
    v_mov_b32 v134, 0
    v_mov_b32 v135, 0
    v_mov_b32 v136, 0
    v_mov_b32 v137, 0
    v_mov_b32 v138, 0
    v_mov_b32 v139, 0
    v_mov_b32 v140, 0
    v_mov_b32 v141, 0
    v_mov_b32 v142, 0
    v_mov_b32 v143, 0
    v_mov_b32 v144, 0
    v_mov_b32 v145, 0
    v_mov_b32 v146, 0
    v_mov_b32 v147, 0
    v_mov_b32 v148, 0
    v_mov_b32 v149, 0
    v_mov_b32 v150, 0
    v_mov_b32 v151, 0
    v_mov_b32 v152, 0
    v_mov_b32 v153, 0
    v_mov_b32 v154, 0
    v_mov_b32 v155, 0
    v_mov_b32 v156, 0
    v_mov_b32 v157, 0
    v_mov_b32 v158, 0
    v_mov_b32 v159, 0
    s_mov_b32 s44, 0
    v_add_u32 v26, s44, v10
    v_add_u32 v27, s44, v11
    v_add_u32 v28, s44, v12
    v_add_u32 v29, s44, v13
    s_waitcnt vmcnt(0) lgkmcnt(0)
    s_barrier
    ds_read_b128 v[32:35], v2
    ds_read_b128 v[36:39], v18
    ds_read_b64_tr_b16 v[48:49], v26 offset:0
    ds_read_b64_tr_b16 v[50:51], v26 offset:768
    ds_read_b64_tr_b16 v[56:57], v27 offset:0
    ds_read_b64_tr_b16 v[58:59], v27 offset:1536
    ds_read_b64_tr_b16 v[60:61], v28 offset:0
    ds_read_b64_tr_b16 v[62:63], v28 offset:1536
    ds_read_b64_tr_b16 v[64:65], v29 offset:0
    ds_read_b64_tr_b16 v[66:67], v29 offset:1536
    ds_read_b128 v[40:43], v3
    ds_read_b128 v[44:47], v19
    ds_read_b64_tr_b16 v[52:53], v26 offset:3072
    ds_read_b64_tr_b16 v[54:55], v26 offset:3840
    ds_read_b64_tr_b16 v[68:69], v27 offset:6144
    ds_read_b64_tr_b16 v[70:71], v27 offset:7680
    ds_read_b64_tr_b16 v[72:73], v28 offset:6144
    ds_read_b64_tr_b16 v[74:75], v28 offset:7680
    ds_read_b64_tr_b16 v[76:77], v29 offset:6144
    ds_read_b64_tr_b16 v[78:79], v29 offset:7680
    s_add_u32 s44, s44, 18432
    s_cmp_eq_u32 s44, 55296
    s_cselect_b32 s44, 0, s44
    v_add_u32 v26, s44, v10
    v_add_u32 v27, s44, v11
    v_add_u32 v28, s44, v12
    v_add_u32 v29, s44, v13
    s_mov_b32 s43, 5
L_gemm1_4:
    s_waitcnt lgkmcnt(0)
    s_barrier
    v_mfma_f32_32x32x16_bf16 v[160:175], v[56:59], v[32:35], v[160:175]
    ds_read_b128 v[80:83], v4
    ds_read_b128 v[84:87], v20
    ds_read_b64_tr_b16 v[96:97], v26 offset:0
    v_mfma_f32_32x32x16_bf16 v[176:191], v[60:63], v[32:35], v[176:191]
    ds_read_b64_tr_b16 v[98:99], v26 offset:768
    ds_read_b64_tr_b16 v[104:105], v27 offset:0
    ds_read_b64_tr_b16 v[106:107], v27 offset:1536
    v_mfma_f32_32x32x16_bf16 v[192:207], v[64:67], v[32:35], v[192:207]
    ds_read_b64_tr_b16 v[108:109], v28 offset:0
    ds_read_b64_tr_b16 v[110:111], v28 offset:1536
    ds_read_b64_tr_b16 v[112:113], v29 offset:0
    v_mfma_f32_32x32x16_bf16 v[128:143], v[48:51], v[32:35], v[128:143]
    ds_read_b64_tr_b16 v[114:115], v29 offset:1536
    ds_read_b128 v[88:91], v5
    ds_read_b128 v[92:95], v21
    v_mfma_f32_32x32x16_bf16 v[144:159], v[48:51], v[36:39], v[144:159]
    ds_read_b64_tr_b16 v[100:101], v26 offset:3072
    ds_read_b64_tr_b16 v[102:103], v26 offset:3840
    ds_read_b64_tr_b16 v[116:117], v27 offset:6144
    v_mfma_f32_32x32x16_bf16 v[160:175], v[68:71], v[40:43], v[160:175]
    ds_read_b64_tr_b16 v[118:119], v27 offset:7680
    ds_read_b64_tr_b16 v[120:121], v28 offset:6144
    ds_read_b64_tr_b16 v[122:123], v28 offset:7680
    v_mfma_f32_32x32x16_bf16 v[176:191], v[72:75], v[40:43], v[176:191]
    ds_read_b64_tr_b16 v[124:125], v29 offset:6144
    ds_read_b64_tr_b16 v[126:127], v29 offset:7680
    v_mfma_f32_32x32x16_bf16 v[192:207], v[76:79], v[40:43], v[192:207]
    s_add_u32 s44, s44, 18432
    s_cmp_eq_u32 s44, 55296
    s_cselect_b32 s44, 0, s44
    v_add_u32 v26, s44, v10
    v_add_u32 v27, s44, v11
    v_add_u32 v28, s44, v12
    v_add_u32 v29, s44, v13
    v_mfma_f32_32x32x16_bf16 v[128:143], v[52:55], v[40:43], v[128:143]
    v_mfma_f32_32x32x16_bf16 v[144:159], v[52:55], v[44:47], v[144:159]
    s_waitcnt lgkmcnt(0)
    s_barrier
    s_cmp_eq_u32 s43, 2
    s_cbranch_scc0 L_nonce_5
    v_mov_b32 v14, 162816
    ds_read_b32 v15, v14
    s_waitcnt lgkmcnt(0)
    v_readfirstlane_b32 s76, v15
L_nonce_5:
    v_mfma_f32_32x32x16_bf16 v[160:175], v[104:107], v[80:83], v[160:175]
    ds_read_b128 v[32:35], v6
    ds_read_b128 v[36:39], v22
    ds_read_b64_tr_b16 v[48:49], v26 offset:0
    v_mfma_f32_32x32x16_bf16 v[176:191], v[108:111], v[80:83], v[176:191]
    ds_read_b64_tr_b16 v[50:51], v26 offset:768
    ds_read_b64_tr_b16 v[56:57], v27 offset:0
    ds_read_b64_tr_b16 v[58:59], v27 offset:1536
    v_mfma_f32_32x32x16_bf16 v[192:207], v[112:115], v[80:83], v[192:207]
    ds_read_b64_tr_b16 v[60:61], v28 offset:0
    ds_read_b64_tr_b16 v[62:63], v28 offset:1536
    ds_read_b64_tr_b16 v[64:65], v29 offset:0
    v_mfma_f32_32x32x16_bf16 v[128:143], v[96:99], v[80:83], v[128:143]
    ds_read_b64_tr_b16 v[66:67], v29 offset:1536
    ds_read_b128 v[40:43], v7
    ds_read_b128 v[44:47], v23
    v_mfma_f32_32x32x16_bf16 v[144:159], v[96:99], v[84:87], v[144:159]
    ds_read_b64_tr_b16 v[52:53], v26 offset:3072
    ds_read_b64_tr_b16 v[54:55], v26 offset:3840
    ds_read_b64_tr_b16 v[68:69], v27 offset:6144
    v_mfma_f32_32x32x16_bf16 v[160:175], v[116:119], v[88:91], v[160:175]
    ds_read_b64_tr_b16 v[70:71], v27 offset:7680
    ds_read_b64_tr_b16 v[72:73], v28 offset:6144
    ds_read_b64_tr_b16 v[74:75], v28 offset:7680
    v_mfma_f32_32x32x16_bf16 v[176:191], v[120:123], v[88:91], v[176:191]
    ds_read_b64_tr_b16 v[76:77], v29 offset:6144
    ds_read_b64_tr_b16 v[78:79], v29 offset:7680
    v_mfma_f32_32x32x16_bf16 v[192:207], v[124:127], v[88:91], v[192:207]
    s_add_u32 s44, s44, 18432
    s_cmp_eq_u32 s44, 55296
    s_cselect_b32 s44, 0, s44
    v_add_u32 v26, s44, v10
    v_add_u32 v27, s44, v11
    v_add_u32 v28, s44, v12
    v_add_u32 v29, s44, v13
    v_mfma_f32_32x32x16_bf16 v[128:143], v[100:103], v[88:91], v[128:143]
    v_mfma_f32_32x32x16_bf16 v[144:159], v[100:103], v[92:95], v[144:159]
    s_waitcnt lgkmcnt(0)
    s_barrier
    v_mfma_f32_32x32x16_bf16 v[160:175], v[56:59], v[32:35], v[160:175]
    ds_read_b128 v[80:83], v8
    ds_read_b128 v[84:87], v24
    ds_read_b64_tr_b16 v[96:97], v26 offset:0
    v_mfma_f32_32x32x16_bf16 v[176:191], v[60:63], v[32:35], v[176:191]
    ds_read_b64_tr_b16 v[98:99], v26 offset:768
    ds_read_b64_tr_b16 v[104:105], v27 offset:0
    ds_read_b64_tr_b16 v[106:107], v27 offset:1536
    v_mfma_f32_32x32x16_bf16 v[192:207], v[64:67], v[32:35], v[192:207]
    ds_read_b64_tr_b16 v[108:109], v28 offset:0
    ds_read_b64_tr_b16 v[110:111], v28 offset:1536
    ds_read_b64_tr_b16 v[112:113], v29 offset:0
    v_mfma_f32_32x32x16_bf16 v[128:143], v[48:51], v[32:35], v[128:143]
    ds_read_b64_tr_b16 v[114:115], v29 offset:1536
    ds_read_b128 v[88:91], v9
    ds_read_b128 v[92:95], v25
    v_mfma_f32_32x32x16_bf16 v[144:159], v[48:51], v[36:39], v[144:159]
    ds_read_b64_tr_b16 v[100:101], v26 offset:3072
    ds_read_b64_tr_b16 v[102:103], v26 offset:3840
    ds_read_b64_tr_b16 v[116:117], v27 offset:6144
    v_mfma_f32_32x32x16_bf16 v[160:175], v[68:71], v[40:43], v[160:175]
    ds_read_b64_tr_b16 v[118:119], v27 offset:7680
    ds_read_b64_tr_b16 v[120:121], v28 offset:6144
    ds_read_b64_tr_b16 v[122:123], v28 offset:7680
    v_mfma_f32_32x32x16_bf16 v[176:191], v[72:75], v[40:43], v[176:191]
    ds_read_b64_tr_b16 v[124:125], v29 offset:6144
    ds_read_b64_tr_b16 v[126:127], v29 offset:7680
    v_mfma_f32_32x32x16_bf16 v[192:207], v[76:79], v[40:43], v[192:207]
    s_add_u32 s44, s44, 18432
    s_cmp_eq_u32 s44, 55296
    s_cselect_b32 s44, 0, s44
    v_add_u32 v26, s44, v10
    v_add_u32 v27, s44, v11
    v_add_u32 v28, s44, v12
    v_add_u32 v29, s44, v13
    v_add_u32 v2, 256, v2
    v_add_u32 v3, 256, v3
    v_add_u32 v4, 256, v4
    v_add_u32 v5, 256, v5
    v_add_u32 v6, 256, v6
    v_add_u32 v7, 256, v7
    v_add_u32 v8, 256, v8
    v_add_u32 v9, 256, v9
    v_mfma_f32_32x32x16_bf16 v[128:143], v[52:55], v[40:43], v[128:143]
    v_add_u32 v18, 256, v18
    v_add_u32 v19, 256, v19
    v_add_u32 v20, 256, v20
    v_add_u32 v21, 256, v21
    v_add_u32 v22, 256, v22
    v_add_u32 v23, 256, v23
    v_add_u32 v24, 256, v24
    v_add_u32 v25, 256, v25
    v_mfma_f32_32x32x16_bf16 v[144:159], v[52:55], v[44:47], v[144:159]
    s_waitcnt lgkmcnt(0)
    s_barrier
    v_mfma_f32_32x32x16_bf16 v[160:175], v[104:107], v[80:83], v[160:175]
    ds_read_b128 v[32:35], v2
    ds_read_b128 v[36:39], v18
    ds_read_b64_tr_b16 v[48:49], v26 offset:0
    v_mfma_f32_32x32x16_bf16 v[176:191], v[108:111], v[80:83], v[176:191]
    ds_read_b64_tr_b16 v[50:51], v26 offset:768
    ds_read_b64_tr_b16 v[56:57], v27 offset:0
    ds_read_b64_tr_b16 v[58:59], v27 offset:1536
    v_mfma_f32_32x32x16_bf16 v[192:207], v[112:115], v[80:83], v[192:207]
    ds_read_b64_tr_b16 v[60:61], v28 offset:0
    ds_read_b64_tr_b16 v[62:63], v28 offset:1536
    ds_read_b64_tr_b16 v[64:65], v29 offset:0
    v_mfma_f32_32x32x16_bf16 v[128:143], v[96:99], v[80:83], v[128:143]
    ds_read_b64_tr_b16 v[66:67], v29 offset:1536
    ds_read_b128 v[40:43], v3
    ds_read_b128 v[44:47], v19
    v_mfma_f32_32x32x16_bf16 v[144:159], v[96:99], v[84:87], v[144:159]
    ds_read_b64_tr_b16 v[52:53], v26 offset:3072
    ds_read_b64_tr_b16 v[54:55], v26 offset:3840
    ds_read_b64_tr_b16 v[68:69], v27 offset:6144
    v_mfma_f32_32x32x16_bf16 v[160:175], v[116:119], v[88:91], v[160:175]
    ds_read_b64_tr_b16 v[70:71], v27 offset:7680
    ds_read_b64_tr_b16 v[72:73], v28 offset:6144
    ds_read_b64_tr_b16 v[74:75], v28 offset:7680
    v_mfma_f32_32x32x16_bf16 v[176:191], v[120:123], v[88:91], v[176:191]
    ds_read_b64_tr_b16 v[76:77], v29 offset:6144
    ds_read_b64_tr_b16 v[78:79], v29 offset:7680
    v_mfma_f32_32x32x16_bf16 v[192:207], v[124:127], v[88:91], v[192:207]
    s_add_u32 s44, s44, 18432
    s_cmp_eq_u32 s44, 55296
    s_cselect_b32 s44, 0, s44
    v_add_u32 v26, s44, v10
    v_add_u32 v27, s44, v11
    v_add_u32 v28, s44, v12
    v_add_u32 v29, s44, v13
    v_mfma_f32_32x32x16_bf16 v[128:143], v[100:103], v[88:91], v[128:143]
    v_mfma_f32_32x32x16_bf16 v[144:159], v[100:103], v[92:95], v[144:159]
    s_sub_u32 s43, s43, 1
    s_cmp_lg_u32 s43, 0
    s_cbranch_scc1 L_gemm1_4
    s_waitcnt lgkmcnt(0)
    s_nop 15
    s_nop 3
    s_mov_b32 s40, 1051011932
    v_mul_f32 v128, s40, v128
    v_mul_f32 v129, s40, v129
    v_mul_f32 v130, s40, v130
    v_mul_f32 v131, s40, v131
    v_mul_f32 v132, s40, v132
    v_mul_f32 v133, s40, v133
    v_mul_f32 v134, s40, v134
    v_mul_f32 v135, s40, v135
    v_mul_f32 v136, s40, v136
    v_mul_f32 v137, s40, v137
    v_mul_f32 v138, s40, v138
    v_mul_f32 v139, s40, v139
    v_cvt_pk_bf16_f32 v208, v128, v129
    v_cvt_pk_bf16_f32 v209, v130, v131
    v_cvt_pk_bf16_f32 v210, v132, v133
    v_cvt_pk_bf16_f32 v211, v134, v135
    v_cvt_pk_bf16_f32 v216, v136, v137
    v_cndmask_b32 v216, 0, v216, s[74:75]
    v_cvt_pk_bf16_f32 v217, v138, v139
    v_cndmask_b32 v217, 0, v217, s[74:75]
    v_mul_f32 v144, s40, v144
    v_mul_f32 v145, s40, v145
    v_mul_f32 v146, s40, v146
    v_mul_f32 v147, s40, v147
    v_mul_f32 v148, s40, v148
    v_mul_f32 v149, s40, v149
    v_mul_f32 v150, s40, v150
    v_mul_f32 v151, s40, v151
    v_mul_f32 v152, s40, v152
    v_mul_f32 v153, s40, v153
    v_mul_f32 v154, s40, v154
    v_mul_f32 v155, s40, v155
    v_cvt_pk_bf16_f32 v212, v144, v145
    v_cvt_pk_bf16_f32 v213, v146, v147
    v_cvt_pk_bf16_f32 v214, v148, v149
    v_cvt_pk_bf16_f32 v215, v150, v151
    v_cvt_pk_bf16_f32 v218, v152, v153
    v_cndmask_b32 v218, 0, v218, s[74:75]
    v_cvt_pk_bf16_f32 v219, v154, v155
    v_cndmask_b32 v219, 0, v219, s[74:75]
    v_max_f32 v160, 0, v160
    v_max_f32 v161, 0, v161
    v_max_f32 v162, 0, v162
    v_max_f32 v163, 0, v163
    v_max_f32 v164, 0, v164
    v_max_f32 v165, 0, v165
    v_max_f32 v166, 0, v166
    v_max_f32 v167, 0, v167
    v_max_f32 v168, 0, v168
    v_max_f32 v169, 0, v169
    v_max_f32 v170, 0, v170
    v_max_f32 v171, 0, v171
    v_max_f32 v172, 0, v172
    v_max_f32 v173, 0, v173
    v_max_f32 v174, 0, v174
    v_max_f32 v175, 0, v175
    v_pk_mul_f32 v[160:161], v[160:161], v[160:161]
    v_pk_mul_f32 v[162:163], v[162:163], v[162:163]
    v_pk_mul_f32 v[164:165], v[164:165], v[164:165]
    v_pk_mul_f32 v[166:167], v[166:167], v[166:167]
    v_pk_mul_f32 v[168:169], v[168:169], v[168:169]
    v_pk_mul_f32 v[170:171], v[170:171], v[170:171]
    v_pk_mul_f32 v[172:173], v[172:173], v[172:173]
    v_pk_mul_f32 v[174:175], v[174:175], v[174:175]
    v_cvt_pk_bf16_f32 v220, v160, v161
    v_cvt_pk_bf16_f32 v221, v162, v163
    v_cvt_pk_bf16_f32 v222, v164, v165
    v_cvt_pk_bf16_f32 v223, v166, v167
    buffer_store_dwordx4 v[220:223], v247, s[24:27], s72 offen offset:0 sc1
    v_cvt_pk_bf16_f32 v224, v168, v169
    v_cvt_pk_bf16_f32 v225, v170, v171
    v_cvt_pk_bf16_f32 v226, v172, v173
    v_cvt_pk_bf16_f32 v227, v174, v175
    buffer_store_dwordx4 v[224:227], v247, s[24:27], s72 offen offset:512 sc1
    v_max_f32 v176, 0, v176
    v_max_f32 v177, 0, v177
    v_max_f32 v178, 0, v178
    v_max_f32 v179, 0, v179
    v_max_f32 v180, 0, v180
    v_max_f32 v181, 0, v181
    v_max_f32 v182, 0, v182
    v_max_f32 v183, 0, v183
    v_max_f32 v184, 0, v184
    v_max_f32 v185, 0, v185
    v_max_f32 v186, 0, v186
    v_max_f32 v187, 0, v187
    v_max_f32 v188, 0, v188
    v_max_f32 v189, 0, v189
    v_max_f32 v190, 0, v190
    v_max_f32 v191, 0, v191
    v_pk_mul_f32 v[176:177], v[176:177], v[176:177]
    v_pk_mul_f32 v[178:179], v[178:179], v[178:179]
    v_pk_mul_f32 v[180:181], v[180:181], v[180:181]
    v_pk_mul_f32 v[182:183], v[182:183], v[182:183]
    v_pk_mul_f32 v[184:185], v[184:185], v[184:185]
    v_pk_mul_f32 v[186:187], v[186:187], v[186:187]
    v_pk_mul_f32 v[188:189], v[188:189], v[188:189]
    v_pk_mul_f32 v[190:191], v[190:191], v[190:191]
    v_cvt_pk_bf16_f32 v228, v176, v177
    v_cvt_pk_bf16_f32 v229, v178, v179
    v_cvt_pk_bf16_f32 v230, v180, v181
    v_cvt_pk_bf16_f32 v231, v182, v183
    buffer_store_dwordx4 v[228:231], v247, s[24:27], s72 offen offset:1024 sc1
    v_cvt_pk_bf16_f32 v232, v184, v185
    v_cvt_pk_bf16_f32 v233, v186, v187
    v_cvt_pk_bf16_f32 v234, v188, v189
    v_cvt_pk_bf16_f32 v235, v190, v191
    buffer_store_dwordx4 v[232:235], v247, s[24:27], s72 offen offset:1536 sc1
    v_max_f32 v192, 0, v192
    v_max_f32 v193, 0, v193
    v_max_f32 v194, 0, v194
    v_max_f32 v195, 0, v195
    v_max_f32 v196, 0, v196
    v_max_f32 v197, 0, v197
    v_max_f32 v198, 0, v198
    v_max_f32 v199, 0, v199
    v_max_f32 v200, 0, v200
    v_max_f32 v201, 0, v201
    v_max_f32 v202, 0, v202
    v_max_f32 v203, 0, v203
    v_max_f32 v204, 0, v204
    v_max_f32 v205, 0, v205
    v_max_f32 v206, 0, v206
    v_max_f32 v207, 0, v207
    v_pk_mul_f32 v[192:193], v[192:193], v[192:193]
    v_pk_mul_f32 v[194:195], v[194:195], v[194:195]
    v_pk_mul_f32 v[196:197], v[196:197], v[196:197]
    v_pk_mul_f32 v[198:199], v[198:199], v[198:199]
    v_pk_mul_f32 v[200:201], v[200:201], v[200:201]
    v_pk_mul_f32 v[202:203], v[202:203], v[202:203]
    v_pk_mul_f32 v[204:205], v[204:205], v[204:205]
    v_pk_mul_f32 v[206:207], v[206:207], v[206:207]
    v_cvt_pk_bf16_f32 v236, v192, v193
    v_cvt_pk_bf16_f32 v237, v194, v195
    v_cvt_pk_bf16_f32 v238, v196, v197
    v_cvt_pk_bf16_f32 v239, v198, v199
    buffer_store_dwordx4 v[236:239], v247, s[24:27], s72 offen offset:2048 sc1
    v_cvt_pk_bf16_f32 v240, v200, v201
    v_cvt_pk_bf16_f32 v241, v202, v203
    v_cvt_pk_bf16_f32 v242, v204, v205
    v_cvt_pk_bf16_f32 v243, v206, v207
    buffer_store_dwordx4 v[240:243], v247, s[24:27], s72 offen offset:2560 sc1
    v_lshlrev_b32 v2, 4, v1
    v_add_u32 v2, 81920, v2
    v_and_b32 v7, 31, v1
    v_lshlrev_b32 v3, 3, v7
    v_add_u32 v3, 82944, v3
    v_lshrrev_b32 v8, 5, v1
    v_mul_u32_u24 v4, 320, v8
    v_lshl_add_u32 v4, v7, 4, v4
    v_add_u32 v4, 122880, v4
    s_mov_b32 s60, 1048575
    s_mov_b32 s61, 1048575
    v_and_b32 v7, 31, v1
    v_cmp_eq_u32 vcc, 20, v7
    v_mov_b32 v12, 0x3f803f80
    s_nop 0
    v_cndmask_b32 v152, 0, v12, vcc
    v_cndmask_b32 v153, 0, v12, vcc
    v_cndmask_b32 v154, 0, v12, vcc
    v_cndmask_b32 v155, 0, v12, vcc
    v_cndmask_b32 v156, 0, v12, vcc
    v_cndmask_b32 v157, 0, v12, vcc
    v_cndmask_b32 v158, 0, v12, vcc
    v_cndmask_b32 v159, 0, v12, vcc
    s_mov_b32 s50, 0
    s_barrier
    ds_read_b128 v[144:147], v2 offset:0
    ds_read_b64 v[148:149], v3 offset:0
    ds_read_b128 v[160:163], v2 offset:1280
    ds_read_b64 v[164:165], v3 offset:1280
    s_waitcnt lgkmcnt(2)
    v_mfma_f32_32x32x16_bf16 v[32:47], v[144:147], v[208:211], 0
    v_mfma_f32_32x32x8_bf16 v[32:47], v[148:149], v[216:217], v[32:47]
    v_mfma_f32_32x32x16_bf16 v[48:63], v[144:147], v[212:215], 0
    v_mfma_f32_32x32x8_bf16 v[48:63], v[148:149], v[218:219], v[48:63]
    s_waitcnt lgkmcnt(0)
    v_mfma_f32_32x32x16_bf16 v[80:95], v[160:163], v[208:211], 0
    v_mfma_f32_32x32x8_bf16 v[80:95], v[164:165], v[216:217], v[80:95]
    v_mfma_f32_32x32x16_bf16 v[96:111], v[160:163], v[212:215], 0
    v_mfma_f32_32x32x8_bf16 v[96:111], v[164:165], v[218:219], v[96:111]
    s_nop 7
    v_max3_f32 v5, v32, v33, v34
    v_max3_f32 v5, v5, v35, v36
    v_max3_f32 v5, v5, v37, v38
    v_max3_f32 v5, v5, v39, v40
    v_max3_f32 v5, v5, v41, v42
    v_max3_f32 v5, v5, v43, v44
    v_max3_f32 v5, v5, v45, v46
    v_max_f32 v5, v5, v47
    v_max3_f32 v6, v48, v49, v50
    v_max3_f32 v6, v6, v51, v52
    v_max3_f32 v6, v6, v53, v54
    v_max3_f32 v6, v6, v55, v56
    v_max3_f32 v6, v6, v57, v58
    v_max3_f32 v6, v6, v59, v60
    v_max3_f32 v6, v6, v61, v62
    v_max_f32 v6, v6, v63
    s_nop 7
    v_max3_f32 v5, v5, v80, v81
    v_max3_f32 v5, v5, v82, v83
    v_max3_f32 v5, v5, v84, v85
    v_max3_f32 v5, v5, v86, v87
    v_max3_f32 v5, v5, v88, v89
    v_max3_f32 v5, v5, v90, v91
    v_max3_f32 v5, v5, v92, v93
    v_max3_f32 v5, v5, v94, v95
    v_max3_f32 v6, v6, v96, v97
    v_max3_f32 v6, v6, v98, v99
    v_max3_f32 v6, v6, v100, v101
    v_max3_f32 v6, v6, v102, v103
    v_max3_f32 v6, v6, v104, v105
    v_max3_f32 v6, v6, v106, v107
    v_max3_f32 v6, v6, v108, v109
    v_max3_f32 v6, v6, v110, v111
    v_mov_b32 v7, v5
    s_nop 1
    v_permlane32_swap_b32 v7, v5
    s_nop 1
    v_max_f32 v5, v5, v7
    v_add_f32 v5, 1118830592, v5
    v_mov_b32 v7, v6
    s_nop 1
    v_permlane32_swap_b32 v7, v6
    s_nop 1
    v_max_f32 v6, v6, v7
    v_add_f32 v6, 1118830592, v6
L_main_6:
    v_sub_f32 v112, 0, v5
    v_mov_b32 v113, v112
    v_mov_b32 v114, v112
    v_mov_b32 v115, v112
    v_mov_b32 v116, v112
    v_mov_b32 v117, v112
    v_mov_b32 v118, v112
    v_mov_b32 v119, v112
    v_mov_b32 v120, v112
    v_mov_b32 v121, v112
    v_mov_b32 v122, v112
    v_mov_b32 v123, v112
    v_mov_b32 v124, v112
    v_mov_b32 v125, v112
    v_mov_b32 v126, v112
    v_mov_b32 v127, v112
    v_sub_f32 v128, 0, v6
    v_mov_b32 v129, v128
    v_mov_b32 v130, v128
    v_mov_b32 v131, v128
    v_mov_b32 v132, v128
    v_mov_b32 v133, v128
    v_mov_b32 v134, v128
    v_mov_b32 v135, v128
    v_mov_b32 v136, v128
    v_mov_b32 v137, v128
    v_mov_b32 v138, v128
    v_mov_b32 v139, v128
    v_mov_b32 v140, v128
    v_mov_b32 v141, v128
    v_mov_b32 v142, v128
    v_mov_b32 v143, v128
    v_mov_b32 v80, 0
    v_mov_b32 v96, 0
    v_mov_b32 v81, 0
    v_mov_b32 v97, 0
    v_mov_b32 v82, 0
    v_mov_b32 v98, 0
    v_mov_b32 v83, 0
    v_mov_b32 v99, 0
    v_mov_b32 v84, 0
    v_mov_b32 v100, 0
    v_mov_b32 v85, 0
    v_mov_b32 v101, 0
    v_mov_b32 v86, 0
    v_mov_b32 v102, 0
    v_mov_b32 v87, 0
    v_mov_b32 v103, 0
    v_mov_b32 v88, 0
    v_mov_b32 v104, 0
    v_mov_b32 v89, 0
    v_mov_b32 v105, 0
    v_mov_b32 v90, 0
    v_mov_b32 v106, 0
    v_mov_b32 v91, 0
    v_mov_b32 v107, 0
    v_mov_b32 v92, 0
    v_mov_b32 v108, 0
    v_mov_b32 v93, 0
    v_mov_b32 v109, 0
    v_mov_b32 v94, 0
    v_mov_b32 v110, 0
    v_mov_b32 v95, 0
    v_mov_b32 v111, 0
    v_mov_b32 v72, 0
    v_mov_b32 v73, 0
    v_mov_b32 v74, 0
    v_mov_b32 v75, 0
    v_mov_b32 v76, 0
    v_mov_b32 v77, 0
    v_mov_b32 v78, 0
    v_mov_b32 v79, 0
    ds_read_b128 v[144:147], v2 offset:0
    ds_read_b64 v[148:149], v3 offset:0
    s_mov_b64 exec, s[60:61]
    ds_read_b128 v[152:155], v4 offset:0
    ds_read_b128 v[156:159], v4 offset:640
    s_mov_b64 exec, -1
    s_waitcnt lgkmcnt(0)
    v_mfma_f32_32x32x16_bf16 v[32:47], v[144:147], v[208:211], v[112:127]
    v_mfma_f32_32x32x8_bf16 v[32:47], v[148:149], v[216:217], v[32:47]
    s_nop 15
    s_mov_b32 s51, 1
    s_mov_b32 s52, 5120
    s_mov_b32 s55, 0
L_att_7:
    v_mfma_f32_32x32x16_bf16 v[48:63], v[144:147], v[212:215], v[128:143]
    ds_read_b128 v[144:147], v2 offset:1280
    v_exp_f32 v32, v32
    v_exp_f32 v33, v33
    v_exp_f32 v34, v34
    v_exp_f32 v35, v35
    v_mfma_f32_32x32x8_bf16 v[48:63], v[148:149], v[218:219], v[48:63]
    ds_read_b64 v[148:149], v3 offset:1280
    v_exp_f32 v36, v36
    v_exp_f32 v37, v37
    v_exp_f32 v38, v38
    v_exp_f32 v39, v39
    v_cvt_pk_bf16_f32 v64, v32, v33
    v_cvt_pk_bf16_f32 v65, v34, v35
    v_mfma_f32_32x32x16_bf16 v[96:111], v[152:155], v[72:75], v[96:111]
    v_exp_f32 v40, v40
    v_exp_f32 v41, v41
    v_exp_f32 v42, v42
    v_exp_f32 v43, v43
    v_cvt_pk_bf16_f32 v66, v36, v37
    v_cvt_pk_bf16_f32 v67, v38, v39
    v_mfma_f32_32x32x16_bf16 v[96:111], v[156:159], v[76:79], v[96:111]
    s_mov_b64 exec, s[60:61]
    ds_read_b128 v[152:155], v4 offset:0
    ds_read_b128 v[156:159], v4 offset:640
    s_mov_b64 exec, -1
    v_exp_f32 v44, v44
    v_exp_f32 v45, v45
    v_exp_f32 v46, v46
    v_exp_f32 v47, v47
    v_cvt_pk_bf16_f32 v68, v40, v41
    v_cvt_pk_bf16_f32 v69, v42, v43
    v_cvt_pk_bf16_f32 v70, v44, v45
    v_cvt_pk_bf16_f32 v71, v46, v47
    s_waitcnt lgkmcnt(2)
    v_mfma_f32_32x32x16_bf16 v[32:47], v[144:147], v[208:211], v[112:127]
    v_exp_f32 v48, v48
    v_exp_f32 v49, v49
    v_exp_f32 v50, v50
    v_exp_f32 v51, v51
    v_mfma_f32_32x32x8_bf16 v[32:47], v[148:149], v[216:217], v[32:47]
    v_exp_f32 v52, v52
    v_exp_f32 v53, v53
    v_exp_f32 v54, v54
    v_exp_f32 v55, v55
    v_cvt_pk_bf16_f32 v72, v48, v49
    v_cvt_pk_bf16_f32 v73, v50, v51
    s_waitcnt lgkmcnt(0)
    v_mfma_f32_32x32x16_bf16 v[80:95], v[152:155], v[64:67], v[80:95]
    v_exp_f32 v56, v56
    v_exp_f32 v57, v57
    v_exp_f32 v58, v58
    v_exp_f32 v59, v59
    v_cvt_pk_bf16_f32 v74, v52, v53
    v_cvt_pk_bf16_f32 v75, v54, v55
    v_mfma_f32_32x32x16_bf16 v[80:95], v[156:159], v[68:71], v[80:95]
    v_exp_f32 v60, v60
    v_exp_f32 v61, v61
    v_exp_f32 v62, v62
    v_exp_f32 v63, v63
    v_cvt_pk_bf16_f32 v76, v56, v57
    v_cvt_pk_bf16_f32 v77, v58, v59
    v_cvt_pk_bf16_f32 v78, v60, v61
    v_cvt_pk_bf16_f32 v79, v62, v63
    v_mfma_f32_32x32x16_bf16 v[48:63], v[144:147], v[212:215], v[128:143]
    ds_read_b128 v[144:147], v2 offset:2560
    v_exp_f32 v32, v32
    v_exp_f32 v33, v33
    v_exp_f32 v34, v34
    v_exp_f32 v35, v35
    v_mfma_f32_32x32x8_bf16 v[48:63], v[148:149], v[218:219], v[48:63]
    ds_read_b64 v[148:149], v3 offset:2560
    v_exp_f32 v36, v36
    v_exp_f32 v37, v37
    v_exp_f32 v38, v38
    v_exp_f32 v39, v39
    v_cvt_pk_bf16_f32 v64, v32, v33
    v_cvt_pk_bf16_f32 v65, v34, v35
    v_mfma_f32_32x32x16_bf16 v[96:111], v[152:155], v[72:75], v[96:111]
    v_exp_f32 v40, v40
    v_exp_f32 v41, v41
    v_exp_f32 v42, v42
    v_exp_f32 v43, v43
    v_cvt_pk_bf16_f32 v66, v36, v37
    v_cvt_pk_bf16_f32 v67, v38, v39
    v_mfma_f32_32x32x16_bf16 v[96:111], v[156:159], v[76:79], v[96:111]
    s_mov_b64 exec, s[60:61]
    ds_read_b128 v[152:155], v4 offset:1280
    ds_read_b128 v[156:159], v4 offset:1920
    s_mov_b64 exec, -1
    v_exp_f32 v44, v44
    v_exp_f32 v45, v45
    v_exp_f32 v46, v46
    v_exp_f32 v47, v47
    v_cvt_pk_bf16_f32 v68, v40, v41
    v_cvt_pk_bf16_f32 v69, v42, v43
    v_cvt_pk_bf16_f32 v70, v44, v45
    v_cvt_pk_bf16_f32 v71, v46, v47
    s_waitcnt lgkmcnt(2)
    v_mfma_f32_32x32x16_bf16 v[32:47], v[144:147], v[208:211], v[112:127]
    v_exp_f32 v48, v48
    v_exp_f32 v49, v49
    v_exp_f32 v50, v50
    v_exp_f32 v51, v51
    v_mfma_f32_32x32x8_bf16 v[32:47], v[148:149], v[216:217], v[32:47]
    v_exp_f32 v52, v52
    v_exp_f32 v53, v53
    v_exp_f32 v54, v54
    v_exp_f32 v55, v55
    v_cvt_pk_bf16_f32 v72, v48, v49
    v_cvt_pk_bf16_f32 v73, v50, v51
    s_waitcnt lgkmcnt(0)
    v_mfma_f32_32x32x16_bf16 v[80:95], v[152:155], v[64:67], v[80:95]
    v_exp_f32 v56, v56
    v_exp_f32 v57, v57
    v_exp_f32 v58, v58
    v_exp_f32 v59, v59
    v_cvt_pk_bf16_f32 v74, v52, v53
    v_cvt_pk_bf16_f32 v75, v54, v55
    v_mfma_f32_32x32x16_bf16 v[80:95], v[156:159], v[68:71], v[80:95]
    v_exp_f32 v60, v60
    v_exp_f32 v61, v61
    v_exp_f32 v62, v62
    v_exp_f32 v63, v63
    v_cvt_pk_bf16_f32 v76, v56, v57
    v_cvt_pk_bf16_f32 v77, v58, v59
    v_cvt_pk_bf16_f32 v78, v60, v61
    v_cvt_pk_bf16_f32 v79, v62, v63
    v_mfma_f32_32x32x16_bf16 v[48:63], v[144:147], v[212:215], v[128:143]
    ds_read_b128 v[144:147], v2 offset:3840
    v_exp_f32 v32, v32
    v_exp_f32 v33, v33
    v_exp_f32 v34, v34
    v_exp_f32 v35, v35
    v_mfma_f32_32x32x8_bf16 v[48:63], v[148:149], v[218:219], v[48:63]
    ds_read_b64 v[148:149], v3 offset:3840
    v_exp_f32 v36, v36
    v_exp_f32 v37, v37
    v_exp_f32 v38, v38
    v_exp_f32 v39, v39
    v_cvt_pk_bf16_f32 v64, v32, v33
    v_cvt_pk_bf16_f32 v65, v34, v35
    v_mfma_f32_32x32x16_bf16 v[96:111], v[152:155], v[72:75], v[96:111]
    v_exp_f32 v40, v40
    v_exp_f32 v41, v41
    v_exp_f32 v42, v42
    v_exp_f32 v43, v43
    v_cvt_pk_bf16_f32 v66, v36, v37
    v_cvt_pk_bf16_f32 v67, v38, v39
    v_mfma_f32_32x32x16_bf16 v[96:111], v[156:159], v[76:79], v[96:111]
    s_mov_b64 exec, s[60:61]
    ds_read_b128 v[152:155], v4 offset:2560
    ds_read_b128 v[156:159], v4 offset:3200
    s_mov_b64 exec, -1
    v_exp_f32 v44, v44
    v_exp_f32 v45, v45
    v_exp_f32 v46, v46
    v_exp_f32 v47, v47
    v_cvt_pk_bf16_f32 v68, v40, v41
    v_cvt_pk_bf16_f32 v69, v42, v43
    v_cvt_pk_bf16_f32 v70, v44, v45
    v_cvt_pk_bf16_f32 v71, v46, v47
    s_waitcnt lgkmcnt(2)
    v_mfma_f32_32x32x16_bf16 v[32:47], v[144:147], v[208:211], v[112:127]
    v_exp_f32 v48, v48
    v_exp_f32 v49, v49
    v_exp_f32 v50, v50
    v_exp_f32 v51, v51
    v_mfma_f32_32x32x8_bf16 v[32:47], v[148:149], v[216:217], v[32:47]
    v_exp_f32 v52, v52
    v_exp_f32 v53, v53
    v_exp_f32 v54, v54
    v_exp_f32 v55, v55
    v_cvt_pk_bf16_f32 v72, v48, v49
    v_cvt_pk_bf16_f32 v73, v50, v51
    s_waitcnt lgkmcnt(0)
    v_mfma_f32_32x32x16_bf16 v[80:95], v[152:155], v[64:67], v[80:95]
    v_exp_f32 v56, v56
    v_exp_f32 v57, v57
    v_exp_f32 v58, v58
    v_exp_f32 v59, v59
    v_cvt_pk_bf16_f32 v74, v52, v53
    v_cvt_pk_bf16_f32 v75, v54, v55
    v_mfma_f32_32x32x16_bf16 v[80:95], v[156:159], v[68:71], v[80:95]
    v_exp_f32 v60, v60
    v_exp_f32 v61, v61
    v_exp_f32 v62, v62
    v_exp_f32 v63, v63
    v_cvt_pk_bf16_f32 v76, v56, v57
    v_cvt_pk_bf16_f32 v77, v58, v59
    v_cvt_pk_bf16_f32 v78, v60, v61
    v_cvt_pk_bf16_f32 v79, v62, v63
    v_mfma_f32_32x32x16_bf16 v[48:63], v[144:147], v[212:215], v[128:143]
    v_add_u32 v2, s52, v2
    ds_read_b128 v[144:147], v2 offset:0
    v_exp_f32 v32, v32
    v_exp_f32 v33, v33
    v_exp_f32 v34, v34
    v_exp_f32 v35, v35
    v_mfma_f32_32x32x8_bf16 v[48:63], v[148:149], v[218:219], v[48:63]
    v_add_u32 v3, s52, v3
    ds_read_b64 v[148:149], v3 offset:0
    v_exp_f32 v36, v36
    v_exp_f32 v37, v37
    v_exp_f32 v38, v38
    v_exp_f32 v39, v39
    v_cvt_pk_bf16_f32 v64, v32, v33
    v_cvt_pk_bf16_f32 v65, v34, v35
    v_mfma_f32_32x32x16_bf16 v[96:111], v[152:155], v[72:75], v[96:111]
    v_exp_f32 v40, v40
    v_exp_f32 v41, v41
    v_exp_f32 v42, v42
    v_exp_f32 v43, v43
    v_cvt_pk_bf16_f32 v66, v36, v37
    v_cvt_pk_bf16_f32 v67, v38, v39
    v_mfma_f32_32x32x16_bf16 v[96:111], v[156:159], v[76:79], v[96:111]
    s_mov_b64 exec, s[60:61]
    ds_read_b128 v[152:155], v4 offset:3840
    ds_read_b128 v[156:159], v4 offset:4480
    s_mov_b64 exec, -1
    v_add_u32 v4, s52, v4
    v_exp_f32 v44, v44
    v_exp_f32 v45, v45
    v_exp_f32 v46, v46
    v_exp_f32 v47, v47
    v_cvt_pk_bf16_f32 v68, v40, v41
    v_cvt_pk_bf16_f32 v69, v42, v43
    v_cvt_pk_bf16_f32 v70, v44, v45
    v_cvt_pk_bf16_f32 v71, v46, v47
    s_waitcnt lgkmcnt(2)
    v_mfma_f32_32x32x16_bf16 v[32:47], v[144:147], v[208:211], v[112:127]
    v_exp_f32 v48, v48
    v_exp_f32 v49, v49
    v_exp_f32 v50, v50
    v_exp_f32 v51, v51
    v_mfma_f32_32x32x8_bf16 v[32:47], v[148:149], v[216:217], v[32:47]
    s_sub_u32 s51, s51, 1
    v_exp_f32 v52, v52
    v_exp_f32 v53, v53
    v_exp_f32 v54, v54
    v_exp_f32 v55, v55
    v_cvt_pk_bf16_f32 v72, v48, v49
    v_cvt_pk_bf16_f32 v73, v50, v51
    s_waitcnt lgkmcnt(0)
    v_mfma_f32_32x32x16_bf16 v[80:95], v[152:155], v[64:67], v[80:95]
    v_exp_f32 v56, v56
    v_exp_f32 v57, v57
    v_exp_f32 v58, v58
    v_exp_f32 v59, v59
    v_cvt_pk_bf16_f32 v74, v52, v53
    v_cvt_pk_bf16_f32 v75, v54, v55
    v_mfma_f32_32x32x16_bf16 v[80:95], v[156:159], v[68:71], v[80:95]
    s_cmp_lg_u32 s51, 0
    v_exp_f32 v60, v60
    v_exp_f32 v61, v61
    v_exp_f32 v62, v62
    v_exp_f32 v63, v63
    v_cvt_pk_bf16_f32 v76, v56, v57
    v_cvt_pk_bf16_f32 v77, v58, v59
    v_cvt_pk_bf16_f32 v78, v60, v61
    v_cvt_pk_bf16_f32 v79, v62, v63
    s_cbranch_scc1 L_att_7
    s_add_u32 s55, s55, 1
    s_cmp_eq_u32 s55, 1
    s_cbranch_scc0 L_sg_9
    s_cmp_eq_u32 s50, 0
    s_cbranch_scc0 L_nobar_10
    s_waitcnt vmcnt(0)
    s_barrier
L_nobar_10:
    s_mov_b32 s51, 2
    s_mov_b32 s52, 5120
    s_branch L_att_7
L_sg_9:
    s_cmp_eq_u32 s55, 2
    s_cbranch_scc0 L_sg_11
    s_cmp_eq_u32 s50, 0
    s_cbranch_scc0 L_nobar_12
    s_barrier
L_nobar_12:
    s_mov_b32 s51, 4
    s_mov_b32 s52, 5120
    s_branch L_att_7
L_sg_11:
    s_cmp_eq_u32 s55, 3
    s_cbranch_scc0 L_sg_13
    s_mov_b32 s51, 1
    s_mov_b32 s52, 4294849536
    s_branch L_att_7
L_sg_13:
    s_cmp_eq_u32 s55, 4
    s_cbranch_scc0 L_sg_14
    s_mov_b32 s51, 8
    s_mov_b32 s52, 5120
    s_branch L_att_7
L_sg_14:
    s_nop 1
    v_mfma_f32_32x32x16_bf16 v[96:111], v[152:155], v[72:75], v[96:111]
    v_mfma_f32_32x32x16_bf16 v[96:111], v[156:159], v[76:79], v[96:111]
    s_waitcnt lgkmcnt(0)
    v_lshlrev_b32 v2, 4, v1
    v_add_u32 v2, 81920, v2
    v_and_b32 v7, 31, v1
    v_lshlrev_b32 v3, 3, v7
    v_add_u32 v3, 82944, v3
    v_lshrrev_b32 v8, 5, v1
    v_mul_u32_u24 v4, 320, v8
    v_lshl_add_u32 v4, v7, 4, v4
    v_add_u32 v4, 122880, v4
    s_nop 15
    s_nop 3
    v_mov_b32 v7, 0
    v_fma_f32 v7, v80, 0, v7
    v_fma_f32 v7, v81, 0, v7
    v_fma_f32 v7, v82, 0, v7
    v_fma_f32 v7, v83, 0, v7
    v_fma_f32 v7, v84, 0, v7
    v_fma_f32 v7, v85, 0, v7
    v_fma_f32 v7, v86, 0, v7
    v_fma_f32 v7, v87, 0, v7
    v_fma_f32 v7, v88, 0, v7
    v_fma_f32 v7, v89, 0, v7
    v_fma_f32 v7, v90, 0, v7
    v_fma_f32 v7, v91, 0, v7
    v_fma_f32 v7, v96, 0, v7
    v_fma_f32 v7, v97, 0, v7
    v_fma_f32 v7, v98, 0, v7
    v_fma_f32 v7, v99, 0, v7
    v_fma_f32 v7, v100, 0, v7
    v_fma_f32 v7, v101, 0, v7
    v_fma_f32 v7, v102, 0, v7
    v_fma_f32 v7, v103, 0, v7
    v_fma_f32 v7, v104, 0, v7
    v_fma_f32 v7, v105, 0, v7
    v_fma_f32 v7, v106, 0, v7
    v_fma_f32 v7, v107, 0, v7
    v_cmp_u_f32 vcc, v7, v7
    s_cmp_lg_u32 s50, 0
    s_cbranch_scc1 L_ok_15
    s_nop 3
    s_cmp_eq_u64 vcc, 0
    s_cbranch_scc1 L_ok_15
    s_mov_b32 s50, 1
    v_mov_b32 v5, 0xff800000
    v_mov_b32 v6, 0xff800000
    s_mov_b32 s51, 0
L_fb_16:
    ds_read_b128 v[144:147], v2 offset:0
    ds_read_b64 v[148:149], v3 offset:0
    s_waitcnt lgkmcnt(0)
    v_mfma_f32_32x32x16_bf16 v[32:47], v[144:147], v[208:211], 0
    v_mfma_f32_32x32x8_bf16 v[32:47], v[148:149], v[216:217], v[32:47]
    v_mfma_f32_32x32x16_bf16 v[48:63], v[144:147], v[212:215], 0
    v_mfma_f32_32x32x8_bf16 v[48:63], v[148:149], v[218:219], v[48:63]
    s_nop 15
    s_nop 3
    v_max3_f32 v5, v5, v32, v33
    v_max3_f32 v5, v5, v34, v35
    v_max3_f32 v5, v5, v36, v37
    v_max3_f32 v5, v5, v38, v39
    v_max3_f32 v5, v5, v40, v41
    v_max3_f32 v5, v5, v42, v43
    v_max3_f32 v5, v5, v44, v45
    v_max3_f32 v5, v5, v46, v47
    v_max3_f32 v6, v6, v48, v49
    v_max3_f32 v6, v6, v50, v51
    v_max3_f32 v6, v6, v52, v53
    v_max3_f32 v6, v6, v54, v55
    v_max3_f32 v6, v6, v56, v57
    v_max3_f32 v6, v6, v58, v59
    v_max3_f32 v6, v6, v60, v61
    v_max3_f32 v6, v6, v62, v63
    s_cmp_eq_u32 s51, 31
    s_mov_b32 s52, 4294845696
    s_cselect_b32 s52, s52, 1280
    v_add_u32 v2, s52, v2
    v_add_u32 v3, s52, v3
    s_add_u32 s51, s51, 1
    s_cmp_lg_u32 s51, 64
    s_cbranch_scc1 L_fb_16
    v_lshlrev_b32 v2, 4, v1
    v_add_u32 v2, 81920, v2
    v_and_b32 v7, 31, v1
    v_lshlrev_b32 v3, 3, v7
    v_add_u32 v3, 82944, v3
    v_lshrrev_b32 v8, 5, v1
    v_mul_u32_u24 v4, 320, v8
    v_lshl_add_u32 v4, v7, 4, v4
    v_add_u32 v4, 122880, v4
    v_mov_b32 v7, v5
    s_nop 1
    v_permlane32_swap_b32 v7, v5
    s_nop 1
    v_max_f32 v5, v5, v7
    v_mov_b32 v7, v6
    s_nop 1
    v_permlane32_swap_b32 v7, v6
    s_nop 1
    v_max_f32 v6, v6, v7
    s_branch L_main_6
L_ok_15:
    v_mov_b32 v9, v88
    v_mov_b32 v10, v88
    s_nop 1
    v_permlane32_swap_b32 v9, v10
    s_nop 1
    v_rcp_f32 v10, v10
    s_nop 0
    v_mul_f32 v80, v80, v10
    v_mul_f32 v81, v81, v10
    v_mul_f32 v82, v82, v10
    v_mul_f32 v83, v83, v10
    v_mul_f32 v84, v84, v10
    v_mul_f32 v85, v85, v10
    v_mul_f32 v86, v86, v10
    v_mul_f32 v87, v87, v10
    v_mul_f32 v88, v88, v10
    v_mul_f32 v89, v89, v10
    v_mul_f32 v90, v90, v10
    v_mul_f32 v91, v91, v10
    v_cvt_pk_bf16_f32 v32, v80, v81
    v_cvt_pk_bf16_f32 v33, v82, v83
    v_cvt_pk_bf16_f32 v34, v84, v85
    v_cvt_pk_bf16_f32 v35, v86, v87
    v_cvt_pk_bf16_f32 v36, v88, v89
    v_cvt_pk_bf16_f32 v37, v90, v91
    buffer_store_dwordx2 v[32:33], v244, s[24:27], s70 offen sc1
    buffer_store_dwordx2 v[34:35], v245, s[24:27], s70 offen sc1
    buffer_store_dwordx2 v[36:37], v246, s[24:27], s70 offen sc1
    v_mov_b32 v9, v104
    v_mov_b32 v10, v104
    s_nop 1
    v_permlane32_swap_b32 v9, v10
    s_nop 1
    v_rcp_f32 v10, v10
    s_nop 0
    v_mul_f32 v96, v96, v10
    v_mul_f32 v97, v97, v10
    v_mul_f32 v98, v98, v10
    v_mul_f32 v99, v99, v10
    v_mul_f32 v100, v100, v10
    v_mul_f32 v101, v101, v10
    v_mul_f32 v102, v102, v10
    v_mul_f32 v103, v103, v10
    v_mul_f32 v104, v104, v10
    v_mul_f32 v105, v105, v10
    v_mul_f32 v106, v106, v10
    v_mul_f32 v107, v107, v10
    v_cvt_pk_bf16_f32 v40, v96, v97
    v_cvt_pk_bf16_f32 v41, v98, v99
    v_cvt_pk_bf16_f32 v42, v100, v101
    v_cvt_pk_bf16_f32 v43, v102, v103
    v_cvt_pk_bf16_f32 v44, v104, v105
    v_cvt_pk_bf16_f32 v45, v106, v107
    buffer_store_dwordx2 v[40:41], v244, s[24:27], s71 offen sc1
    buffer_store_dwordx2 v[42:43], v245, s[24:27], s71 offen sc1
    buffer_store_dwordx2 v[44:45], v246, s[24:27], s71 offen sc1
    s_waitcnt vmcnt(0)
    s_lshl_b32 s58, s36, 6
    s_lshl_b32 s59, s37, 2
    s_add_u32 s58, s58, s59
    s_add_u32 s58, s58, s38
    s_lshl_b32 s58, s58, 2
    s_add_u32 s58, s58, 11894784
    v_mov_b32 v252, 0
    v_mov_b32 v253, s76
    s_mov_b64 exec, 1
    buffer_store_dword v253, v252, s[24:27], s58 offen sc1
    s_mov_b64 exec, -1
    s_barrier
    v_lshlrev_b32 v2, 4, v1
    s_and_b32 s42, s38, 3
    s_lshl_b32 s49, s36, 2
    s_add_u32 s49, s49, s42
    s_mul_i32 s49, s49, 20
    s_lshl_b32 s49, s49, 10
    s_add_u32 s49, s49, 9240576
    s_mul_i32 s39, s37, 348160
    s_add_u32 s39, s39, 6455296
    s_lshl_b32 s40, s38, 10
    s_add_u32 s39, s39, s40
    s_add_u32 m0, s40, 0
    s_add_u32 s41, s39, 0
    buffer_load_dwordx4 v2, s[24:27], s41 offen sc1 lds
    s_add_u32 m0, s40, 4096
    s_add_u32 s41, s39, 4096
    buffer_load_dwordx4 v2, s[24:27], s41 offen sc1 lds
    s_add_u32 m0, s40, 8192
    s_add_u32 s41, s39, 8192
    buffer_load_dwordx4 v2, s[24:27], s41 offen sc1 lds
    s_add_u32 m0, s40, 12288
    s_add_u32 s41, s39, 12288
    buffer_load_dwordx4 v2, s[24:27], s41 offen sc1 lds
    s_add_u32 m0, s40, 16384
    s_add_u32 s41, s39, 16384
    buffer_load_dwordx4 v2, s[24:27], s41 offen sc1 lds
    s_add_u32 m0, s40, 20480
    s_add_u32 s41, s39, 20480
    buffer_load_dwordx4 v2, s[24:27], s41 offen sc1 lds
    s_add_u32 m0, s40, 24576
    s_add_u32 s41, s39, 24576
    buffer_load_dwordx4 v2, s[24:27], s41 offen sc1 lds
    s_add_u32 m0, s40, 28672
    s_add_u32 s41, s39, 28672
    buffer_load_dwordx4 v2, s[24:27], s41 offen sc1 lds
    s_add_u32 m0, s40, 32768
    s_add_u32 s41, s39, 32768
    buffer_load_dwordx4 v2, s[24:27], s41 offen sc1 lds
    s_add_u32 m0, s40, 36864
    s_add_u32 s41, s39, 36864
    buffer_load_dwordx4 v2, s[24:27], s41 offen sc1 lds
    s_add_u32 m0, s40, 40960
    s_add_u32 s41, s39, 40960
    buffer_load_dwordx4 v2, s[24:27], s41 offen sc1 lds
    s_add_u32 m0, s40, 45056
    s_add_u32 s41, s39, 45056
    buffer_load_dwordx4 v2, s[24:27], s41 offen sc1 lds
    s_add_u32 m0, s40, 49152
    s_add_u32 s41, s39, 49152
    buffer_load_dwordx4 v2, s[24:27], s41 offen sc1 lds
    s_add_u32 m0, s40, 53248
    s_add_u32 s41, s39, 53248
    buffer_load_dwordx4 v2, s[24:27], s41 offen sc1 lds
    s_add_u32 m0, s40, 57344
    s_add_u32 s41, s39, 57344
    buffer_load_dwordx4 v2, s[24:27], s41 offen sc1 lds
    s_add_u32 m0, s40, 61440
    s_add_u32 s41, s39, 61440
    buffer_load_dwordx4 v2, s[24:27], s41 offen sc1 lds
    s_add_u32 m0, s40, 65536
    s_add_u32 s41, s39, 65536
    buffer_load_dwordx4 v2, s[24:27], s41 offen sc1 lds
    s_add_u32 m0, s40, 69632
    s_add_u32 s41, s39, 69632
    buffer_load_dwordx4 v2, s[24:27], s41 offen sc1 lds
    s_add_u32 m0, s40, 73728
    s_add_u32 s41, s39, 73728
    buffer_load_dwordx4 v2, s[24:27], s41 offen sc1 lds
    s_add_u32 m0, s40, 77824
    s_add_u32 s41, s39, 77824
    buffer_load_dwordx4 v2, s[24:27], s41 offen sc1 lds
    s_add_u32 m0, s40, 81920
    s_add_u32 s41, s39, 81920
    buffer_load_dwordx4 v2, s[24:27], s41 offen sc1 lds
    s_add_u32 m0, s40, 86016
    s_add_u32 s41, s39, 86016
    buffer_load_dwordx4 v2, s[24:27], s41 offen sc1 lds
    s_add_u32 m0, s40, 90112
    s_add_u32 s41, s39, 90112
    buffer_load_dwordx4 v2, s[24:27], s41 offen sc1 lds
    s_add_u32 m0, s40, 94208
    s_add_u32 s41, s39, 94208
    buffer_load_dwordx4 v2, s[24:27], s41 offen sc1 lds
    s_add_u32 m0, s40, 98304
    s_add_u32 s41, s39, 98304
    buffer_load_dwordx4 v2, s[24:27], s41 offen sc1 lds
    v_mov_b32 v112, 0
    v_mov_b32 v113, 0
    v_mov_b32 v114, 0
    v_mov_b32 v115, 0
    v_mov_b32 v116, 0
    v_mov_b32 v117, 0
    v_mov_b32 v118, 0
    v_mov_b32 v119, 0
    v_mov_b32 v120, 0
    v_mov_b32 v121, 0
    v_mov_b32 v122, 0
    v_mov_b32 v123, 0
    v_mov_b32 v124, 0
    v_mov_b32 v125, 0
    v_mov_b32 v126, 0
    v_mov_b32 v127, 0
    v_mov_b32 v128, 0
    v_mov_b32 v129, 0
    v_mov_b32 v130, 0
    v_mov_b32 v131, 0
    s_barrier
    s_cmp_eq_u32 s38, 0
    s_cbranch_scc0 L_nopoll_17
    s_mov_b32 s59, 0
L_poll_18:
    s_lshl_b32 s39, s36, 8
    s_add_u32 s39, s39, 11894784
    v_and_b32 v252, 31, v1
    v_lshlrev_b32 v252, 2, v252
    v_add_u32 v252, s39, v252
    buffer_load_dword v253, v252, s[24:27], 0 offen sc1
    s_waitcnt vmcnt(0)
    v_xor_b32 v253, s76, v253
    v_cmp_ne_u32 vcc, 0, v253
    s_add_u32 s59, s59, 1
    s_nop 3
    s_cmp_eq_u64 vcc, 0
    s_cbranch_scc1 L_pollok_19
    s_cmp_gt_u32 s59, 20000
    s_cbranch_scc1 L_pollok_19
    s_sleep 4
    s_branch L_poll_18
L_pollok_19:
L_nopoll_17:
    s_waitcnt vmcnt(0)
    v_add_u32 v12, 0, v2
    s_barrier
    s_mov_b32 s41, s49
    buffer_load_dwordx4 v[132:135], v2, s[24:27], s41 offen offset:0 sc1
    buffer_load_dwordx4 v[136:139], v2, s[24:27], s41 offen offset:1024 sc1
    buffer_load_dwordx4 v[140:143], v2, s[24:27], s41 offen offset:2048 sc1
    buffer_load_dwordx4 v[144:147], v2, s[24:27], s41 offen offset:3072 sc1
    s_add_u32 s41, s41, 4096
    buffer_load_dwordx4 v[148:151], v2, s[24:27], s41 offen offset:0 sc1
    buffer_load_dwordx4 v[152:155], v2, s[24:27], s41 offen offset:1024 sc1
    buffer_load_dwordx4 v[156:159], v2, s[24:27], s41 offen offset:2048 sc1
    buffer_load_dwordx4 v[160:163], v2, s[24:27], s41 offen offset:3072 sc1
    s_add_u32 s41, s41, 4096
    buffer_load_dwordx4 v[164:167], v2, s[24:27], s41 offen offset:0 sc1
    buffer_load_dwordx4 v[168:171], v2, s[24:27], s41 offen offset:1024 sc1
    ds_read_b128 v[172:175], v12 offset:0
    ds_read_b128 v[176:179], v12 offset:1024
    ds_read_b128 v[180:183], v12 offset:2048
    ds_read_b128 v[184:187], v12 offset:3072
    ds_read_b128 v[188:191], v12 offset:4096
    ds_read_b128 v[192:195], v12 offset:5120
    ds_read_b128 v[196:199], v12 offset:6144
    ds_read_b128 v[200:203], v12 offset:7168
    ds_read_b128 v[204:207], v12 offset:8192
    ds_read_b128 v[208:211], v12 offset:9216
    s_waitcnt vmcnt(9) lgkmcnt(5)
    v_mfma_f32_16x16x32_bf16 v[112:115], v[172:175], v[132:135], v[112:115]
    v_mfma_f32_16x16x32_bf16 v[116:119], v[176:179], v[132:135], v[116:119]
    v_mfma_f32_16x16x32_bf16 v[120:123], v[180:183], v[132:135], v[120:123]
    v_mfma_f32_16x16x32_bf16 v[124:127], v[184:187], v[132:135], v[124:127]
    v_mfma_f32_16x16x32_bf16 v[128:131], v[188:191], v[132:135], v[128:131]
    ds_read_b128 v[172:175], v12 offset:10240
    ds_read_b128 v[176:179], v12 offset:11264
    ds_read_b128 v[180:183], v12 offset:12288
    ds_read_b128 v[184:187], v12 offset:13312
    ds_read_b128 v[188:191], v12 offset:14336
    s_waitcnt vmcnt(8) lgkmcnt(5)
    v_mfma_f32_16x16x32_bf16 v[112:115], v[192:195], v[136:139], v[112:115]
    v_mfma_f32_16x16x32_bf16 v[116:119], v[196:199], v[136:139], v[116:119]
    v_mfma_f32_16x16x32_bf16 v[120:123], v[200:203], v[136:139], v[120:123]
    v_mfma_f32_16x16x32_bf16 v[124:127], v[204:207], v[136:139], v[124:127]
    v_mfma_f32_16x16x32_bf16 v[128:131], v[208:211], v[136:139], v[128:131]
    ds_read_b128 v[192:195], v12 offset:15360
    ds_read_b128 v[196:199], v12 offset:16384
    ds_read_b128 v[200:203], v12 offset:17408
    ds_read_b128 v[204:207], v12 offset:18432
    ds_read_b128 v[208:211], v12 offset:19456
    s_waitcnt vmcnt(7) lgkmcnt(5)
    v_mfma_f32_16x16x32_bf16 v[112:115], v[172:175], v[140:143], v[112:115]
    v_mfma_f32_16x16x32_bf16 v[116:119], v[176:179], v[140:143], v[116:119]
    v_mfma_f32_16x16x32_bf16 v[120:123], v[180:183], v[140:143], v[120:123]
    v_mfma_f32_16x16x32_bf16 v[124:127], v[184:187], v[140:143], v[124:127]
    v_mfma_f32_16x16x32_bf16 v[128:131], v[188:191], v[140:143], v[128:131]
    ds_read_b128 v[172:175], v12 offset:20480
    ds_read_b128 v[176:179], v12 offset:21504
    ds_read_b128 v[180:183], v12 offset:22528
    ds_read_b128 v[184:187], v12 offset:23552
    ds_read_b128 v[188:191], v12 offset:24576
    s_waitcnt vmcnt(6) lgkmcnt(5)
    v_mfma_f32_16x16x32_bf16 v[112:115], v[192:195], v[144:147], v[112:115]
    v_mfma_f32_16x16x32_bf16 v[116:119], v[196:199], v[144:147], v[116:119]
    v_mfma_f32_16x16x32_bf16 v[120:123], v[200:203], v[144:147], v[120:123]
    v_mfma_f32_16x16x32_bf16 v[124:127], v[204:207], v[144:147], v[124:127]
    v_mfma_f32_16x16x32_bf16 v[128:131], v[208:211], v[144:147], v[128:131]
    ds_read_b128 v[192:195], v12 offset:25600
    ds_read_b128 v[196:199], v12 offset:26624
    ds_read_b128 v[200:203], v12 offset:27648
    ds_read_b128 v[204:207], v12 offset:28672
    ds_read_b128 v[208:211], v12 offset:29696
    s_waitcnt vmcnt(5) lgkmcnt(5)
    v_mfma_f32_16x16x32_bf16 v[112:115], v[172:175], v[148:151], v[112:115]
    v_mfma_f32_16x16x32_bf16 v[116:119], v[176:179], v[148:151], v[116:119]
    v_mfma_f32_16x16x32_bf16 v[120:123], v[180:183], v[148:151], v[120:123]
    v_mfma_f32_16x16x32_bf16 v[124:127], v[184:187], v[148:151], v[124:127]
    v_mfma_f32_16x16x32_bf16 v[128:131], v[188:191], v[148:151], v[128:131]
    ds_read_b128 v[172:175], v12 offset:30720
    ds_read_b128 v[176:179], v12 offset:31744
    ds_read_b128 v[180:183], v12 offset:32768
    ds_read_b128 v[184:187], v12 offset:33792
    ds_read_b128 v[188:191], v12 offset:34816
    s_waitcnt vmcnt(4) lgkmcnt(5)
    v_mfma_f32_16x16x32_bf16 v[112:115], v[192:195], v[152:155], v[112:115]
    v_mfma_f32_16x16x32_bf16 v[116:119], v[196:199], v[152:155], v[116:119]
    v_mfma_f32_16x16x32_bf16 v[120:123], v[200:203], v[152:155], v[120:123]
    v_mfma_f32_16x16x32_bf16 v[124:127], v[204:207], v[152:155], v[124:127]
    v_mfma_f32_16x16x32_bf16 v[128:131], v[208:211], v[152:155], v[128:131]
    ds_read_b128 v[192:195], v12 offset:35840
    ds_read_b128 v[196:199], v12 offset:36864
    ds_read_b128 v[200:203], v12 offset:37888
    ds_read_b128 v[204:207], v12 offset:38912
    ds_read_b128 v[208:211], v12 offset:39936
    s_waitcnt vmcnt(3) lgkmcnt(5)
    v_mfma_f32_16x16x32_bf16 v[112:115], v[172:175], v[156:159], v[112:115]
    v_mfma_f32_16x16x32_bf16 v[116:119], v[176:179], v[156:159], v[116:119]
    v_mfma_f32_16x16x32_bf16 v[120:123], v[180:183], v[156:159], v[120:123]
    v_mfma_f32_16x16x32_bf16 v[124:127], v[184:187], v[156:159], v[124:127]
    v_mfma_f32_16x16x32_bf16 v[128:131], v[188:191], v[156:159], v[128:131]
    ds_read_b128 v[172:175], v12 offset:40960
    ds_read_b128 v[176:179], v12 offset:41984
    ds_read_b128 v[180:183], v12 offset:43008
    ds_read_b128 v[184:187], v12 offset:44032
    ds_read_b128 v[188:191], v12 offset:45056
    s_waitcnt vmcnt(2) lgkmcnt(5)
    v_mfma_f32_16x16x32_bf16 v[112:115], v[192:195], v[160:163], v[112:115]
    v_mfma_f32_16x16x32_bf16 v[116:119], v[196:199], v[160:163], v[116:119]
    v_mfma_f32_16x16x32_bf16 v[120:123], v[200:203], v[160:163], v[120:123]
    v_mfma_f32_16x16x32_bf16 v[124:127], v[204:207], v[160:163], v[124:127]
    v_mfma_f32_16x16x32_bf16 v[128:131], v[208:211], v[160:163], v[128:131]
    ds_read_b128 v[192:195], v12 offset:46080
    ds_read_b128 v[196:199], v12 offset:47104
    ds_read_b128 v[200:203], v12 offset:48128
    ds_read_b128 v[204:207], v12 offset:49152
    ds_read_b128 v[208:211], v12 offset:50176
    s_waitcnt vmcnt(1) lgkmcnt(5)
    v_mfma_f32_16x16x32_bf16 v[112:115], v[172:175], v[164:167], v[112:115]
    v_mfma_f32_16x16x32_bf16 v[116:119], v[176:179], v[164:167], v[116:119]
    v_mfma_f32_16x16x32_bf16 v[120:123], v[180:183], v[164:167], v[120:123]
    v_mfma_f32_16x16x32_bf16 v[124:127], v[184:187], v[164:167], v[124:127]
    v_mfma_f32_16x16x32_bf16 v[128:131], v[188:191], v[164:167], v[128:131]
    s_waitcnt vmcnt(0) lgkmcnt(0)
    v_mfma_f32_16x16x32_bf16 v[112:115], v[192:195], v[168:171], v[112:115]
    v_mfma_f32_16x16x32_bf16 v[116:119], v[196:199], v[168:171], v[116:119]
    v_mfma_f32_16x16x32_bf16 v[120:123], v[200:203], v[168:171], v[120:123]
    v_mfma_f32_16x16x32_bf16 v[124:127], v[204:207], v[168:171], v[124:127]
    v_mfma_f32_16x16x32_bf16 v[128:131], v[208:211], v[168:171], v[128:131]
    s_mul_i32 s40, s42, 5120
    s_add_u32 s40, s40, 102400
    v_add_u32 v90, s40, v2
    s_nop 7
    ds_write_b128 v90, v[112:115] offset:0
    ds_write_b128 v90, v[116:119] offset:1024
    ds_write_b128 v90, v[120:123] offset:2048
    ds_write_b128 v90, v[124:127] offset:3072
    ds_write_b128 v90, v[128:131] offset:4096
    s_waitcnt lgkmcnt(0)
    s_barrier
    s_endpgm
L_parallel_sum__grouped_kv_mqa__dense_activation_squared_relu__prompt_kernel_roleL:
    s_setprio 0
    v_lshlrev_b32 v2, 4, v1
    s_cmp_eq_u32 s38, 4
    s_cbranch_scc0 L_parallel_sum__grouped_kv_mqa__dense_activation_squared_relu__prompt_kernel_loader
    v_mov_b32 v144, 0x3f803f80
    v_mov_b32 v146, 0
    v_mov_b32 v147, 0
    v_mov_b32 v148, 0
    v_mov_b32 v149, 0
    v_mov_b32 v150, 0
    v_mov_b32 v151, 0
    v_mov_b32 v152, 0
    v_mov_b32 v153, 0
    v_add_u32 v7, 0, v5
    v_and_b32 v8, 15, v7
    v_xor_b32 v8, v8, v4
    v_mul_u32_u24 v7, 1280, v7
    v_lshl_add_u32 v154, v8, 4, v7
    v_add_u32 v7, 4, v5
    v_and_b32 v8, 15, v7
    v_xor_b32 v8, v8, v4
    v_mul_u32_u24 v7, 1280, v7
    v_lshl_add_u32 v155, v8, 4, v7
    s_cmp_eq_u32 s77, 0
    s_cbranch_scc1 L_nd_20
    s_sub_u32 s39, s38, 4
    s_mul_i32 s39, s39, 10
    s_and_b32 s40, s79, 1
    s_mul_i32 s40, s40, 40960
    v_and_b32 v20, 31, v1
    v_lshrrev_b32 v21, 5, v1
    v_and_b32 v22, 15, v20
    v_xor_b32 v22, v22, v21
    v_mul_u32_u24 v16, 1280, v20
    v_lshl_add_u32 v16, v22, 4, v16
    v_lshrrev_b32 v20, 5, v1
    v_bfe_u32 v22, v1, 2, 2
    v_lshl_add_u32 v20, v20, 3, v22
    v_bfe_u32 v21, v1, 4, 1
    v_lshlrev_b32 v21, 5, v21
    v_and_b32 v23, 3, v1
    v_lshl_add_u32 v21, v23, 3, v21
    v_mul_u32_u24 v17, 40, v20
    v_add_u32 v17, v17, v21
    v_add_u32 v17, 137216, v17
    s_add_u32 s41, s39, 0
    s_and_b32 s42, s41, 7
    s_lshl_b32 s42, s42, 5
    s_lshr_b32 s43, s41, 3
    s_lshl_b32 s43, s43, 8
    s_add_u32 s43, s43, s40
    v_xor_b32 v46, s42, v16
    v_add_u32 v46, s43, v46
    s_mul_i32 s41, s41, 640
    v_add_u32 v160, s41, v17
    s_add_u32 s41, s39, 1
    s_and_b32 s42, s41, 7
    s_lshl_b32 s42, s42, 5
    s_lshr_b32 s43, s41, 3
    s_lshl_b32 s43, s43, 8
    s_add_u32 s43, s43, s40
    v_xor_b32 v47, s42, v16
    v_add_u32 v47, s43, v47
    s_mul_i32 s41, s41, 640
    v_add_u32 v161, s41, v17
    s_add_u32 s41, s39, 2
    s_and_b32 s42, s41, 7
    s_lshl_b32 s42, s42, 5
    s_lshr_b32 s43, s41, 3
    s_lshl_b32 s43, s43, 8
    s_add_u32 s43, s43, s40
    v_xor_b32 v48, s42, v16
    v_add_u32 v48, s43, v48
    s_mul_i32 s41, s41, 640
    v_add_u32 v162, s41, v17
    s_add_u32 s41, s39, 3
    s_and_b32 s42, s41, 7
    s_lshl_b32 s42, s42, 5
    s_lshr_b32 s43, s41, 3
    s_lshl_b32 s43, s43, 8
    s_add_u32 s43, s43, s40
    v_xor_b32 v49, s42, v16
    v_add_u32 v49, s43, v49
    s_mul_i32 s41, s41, 640
    v_add_u32 v163, s41, v17
    s_add_u32 s41, s39, 4
    s_and_b32 s42, s41, 7
    s_lshl_b32 s42, s42, 5
    s_lshr_b32 s43, s41, 3
    s_lshl_b32 s43, s43, 8
    s_add_u32 s43, s43, s40
    v_xor_b32 v50, s42, v16
    v_add_u32 v50, s43, v50
    s_mul_i32 s41, s41, 640
    v_add_u32 v164, s41, v17
    s_add_u32 s41, s39, 5
    s_and_b32 s42, s41, 7
    s_lshl_b32 s42, s42, 5
    s_lshr_b32 s43, s41, 3
    s_lshl_b32 s43, s43, 8
    s_add_u32 s43, s43, s40
    v_xor_b32 v51, s42, v16
    v_add_u32 v51, s43, v51
    s_mul_i32 s41, s41, 640
    v_add_u32 v165, s41, v17
    s_add_u32 s41, s39, 6
    s_and_b32 s42, s41, 7
    s_lshl_b32 s42, s42, 5
    s_lshr_b32 s43, s41, 3
    s_lshl_b32 s43, s43, 8
    s_add_u32 s43, s43, s40
    v_xor_b32 v52, s42, v16
    v_add_u32 v52, s43, v52
    s_mul_i32 s41, s41, 640
    v_add_u32 v166, s41, v17
    s_add_u32 s41, s39, 7
    s_and_b32 s42, s41, 7
    s_lshl_b32 s42, s42, 5
    s_lshr_b32 s43, s41, 3
    s_lshl_b32 s43, s43, 8
    s_add_u32 s43, s43, s40
    v_xor_b32 v53, s42, v16
    v_add_u32 v53, s43, v53
    s_mul_i32 s41, s41, 640
    v_add_u32 v167, s41, v17
    s_add_u32 s41, s39, 8
    s_and_b32 s42, s41, 7
    s_lshl_b32 s42, s42, 5
    s_lshr_b32 s43, s41, 3
    s_lshl_b32 s43, s43, 8
    s_add_u32 s43, s43, s40
    v_xor_b32 v54, s42, v16
    v_add_u32 v54, s43, v54
    s_mul_i32 s41, s41, 640
    v_add_u32 v168, s41, v17
    s_add_u32 s41, s39, 9
    s_and_b32 s42, s41, 7
    s_lshl_b32 s42, s42, 5
    s_lshr_b32 s43, s41, 3
    s_lshl_b32 s43, s43, 8
    s_add_u32 s43, s43, s40
    v_xor_b32 v55, s42, v16
    v_add_u32 v55, s43, v55
    s_mul_i32 s41, s41, 640
    v_add_u32 v169, s41, v17
    v_mov_b32 v64, 0
    v_mov_b32 v65, 0
    v_mov_b32 v66, 0
    v_mov_b32 v67, 0
    v_mov_b32 v68, 0
    v_mov_b32 v69, 0
    v_mov_b32 v70, 0
    v_mov_b32 v71, 0
    v_mov_b32 v72, 0
    v_mov_b32 v73, 0
    v_mov_b32 v74, 0
    v_mov_b32 v75, 0
    v_mov_b32 v76, 0
    v_mov_b32 v77, 0
    v_mov_b32 v78, 0
    v_mov_b32 v79, 0
L_nd_20:
    s_waitcnt lgkmcnt(0)
    s_mov_b32 s8, s44
    s_mov_b32 s9, s45
    s_mov_b32 s10, 2621440
    s_mov_b32 s11, 0x00020000
    s_mov_b32 s12, s46
    s_mov_b32 s13, s47
    s_mov_b32 s14, 819200
    s_mov_b32 s15, 0x00020000
    s_mov_b32 s16, s56
    s_mov_b32 s17, s57
    s_mov_b32 s18, 1966080
    s_mov_b32 s19, 0x00020000
    s_mov_b32 s24, s68
    s_mov_b32 s25, s69
    s_mov_b32 s26, 13008896
    s_mov_b32 s27, 0x00020000
    s_mov_b32 s32, s58
    s_mov_b32 s33, s59
    s_mov_b32 s34, 3072
    s_mov_b32 s35, 0x00020000
    s_cmp_lt_u32 s79, 2
    s_cselect_b32 s20, s48, s50
    s_cselect_b32 s21, s49, s51
    s_mov_b32 s22, 25600
    s_mov_b32 s23, 0x00020000
    s_getpc_b64 s[70:71]
L_parallel_sum__grouped_kv_mqa__dense_activation_squared_relu__prompt_kernel_pcref:
    s_sub_u32 s70, s70, L_parallel_sum__grouped_kv_mqa__dense_activation_squared_relu__prompt_kernel_pcref-parallel_sum__grouped_kv_mqa__dense_activation_squared_relu__prompt_kernel
    s_subb_u32 s71, s71, 0
    s_lshr_b32 s39, s2, 3
    s_mul_i32 s39, s39, 1536
    v_lshlrev_b32 v222, 7, v1
    v_add_u32 v222, s39, v222
    v_mov_b32 v223, s71
    v_add_co_u32 v222, vcc, s70, v222
    s_nop 1
    v_addc_co_u32 v223, vcc, 0, v223, vcc
    v_cmp_gt_u32 vcc, 12, v1
    s_mov_b64 s[72:73], vcc
    s_lshr_b32 s39, s2, 3
    s_mul_i32 s39, s39, 12
    v_add_u32 v225, s39, v1
    v_cmp_gt_u32 vcc, (L_parallel_sum__grouped_kv_mqa__dense_activation_squared_relu__prompt_kernel_end-parallel_sum__grouped_kv_mqa__dense_activation_squared_relu__prompt_kernel)/128, v225
    s_nop 3
    s_and_b64 vcc, vcc, s[72:73]
    s_and_saveexec_b64 s[70:71], vcc
    s_cbranch_execz L_parallel_sum__grouped_kv_mqa__dense_activation_squared_relu__prompt_kernel_nopf
    global_load_dword v224, v[222:223], off
L_parallel_sum__grouped_kv_mqa__dense_activation_squared_relu__prompt_kernel_nopf:
    s_mov_b64 exec, s[70:71]
    s_mul_i32 s39, s36, 81920
    s_add_u32 s40, s39, 5120
    buffer_load_dwordx4 v[80:83], v249, s[8:11], s39 offen offset:0
    buffer_load_dwordx4 v[84:87], v249, s[8:11], s39 offen offset:256
    buffer_load_dwordx4 v[88:91], v249, s[8:11], s39 offen offset:512
    buffer_load_dwordx4 v[92:95], v249, s[8:11], s39 offen offset:768
    buffer_load_dwordx4 v[96:99], v249, s[8:11], s39 offen offset:1024
    buffer_load_dwordx4 v[100:103], v249, s[8:11], s40 offen offset:0
    buffer_load_dwordx4 v[104:107], v249, s[8:11], s40 offen offset:256
    buffer_load_dwordx4 v[108:111], v249, s[8:11], s40 offen offset:512
    buffer_load_dwordx4 v[112:115], v249, s[8:11], s40 offen offset:768
    buffer_load_dwordx4 v[116:119], v249, s[8:11], s40 offen offset:1024
    s_cmp_eq_u32 s77, 0
    s_cbranch_scc1 L_nokvw_21
    v_lshlrev_b32 v255, 4, v1
    s_lshl_b32 s39, s38, 10
    s_add_u32 m0, s39, 137216
    s_add_u32 s40, s39, 0
    buffer_load_dwordx4 v255, s[20:23], s40 offen lds
    s_add_u32 m0, s39, 145408
    s_add_u32 s40, s39, 8192
    buffer_load_dwordx4 v255, s[20:23], s40 offen lds
    s_add_u32 m0, s39, 153600
    s_add_u32 s40, s39, 16384
    buffer_load_dwordx4 v255, s[20:23], s40 offen lds
    s_add_u32 m0, s39, 161792
    s_add_u32 s40, s39, 24576
    buffer_load_dwordx4 v255, s[20:23], s40 offen lds
L_nokvw_21:
    s_mov_b32 s72, s66
    s_mov_b32 s73, s67
    s_mov_b32 s74, 256
    s_mov_b32 s75, 0x00020000
    s_memrealtime s[70:71]
    s_waitcnt lgkmcnt(0)
    s_or_b32 s78, s70, 1
    v_mov_b32 v170, s78
    v_mov_b32 v171, 0
    v_mov_b32 v172, 0
    s_mov_b64 exec, 1
    buffer_atomic_cmpswap v[170:171], v172, s[72:75], 0 offen sc0 sc1
    s_mov_b64 exec, -1
    s_cmp_eq_u32 s77, 0
    s_cbranch_scc1 L_wx1_22
    s_waitcnt vmcnt(5)
    s_branch L_wx2_23
L_wx1_22:
    s_waitcnt vmcnt(1)
L_wx2_23:
    v_dot2_f32_bf16 v146, v80, v144, v146
    v_dot2_f32_bf16 v148, v80, v80, v148
    v_dot2_f32_bf16 v147, v81, v144, v147
    v_dot2_f32_bf16 v149, v81, v81, v149
    v_dot2_f32_bf16 v146, v82, v144, v146
    v_dot2_f32_bf16 v148, v82, v82, v148
    v_dot2_f32_bf16 v147, v83, v144, v147
    v_dot2_f32_bf16 v149, v83, v83, v149
    v_dot2_f32_bf16 v146, v84, v144, v146
    v_dot2_f32_bf16 v148, v84, v84, v148
    v_dot2_f32_bf16 v147, v85, v144, v147
    v_dot2_f32_bf16 v149, v85, v85, v149
    v_dot2_f32_bf16 v146, v86, v144, v146
    v_dot2_f32_bf16 v148, v86, v86, v148
    v_dot2_f32_bf16 v147, v87, v144, v147
    v_dot2_f32_bf16 v149, v87, v87, v149
    v_dot2_f32_bf16 v146, v88, v144, v146
    v_dot2_f32_bf16 v148, v88, v88, v148
    v_dot2_f32_bf16 v147, v89, v144, v147
    v_dot2_f32_bf16 v149, v89, v89, v149
    v_dot2_f32_bf16 v146, v90, v144, v146
    v_dot2_f32_bf16 v148, v90, v90, v148
    v_dot2_f32_bf16 v147, v91, v144, v147
    v_dot2_f32_bf16 v149, v91, v91, v149
    v_dot2_f32_bf16 v146, v92, v144, v146
    v_dot2_f32_bf16 v148, v92, v92, v148
    v_dot2_f32_bf16 v147, v93, v144, v147
    v_dot2_f32_bf16 v149, v93, v93, v149
    v_dot2_f32_bf16 v146, v94, v144, v146
    v_dot2_f32_bf16 v148, v94, v94, v148
    v_dot2_f32_bf16 v147, v95, v144, v147
    v_dot2_f32_bf16 v149, v95, v95, v149
    v_dot2_f32_bf16 v146, v96, v144, v146
    v_dot2_f32_bf16 v148, v96, v96, v148
    v_dot2_f32_bf16 v147, v97, v144, v147
    v_dot2_f32_bf16 v149, v97, v97, v149
    v_dot2_f32_bf16 v146, v98, v144, v146
    v_dot2_f32_bf16 v148, v98, v98, v148
    v_dot2_f32_bf16 v147, v99, v144, v147
    v_dot2_f32_bf16 v149, v99, v99, v149
    v_dot2_f32_bf16 v150, v100, v144, v150
    v_dot2_f32_bf16 v152, v100, v100, v152
    v_dot2_f32_bf16 v151, v101, v144, v151
    v_dot2_f32_bf16 v153, v101, v101, v153
    v_dot2_f32_bf16 v150, v102, v144, v150
    v_dot2_f32_bf16 v152, v102, v102, v152
    v_dot2_f32_bf16 v151, v103, v144, v151
    v_dot2_f32_bf16 v153, v103, v103, v153
    v_dot2_f32_bf16 v150, v104, v144, v150
    v_dot2_f32_bf16 v152, v104, v104, v152
    v_dot2_f32_bf16 v151, v105, v144, v151
    v_dot2_f32_bf16 v153, v105, v105, v153
    v_dot2_f32_bf16 v150, v106, v144, v150
    v_dot2_f32_bf16 v152, v106, v106, v152
    v_dot2_f32_bf16 v151, v107, v144, v151
    v_dot2_f32_bf16 v153, v107, v107, v153
    v_dot2_f32_bf16 v150, v108, v144, v150
    v_dot2_f32_bf16 v152, v108, v108, v152
    v_dot2_f32_bf16 v151, v109, v144, v151
    v_dot2_f32_bf16 v153, v109, v109, v153
    v_dot2_f32_bf16 v150, v110, v144, v150
    v_dot2_f32_bf16 v152, v110, v110, v152
    v_dot2_f32_bf16 v151, v111, v144, v151
    v_dot2_f32_bf16 v153, v111, v111, v153
    v_dot2_f32_bf16 v150, v112, v144, v150
    v_dot2_f32_bf16 v152, v112, v112, v152
    v_dot2_f32_bf16 v151, v113, v144, v151
    v_dot2_f32_bf16 v153, v113, v113, v153
    v_dot2_f32_bf16 v150, v114, v144, v150
    v_dot2_f32_bf16 v152, v114, v114, v152
    v_dot2_f32_bf16 v151, v115, v144, v151
    v_dot2_f32_bf16 v153, v115, v115, v153
    v_dot2_f32_bf16 v150, v116, v144, v150
    v_dot2_f32_bf16 v152, v116, v116, v152
    v_dot2_f32_bf16 v151, v117, v144, v151
    v_dot2_f32_bf16 v153, v117, v117, v153
    v_dot2_f32_bf16 v150, v118, v144, v150
    v_dot2_f32_bf16 v152, v118, v118, v152
    v_dot2_f32_bf16 v151, v119, v144, v151
    v_dot2_f32_bf16 v153, v119, v119, v153
    s_mov_b32 s39, 986500301
    s_mov_b32 s40, 925353388
    s_nop 1
    v_add_f32 v146, v146, v147
    v_add_f32 v148, v148, v149
    v_add_f32 v150, v150, v151
    v_add_f32 v152, v152, v153
    s_nop 0
    v_add_f32_dpp v146, v146, v146 row_ror:8 row_mask:0xf bank_mask:0xf
    v_add_f32_dpp v148, v148, v148 row_ror:8 row_mask:0xf bank_mask:0xf
    v_add_f32_dpp v150, v150, v150 row_ror:8 row_mask:0xf bank_mask:0xf
    v_add_f32_dpp v152, v152, v152 row_ror:8 row_mask:0xf bank_mask:0xf
    v_add_f32_dpp v146, v146, v146 row_ror:4 row_mask:0xf bank_mask:0xf
    v_add_f32_dpp v148, v148, v148 row_ror:4 row_mask:0xf bank_mask:0xf
    v_add_f32_dpp v150, v150, v150 row_ror:4 row_mask:0xf bank_mask:0xf
    v_add_f32_dpp v152, v152, v152 row_ror:4 row_mask:0xf bank_mask:0xf
    v_add_f32_dpp v146, v146, v146 row_ror:2 row_mask:0xf bank_mask:0xf
    v_add_f32_dpp v148, v148, v148 row_ror:2 row_mask:0xf bank_mask:0xf
    v_add_f32_dpp v150, v150, v150 row_ror:2 row_mask:0xf bank_mask:0xf
    v_add_f32_dpp v152, v152, v152 row_ror:2 row_mask:0xf bank_mask:0xf
    v_add_f32_dpp v146, v146, v146 row_ror:1 row_mask:0xf bank_mask:0xf
    v_add_f32_dpp v148, v148, v148 row_ror:1 row_mask:0xf bank_mask:0xf
    v_add_f32_dpp v150, v150, v150 row_ror:1 row_mask:0xf bank_mask:0xf
    v_add_f32_dpp v152, v152, v152 row_ror:1 row_mask:0xf bank_mask:0xf
    v_mul_f32 v146, s39, v146
    v_mul_f32 v148, s39, v148
    v_mul_f32 v150, s39, v150
    v_mul_f32 v152, s39, v152
    v_fma_f32 v148, -v146, v146, v148
    v_fma_f32 v152, -v150, v150, v152
    v_max_f32 v148, 0, v148
    v_max_f32 v152, 0, v152
    v_add_f32 v148, s40, v148
    v_add_f32 v152, s40, v152
    v_rsq_f32 v148, v148
    v_rsq_f32 v152, v152
    s_nop 0
    v_mul_f32 v149, -v146, v148
    v_mul_f32 v153, -v150, v152
    v_lshlrev_b32 v156, 16, v80
    v_and_b32 v157, 0xffff0000, v80
    v_pk_fma_f32 v[156:157], v[156:157], v[148:149], v[148:149] op_sel:[0,0,1] op_sel_hi:[1,0,1]
    v_cvt_pk_bf16_f32 v80, v156, v157
    v_lshlrev_b32 v158, 16, v81
    v_and_b32 v159, 0xffff0000, v81
    v_pk_fma_f32 v[158:159], v[158:159], v[148:149], v[148:149] op_sel:[0,0,1] op_sel_hi:[1,0,1]
    v_cvt_pk_bf16_f32 v81, v158, v159
    v_lshlrev_b32 v156, 16, v82
    v_and_b32 v157, 0xffff0000, v82
    v_pk_fma_f32 v[156:157], v[156:157], v[148:149], v[148:149] op_sel:[0,0,1] op_sel_hi:[1,0,1]
    v_cvt_pk_bf16_f32 v82, v156, v157
    v_lshlrev_b32 v158, 16, v83
    v_and_b32 v159, 0xffff0000, v83
    v_pk_fma_f32 v[158:159], v[158:159], v[148:149], v[148:149] op_sel:[0,0,1] op_sel_hi:[1,0,1]
    v_cvt_pk_bf16_f32 v83, v158, v159
    ds_write_b128 v154, v[80:83] offset:0
    v_lshlrev_b32 v156, 16, v84
    v_and_b32 v157, 0xffff0000, v84
    v_pk_fma_f32 v[156:157], v[156:157], v[148:149], v[148:149] op_sel:[0,0,1] op_sel_hi:[1,0,1]
    v_cvt_pk_bf16_f32 v84, v156, v157
    v_lshlrev_b32 v158, 16, v85
    v_and_b32 v159, 0xffff0000, v85
    v_pk_fma_f32 v[158:159], v[158:159], v[148:149], v[148:149] op_sel:[0,0,1] op_sel_hi:[1,0,1]
    v_cvt_pk_bf16_f32 v85, v158, v159
    v_lshlrev_b32 v156, 16, v86
    v_and_b32 v157, 0xffff0000, v86
    v_pk_fma_f32 v[156:157], v[156:157], v[148:149], v[148:149] op_sel:[0,0,1] op_sel_hi:[1,0,1]
    v_cvt_pk_bf16_f32 v86, v156, v157
    v_lshlrev_b32 v158, 16, v87
    v_and_b32 v159, 0xffff0000, v87
    v_pk_fma_f32 v[158:159], v[158:159], v[148:149], v[148:149] op_sel:[0,0,1] op_sel_hi:[1,0,1]
    v_cvt_pk_bf16_f32 v87, v158, v159
    ds_write_b128 v154, v[84:87] offset:256
    v_lshlrev_b32 v156, 16, v88
    v_and_b32 v157, 0xffff0000, v88
    v_pk_fma_f32 v[156:157], v[156:157], v[148:149], v[148:149] op_sel:[0,0,1] op_sel_hi:[1,0,1]
    v_cvt_pk_bf16_f32 v88, v156, v157
    v_lshlrev_b32 v158, 16, v89
    v_and_b32 v159, 0xffff0000, v89
    v_pk_fma_f32 v[158:159], v[158:159], v[148:149], v[148:149] op_sel:[0,0,1] op_sel_hi:[1,0,1]
    v_cvt_pk_bf16_f32 v89, v158, v159
    v_lshlrev_b32 v156, 16, v90
    v_and_b32 v157, 0xffff0000, v90
    v_pk_fma_f32 v[156:157], v[156:157], v[148:149], v[148:149] op_sel:[0,0,1] op_sel_hi:[1,0,1]
    v_cvt_pk_bf16_f32 v90, v156, v157
    v_lshlrev_b32 v158, 16, v91
    v_and_b32 v159, 0xffff0000, v91
    v_pk_fma_f32 v[158:159], v[158:159], v[148:149], v[148:149] op_sel:[0,0,1] op_sel_hi:[1,0,1]
    v_cvt_pk_bf16_f32 v91, v158, v159
    ds_write_b128 v154, v[88:91] offset:512
    v_lshlrev_b32 v156, 16, v92
    v_and_b32 v157, 0xffff0000, v92
    v_pk_fma_f32 v[156:157], v[156:157], v[148:149], v[148:149] op_sel:[0,0,1] op_sel_hi:[1,0,1]
    v_cvt_pk_bf16_f32 v92, v156, v157
    v_lshlrev_b32 v158, 16, v93
    v_and_b32 v159, 0xffff0000, v93
    v_pk_fma_f32 v[158:159], v[158:159], v[148:149], v[148:149] op_sel:[0,0,1] op_sel_hi:[1,0,1]
    v_cvt_pk_bf16_f32 v93, v158, v159
    v_lshlrev_b32 v156, 16, v94
    v_and_b32 v157, 0xffff0000, v94
    v_pk_fma_f32 v[156:157], v[156:157], v[148:149], v[148:149] op_sel:[0,0,1] op_sel_hi:[1,0,1]
    v_cvt_pk_bf16_f32 v94, v156, v157
    v_lshlrev_b32 v158, 16, v95
    v_and_b32 v159, 0xffff0000, v95
    v_pk_fma_f32 v[158:159], v[158:159], v[148:149], v[148:149] op_sel:[0,0,1] op_sel_hi:[1,0,1]
    v_cvt_pk_bf16_f32 v95, v158, v159
    ds_write_b128 v154, v[92:95] offset:768
    v_lshlrev_b32 v156, 16, v96
    v_and_b32 v157, 0xffff0000, v96
    v_pk_fma_f32 v[156:157], v[156:157], v[148:149], v[148:149] op_sel:[0,0,1] op_sel_hi:[1,0,1]
    v_cvt_pk_bf16_f32 v96, v156, v157
    v_lshlrev_b32 v158, 16, v97
    v_and_b32 v159, 0xffff0000, v97
    v_pk_fma_f32 v[158:159], v[158:159], v[148:149], v[148:149] op_sel:[0,0,1] op_sel_hi:[1,0,1]
    v_cvt_pk_bf16_f32 v97, v158, v159
    v_lshlrev_b32 v156, 16, v98
    v_and_b32 v157, 0xffff0000, v98
    v_pk_fma_f32 v[156:157], v[156:157], v[148:149], v[148:149] op_sel:[0,0,1] op_sel_hi:[1,0,1]
    v_cvt_pk_bf16_f32 v98, v156, v157
    v_lshlrev_b32 v158, 16, v99
    v_and_b32 v159, 0xffff0000, v99
    v_pk_fma_f32 v[158:159], v[158:159], v[148:149], v[148:149] op_sel:[0,0,1] op_sel_hi:[1,0,1]
    v_cvt_pk_bf16_f32 v99, v158, v159
    ds_write_b128 v154, v[96:99] offset:1024
    v_lshlrev_b32 v156, 16, v100
    v_and_b32 v157, 0xffff0000, v100
    v_pk_fma_f32 v[156:157], v[156:157], v[152:153], v[152:153] op_sel:[0,0,1] op_sel_hi:[1,0,1]
    v_cvt_pk_bf16_f32 v100, v156, v157
    v_lshlrev_b32 v158, 16, v101
    v_and_b32 v159, 0xffff0000, v101
    v_pk_fma_f32 v[158:159], v[158:159], v[152:153], v[152:153] op_sel:[0,0,1] op_sel_hi:[1,0,1]
    v_cvt_pk_bf16_f32 v101, v158, v159
    v_lshlrev_b32 v156, 16, v102
    v_and_b32 v157, 0xffff0000, v102
    v_pk_fma_f32 v[156:157], v[156:157], v[152:153], v[152:153] op_sel:[0,0,1] op_sel_hi:[1,0,1]
    v_cvt_pk_bf16_f32 v102, v156, v157
    v_lshlrev_b32 v158, 16, v103
    v_and_b32 v159, 0xffff0000, v103
    v_pk_fma_f32 v[158:159], v[158:159], v[152:153], v[152:153] op_sel:[0,0,1] op_sel_hi:[1,0,1]
    v_cvt_pk_bf16_f32 v103, v158, v159
    ds_write_b128 v155, v[100:103] offset:0
    v_lshlrev_b32 v156, 16, v104
    v_and_b32 v157, 0xffff0000, v104
    v_pk_fma_f32 v[156:157], v[156:157], v[152:153], v[152:153] op_sel:[0,0,1] op_sel_hi:[1,0,1]
    v_cvt_pk_bf16_f32 v104, v156, v157
    v_lshlrev_b32 v158, 16, v105
    v_and_b32 v159, 0xffff0000, v105
    v_pk_fma_f32 v[158:159], v[158:159], v[152:153], v[152:153] op_sel:[0,0,1] op_sel_hi:[1,0,1]
    v_cvt_pk_bf16_f32 v105, v158, v159
    v_lshlrev_b32 v156, 16, v106
    v_and_b32 v157, 0xffff0000, v106
    v_pk_fma_f32 v[156:157], v[156:157], v[152:153], v[152:153] op_sel:[0,0,1] op_sel_hi:[1,0,1]
    v_cvt_pk_bf16_f32 v106, v156, v157
    v_lshlrev_b32 v158, 16, v107
    v_and_b32 v159, 0xffff0000, v107
    v_pk_fma_f32 v[158:159], v[158:159], v[152:153], v[152:153] op_sel:[0,0,1] op_sel_hi:[1,0,1]
    v_cvt_pk_bf16_f32 v107, v158, v159
    ds_write_b128 v155, v[104:107] offset:256
    v_lshlrev_b32 v156, 16, v108
    v_and_b32 v157, 0xffff0000, v108
    v_pk_fma_f32 v[156:157], v[156:157], v[152:153], v[152:153] op_sel:[0,0,1] op_sel_hi:[1,0,1]
    v_cvt_pk_bf16_f32 v108, v156, v157
    v_lshlrev_b32 v158, 16, v109
    v_and_b32 v159, 0xffff0000, v109
    v_pk_fma_f32 v[158:159], v[158:159], v[152:153], v[152:153] op_sel:[0,0,1] op_sel_hi:[1,0,1]
    v_cvt_pk_bf16_f32 v109, v158, v159
    v_lshlrev_b32 v156, 16, v110
    v_and_b32 v157, 0xffff0000, v110
    v_pk_fma_f32 v[156:157], v[156:157], v[152:153], v[152:153] op_sel:[0,0,1] op_sel_hi:[1,0,1]
    v_cvt_pk_bf16_f32 v110, v156, v157
    v_lshlrev_b32 v158, 16, v111
    v_and_b32 v159, 0xffff0000, v111
    v_pk_fma_f32 v[158:159], v[158:159], v[152:153], v[152:153] op_sel:[0,0,1] op_sel_hi:[1,0,1]
    v_cvt_pk_bf16_f32 v111, v158, v159
    ds_write_b128 v155, v[108:111] offset:512
    v_lshlrev_b32 v156, 16, v112
    v_and_b32 v157, 0xffff0000, v112
    v_pk_fma_f32 v[156:157], v[156:157], v[152:153], v[152:153] op_sel:[0,0,1] op_sel_hi:[1,0,1]
    v_cvt_pk_bf16_f32 v112, v156, v157
    v_lshlrev_b32 v158, 16, v113
    v_and_b32 v159, 0xffff0000, v113
    v_pk_fma_f32 v[158:159], v[158:159], v[152:153], v[152:153] op_sel:[0,0,1] op_sel_hi:[1,0,1]
    v_cvt_pk_bf16_f32 v113, v158, v159
    v_lshlrev_b32 v156, 16, v114
    v_and_b32 v157, 0xffff0000, v114
    v_pk_fma_f32 v[156:157], v[156:157], v[152:153], v[152:153] op_sel:[0,0,1] op_sel_hi:[1,0,1]
    v_cvt_pk_bf16_f32 v114, v156, v157
    v_lshlrev_b32 v158, 16, v115
    v_and_b32 v159, 0xffff0000, v115
    v_pk_fma_f32 v[158:159], v[158:159], v[152:153], v[152:153] op_sel:[0,0,1] op_sel_hi:[1,0,1]
    v_cvt_pk_bf16_f32 v115, v158, v159
    ds_write_b128 v155, v[112:115] offset:768
    v_lshlrev_b32 v156, 16, v116
    v_and_b32 v157, 0xffff0000, v116
    v_pk_fma_f32 v[156:157], v[156:157], v[152:153], v[152:153] op_sel:[0,0,1] op_sel_hi:[1,0,1]
    v_cvt_pk_bf16_f32 v116, v156, v157
    v_lshlrev_b32 v158, 16, v117
    v_and_b32 v159, 0xffff0000, v117
    v_pk_fma_f32 v[158:159], v[158:159], v[152:153], v[152:153] op_sel:[0,0,1] op_sel_hi:[1,0,1]
    v_cvt_pk_bf16_f32 v117, v158, v159
    v_lshlrev_b32 v156, 16, v118
    v_and_b32 v157, 0xffff0000, v118
    v_pk_fma_f32 v[156:157], v[156:157], v[152:153], v[152:153] op_sel:[0,0,1] op_sel_hi:[1,0,1]
    v_cvt_pk_bf16_f32 v118, v156, v157
    v_lshlrev_b32 v158, 16, v119
    v_and_b32 v159, 0xffff0000, v119
    v_pk_fma_f32 v[158:159], v[158:159], v[152:153], v[152:153] op_sel:[0,0,1] op_sel_hi:[1,0,1]
    v_cvt_pk_bf16_f32 v119, v158, v159
    ds_write_b128 v155, v[116:119] offset:1024
    s_bfe_u32 s41, s2, 0x10001
    s_lshr_b32 s42, s2, 3
    s_mul_i32 s43, s42, 25600
    s_mul_i32 s44, s41, 640
    s_add_u32 s43, s43, s44
    v_add_u32 v7, 0, v1
    v_mul_u32_u24 v8, 205, v7
    v_lshrrev_b32 v8, 10, v8
    v_mul_u32_u24 v9, 5, v8
    v_sub_u32 v9, v7, v9
    v_mul_u32_u24 v8, 1280, v8
    v_lshl_add_u32 v8, v9, 7, v8
    v_cmp_gt_u32 vcc, 100, v7
    v_mov_b32 v9, 1073741824
    s_nop 0
    v_cndmask_b32 v8, v9, v8, vcc
    buffer_load_dword v173, v8, s[12:15], s43 offen
    v_add_u32 v7, 64, v1
    v_mul_u32_u24 v8, 205, v7
    v_lshrrev_b32 v8, 10, v8
    v_mul_u32_u24 v9, 5, v8
    v_sub_u32 v9, v7, v9
    v_mul_u32_u24 v8, 1280, v8
    v_lshl_add_u32 v8, v9, 7, v8
    v_cmp_gt_u32 vcc, 100, v7
    v_mov_b32 v9, 1073741824
    s_nop 0
    v_cndmask_b32 v8, v9, v8, vcc
    buffer_load_dword v174, v8, s[12:15], s43 offen
    s_mul_i32 s43, s42, 61440
    s_mul_i32 s44, s41, 1536
    s_add_u32 s43, s43, s44
    v_add_u32 v7, 0, v1
    v_mul_u32_u24 v8, 171, v7
    v_lshrrev_b32 v8, 11, v8
    v_mul_u32_u24 v9, 12, v8
    v_sub_u32 v9, v7, v9
    v_mul_u32_u24 v8, 3072, v8
    v_lshl_add_u32 v8, v9, 7, v8
    v_cmp_gt_u32 vcc, 240, v7
    v_mov_b32 v9, 1073741824
    s_nop 0
    v_cndmask_b32 v8, v9, v8, vcc
    buffer_load_dword v175, v8, s[16:19], s43 offen
    v_add_u32 v7, 64, v1
    v_mul_u32_u24 v8, 171, v7
    v_lshrrev_b32 v8, 11, v8
    v_mul_u32_u24 v9, 12, v8
    v_sub_u32 v9, v7, v9
    v_mul_u32_u24 v8, 3072, v8
    v_lshl_add_u32 v8, v9, 7, v8
    v_cmp_gt_u32 vcc, 240, v7
    v_mov_b32 v9, 1073741824
    s_nop 0
    v_cndmask_b32 v8, v9, v8, vcc
    buffer_load_dword v176, v8, s[16:19], s43 offen
    v_add_u32 v7, 128, v1
    v_mul_u32_u24 v8, 171, v7
    v_lshrrev_b32 v8, 11, v8
    v_mul_u32_u24 v9, 12, v8
    v_sub_u32 v9, v7, v9
    v_mul_u32_u24 v8, 3072, v8
    v_lshl_add_u32 v8, v9, 7, v8
    v_cmp_gt_u32 vcc, 240, v7
    v_mov_b32 v9, 1073741824
    s_nop 0
    v_cndmask_b32 v8, v9, v8, vcc
    buffer_load_dword v177, v8, s[16:19], s43 offen
    v_add_u32 v7, 192, v1
    v_mul_u32_u24 v8, 171, v7
    v_lshrrev_b32 v8, 11, v8
    v_mul_u32_u24 v9, 12, v8
    v_sub_u32 v9, v7, v9
    v_mul_u32_u24 v8, 3072, v8
    v_lshl_add_u32 v8, v9, 7, v8
    v_cmp_gt_u32 vcc, 240, v7
    v_mov_b32 v9, 1073741824
    s_nop 0
    v_cndmask_b32 v8, v9, v8, vcc
    buffer_load_dword v178, v8, s[16:19], s43 offen
    s_cmp_eq_u32 s77, 0
    s_cbranch_scc1 L_svc_nonduty_24
    s_waitcnt vmcnt(7) lgkmcnt(0)
    s_setprio 0
    s_barrier
    ds_read_b128 v[80:83], v46
    ds_read_b64_tr_b16 v[84:85], v160
    ds_read_b64_tr_b16 v[86:87], v160 offset:160
    ds_read_b128 v[88:91], v47
    ds_read_b64_tr_b16 v[92:93], v161
    ds_read_b64_tr_b16 v[94:95], v161 offset:160
    ds_read_b128 v[96:99], v48
    ds_read_b64_tr_b16 v[100:101], v162
    ds_read_b64_tr_b16 v[102:103], v162 offset:160
    ds_read_b128 v[104:107], v49
    ds_read_b64_tr_b16 v[108:109], v163
    ds_read_b64_tr_b16 v[110:111], v163 offset:160
    ds_read_b128 v[112:115], v50
    ds_read_b64_tr_b16 v[116:117], v164
    ds_read_b64_tr_b16 v[118:119], v164 offset:160
    ds_read_b128 v[120:123], v51
    ds_read_b64_tr_b16 v[124:125], v165
    ds_read_b64_tr_b16 v[126:127], v165 offset:160
    ds_read_b128 v[128:131], v52
    ds_read_b64_tr_b16 v[132:133], v166
    ds_read_b64_tr_b16 v[134:135], v166 offset:160
    ds_read_b128 v[136:139], v53
    ds_read_b64_tr_b16 v[140:141], v167
    ds_read_b64_tr_b16 v[142:143], v167 offset:160
    ds_read_b128 v[144:147], v54
    ds_read_b64_tr_b16 v[148:149], v168
    ds_read_b64_tr_b16 v[150:151], v168 offset:160
    ds_read_b128 v[152:155], v55
    ds_read_b64_tr_b16 v[156:157], v169
    ds_read_b64_tr_b16 v[158:159], v169 offset:160
    s_barrier
    s_waitcnt lgkmcnt(0)
    v_mfma_f32_32x32x16_bf16 v[64:79], v[84:87], v[80:83], v[64:79]
    v_mfma_f32_32x32x16_bf16 v[64:79], v[92:95], v[88:91], v[64:79]
    v_mfma_f32_32x32x16_bf16 v[64:79], v[100:103], v[96:99], v[64:79]
    v_mfma_f32_32x32x16_bf16 v[64:79], v[108:111], v[104:107], v[64:79]
    v_mfma_f32_32x32x16_bf16 v[64:79], v[116:119], v[112:115], v[64:79]
    v_mfma_f32_32x32x16_bf16 v[64:79], v[124:127], v[120:123], v[64:79]
    v_mfma_f32_32x32x16_bf16 v[64:79], v[132:135], v[128:131], v[64:79]
    v_mfma_f32_32x32x16_bf16 v[64:79], v[140:143], v[136:139], v[64:79]
    v_mfma_f32_32x32x16_bf16 v[64:79], v[148:151], v[144:147], v[64:79]
    v_mfma_f32_32x32x16_bf16 v[64:79], v[156:159], v[152:155], v[64:79]
    s_barrier
    s_barrier
    v_add_u32 v16, 137216, v2
    ds_read_b128 v[80:83], v16 offset:0
    ds_read_b128 v[84:87], v16 offset:1024
    ds_read_b128 v[88:91], v16 offset:2048
    ds_read_b128 v[92:95], v16 offset:3072
    ds_read_b128 v[96:99], v16 offset:4096
    ds_read_b128 v[100:103], v16 offset:5120
    ds_read_b128 v[104:107], v16 offset:6144
    ds_read_b128 v[108:111], v16 offset:7168
    ds_read_b128 v[112:115], v16 offset:8192
    ds_read_b128 v[116:119], v16 offset:9216
    ds_read_b128 v[120:123], v16 offset:10240
    ds_read_b128 v[124:127], v16 offset:11264
    s_waitcnt lgkmcnt(0)
    v_add_f32 v64, v64, v80
    v_add_f32 v96, v96, v112
    v_add_f32 v65, v65, v81
    v_add_f32 v97, v97, v113
    v_add_f32 v66, v66, v82
    v_add_f32 v98, v98, v114
    v_add_f32 v67, v67, v83
    v_add_f32 v99, v99, v115
    v_add_f32 v68, v68, v84
    v_add_f32 v100, v100, v116
    v_add_f32 v69, v69, v85
    v_add_f32 v101, v101, v117
    v_add_f32 v70, v70, v86
    v_add_f32 v102, v102, v118
    v_add_f32 v71, v71, v87
    v_add_f32 v103, v103, v119
    v_add_f32 v72, v72, v88
    v_add_f32 v104, v104, v120
    v_add_f32 v73, v73, v89
    v_add_f32 v105, v105, v121
    v_add_f32 v74, v74, v90
    v_add_f32 v106, v106, v122
    v_add_f32 v75, v75, v91
    v_add_f32 v107, v107, v123
    v_add_f32 v76, v76, v92
    v_add_f32 v108, v108, v124
    v_add_f32 v77, v77, v93
    v_add_f32 v109, v109, v125
    v_add_f32 v78, v78, v94
    v_add_f32 v110, v110, v126
    v_add_f32 v79, v79, v95
    v_add_f32 v111, v111, v127
    v_add_f32 v64, v64, v96
    v_add_f32 v65, v65, v97
    v_add_f32 v66, v66, v98
    v_add_f32 v67, v67, v99
    v_add_f32 v68, v68, v100
    v_add_f32 v69, v69, v101
    v_add_f32 v70, v70, v102
    v_add_f32 v71, v71, v103
    v_add_f32 v72, v72, v104
    v_add_f32 v73, v73, v105
    v_add_f32 v74, v74, v106
    v_add_f32 v75, v75, v107
    v_add_f32 v76, v76, v108
    v_add_f32 v77, v77, v109
    v_add_f32 v78, v78, v110
    v_add_f32 v79, v79, v111
    s_barrier
    v_cvt_pk_bf16_f32 v48, v64, v65
    v_cvt_pk_bf16_f32 v49, v66, v67
    v_cvt_pk_bf16_f32 v50, v68, v69
    v_cvt_pk_bf16_f32 v51, v70, v71
    v_cvt_pk_bf16_f32 v52, v72, v73
    v_cvt_pk_bf16_f32 v53, v74, v75
    s_lshl_b32 s39, s36, 1
    s_and_b32 s40, s79, 1
    s_add_u32 s39, s39, s40
    s_lshr_b32 s40, s39, 5
    s_mul_i32 s40, s40, 81920
    s_and_b32 s39, s39, 31
    s_mul_i32 s39, s39, 1280
    s_add_u32 s39, s39, s40
    v_and_b32 v16, 31, v1
    v_lshrrev_b32 v17, 5, v1
    v_mov_b32 v22, 1073741824
    v_cmp_eq_u32 vcc, 0, v17
    s_cmp_lt_u32 s79, 2
    s_cbranch_scc0 L_isV_25
    buffer_store_dwordx4 v[48:51], v2, s[24:27], s39 offen sc1
    v_lshlrev_b32 v21, 3, v16
    v_cndmask_b32 v21, v22, v21, vcc
    buffer_store_dwordx2 v[52:53], v21, s[24:27], s39 offen offset:1024 sc1
    s_branch L_kvst_26
L_isV_25:
    s_add_u32 s39, s39, 40960
    v_lshrrev_b32 v20, 4, v16
    v_mul_u32_u24 v20, 640, v20
    v_bfe_u32 v21, v16, 2, 1
    v_mul_u32_u24 v21, 320, v21
    v_add_u32 v20, v20, v21
    v_bfe_u32 v21, v16, 3, 1
    v_lshl_add_u32 v20, v21, 3, v20
    v_and_b32 v21, 3, v16
    v_lshl_add_u32 v20, v21, 1, v20
    v_lshl_add_u32 v20, v17, 6, v20
    v_cndmask_b32 v21, v22, v20, vcc
    buffer_store_short v48, v20, s[24:27], s39 offen offset:0 sc1
    buffer_store_short_d16_hi v48, v20, s[24:27], s39 offen offset:16 sc1
    buffer_store_short v49, v20, s[24:27], s39 offen offset:32 sc1
    buffer_store_short_d16_hi v49, v20, s[24:27], s39 offen offset:48 sc1
    buffer_store_short v50, v20, s[24:27], s39 offen offset:128 sc1
    buffer_store_short_d16_hi v50, v20, s[24:27], s39 offen offset:144 sc1
    buffer_store_short v51, v20, s[24:27], s39 offen offset:160 sc1
    buffer_store_short_d16_hi v51, v20, s[24:27], s39 offen offset:176 sc1
    buffer_store_short v52, v21, s[24:27], s39 offen offset:256 sc1
    buffer_store_short_d16_hi v52, v21, s[24:27], s39 offen offset:272 sc1
    buffer_store_short v53, v21, s[24:27], s39 offen offset:288 sc1
    buffer_store_short_d16_hi v53, v21, s[24:27], s39 offen offset:304 sc1
L_kvst_26:
    s_barrier
    s_barrier
    s_barrier
    s_barrier
    s_waitcnt vmcnt(0)
    v_readfirstlane_b32 s40, v170
    s_nop 3
    s_cmp_eq_u32 s40, 0
    s_cselect_b32 s76, s78, s40
    v_mov_b32 v16, 162816
    v_mov_b32 v17, s76
    ds_write_b32 v16, v17
    s_waitcnt lgkmcnt(0)
    s_waitcnt vmcnt(0)
    s_lshl_b32 s58, s36, 2
    s_add_u32 s58, s58, s79
    s_lshl_b32 s58, s58, 2
    s_add_u32 s58, s58, 11862016
    v_mov_b32 v252, 0
    v_mov_b32 v253, s76
    s_mov_b64 exec, 1
    buffer_store_dword v253, v252, s[24:27], s58 offen sc1
    s_mov_b64 exec, -1
    s_barrier
    s_barrier
    s_barrier
    s_barrier
    s_barrier
    s_barrier
    s_barrier
    s_barrier
    s_barrier
    s_mov_b32 s59, 0
L_poll_27:
    v_lshlrev_b32 v252, 2, v1
    v_add_u32 v252, 11862016, v252
    buffer_load_dword v253, v252, s[24:27], 0 offen sc1
    s_waitcnt vmcnt(0)
    v_xor_b32 v253, s76, v253
    v_cmp_ne_u32 vcc, 0, v253
    s_add_u32 s59, s59, 1
    s_nop 3
    s_cmp_eq_u64 vcc, 0
    s_cbranch_scc1 L_pollok_28
    s_cmp_gt_u32 s59, 20000
    s_cbranch_scc1 L_pollok_28
    s_sleep 4
    s_branch L_poll_27
L_pollok_28:
    s_barrier
    s_mov_b32 m0, 118784
    s_mov_b32 s58, 36864
    buffer_load_dwordx4 v2, s[24:27], s58 offen sc1 lds
    s_mov_b32 m0, 122880
    s_mov_b32 s58, 40960
    buffer_load_dwordx4 v2, s[24:27], s58 offen sc1 lds
    s_mov_b32 m0, 126976
    s_mov_b32 s58, 45056
    buffer_load_dwordx4 v2, s[24:27], s58 offen sc1 lds
    s_mov_b32 m0, 131072
    s_mov_b32 s58, 49152
    buffer_load_dwordx4 v2, s[24:27], s58 offen sc1 lds
    s_mov_b32 m0, 135168
    s_mov_b32 s58, 53248
    buffer_load_dwordx4 v2, s[24:27], s58 offen sc1 lds
    s_mov_b32 m0, 139264
    s_mov_b32 s58, 57344
    buffer_load_dwordx4 v2, s[24:27], s58 offen sc1 lds
    s_mov_b32 m0, 143360
    s_mov_b32 s58, 61440
    buffer_load_dwordx4 v2, s[24:27], s58 offen sc1 lds
    s_mov_b32 m0, 147456
    s_mov_b32 s58, 65536
    buffer_load_dwordx4 v2, s[24:27], s58 offen sc1 lds
    s_mov_b32 m0, 151552
    s_mov_b32 s58, 69632
    buffer_load_dwordx4 v2, s[24:27], s58 offen sc1 lds
    s_mov_b32 m0, 155648
    s_mov_b32 s58, 73728
    buffer_load_dwordx4 v2, s[24:27], s58 offen sc1 lds
    s_mov_b32 m0, 159744
    s_mov_b32 s58, 77824
    buffer_load_dwordx4 v2, s[24:27], s58 offen sc1 lds
    s_barrier
    s_mov_b32 m0, 81920
    s_mov_b32 s58, 0
    buffer_load_dwordx4 v2, s[24:27], s58 offen sc1 lds
    s_mov_b32 m0, 86016
    s_mov_b32 s58, 4096
    buffer_load_dwordx4 v2, s[24:27], s58 offen sc1 lds
    s_mov_b32 m0, 90112
    s_mov_b32 s58, 8192
    buffer_load_dwordx4 v2, s[24:27], s58 offen sc1 lds
    s_mov_b32 m0, 94208
    s_mov_b32 s58, 12288
    buffer_load_dwordx4 v2, s[24:27], s58 offen sc1 lds
    s_mov_b32 m0, 98304
    s_mov_b32 s58, 16384
    buffer_load_dwordx4 v2, s[24:27], s58 offen sc1 lds
    s_barrier
    s_mov_b32 m0, 100352
    s_mov_b32 s58, 18432
    buffer_load_dwordx4 v2, s[24:27], s58 offen sc1 lds
    s_mov_b32 m0, 104448
    s_mov_b32 s58, 22528
    buffer_load_dwordx4 v2, s[24:27], s58 offen sc1 lds
    s_mov_b32 m0, 108544
    s_mov_b32 s58, 26624
    buffer_load_dwordx4 v2, s[24:27], s58 offen sc1 lds
    s_mov_b32 m0, 112640
    s_mov_b32 s58, 30720
    buffer_load_dwordx4 v2, s[24:27], s58 offen sc1 lds
    s_mov_b32 m0, 116736
    s_mov_b32 s58, 34816
    buffer_load_dwordx4 v2, s[24:27], s58 offen sc1 lds
    s_branch L_parallel_sum__grouped_kv_mqa__dense_activation_squared_relu__prompt_kernel_svcjoin
L_svc_nonduty_24:
    v_add_u32 v7, 0, v1
    v_mul_u32_u24 v8, 205, v7
    v_lshrrev_b32 v8, 11, v8
    v_mul_u32_u24 v9, 10, v8
    v_sub_u32 v9, v7, v9
    v_mul_u32_u24 v8, 1280, v8
    v_lshl_add_u32 v24, v9, 4, v8
    v_add_u32 v7, 64, v1
    v_mul_u32_u24 v8, 205, v7
    v_lshrrev_b32 v8, 11, v8
    v_mul_u32_u24 v9, 10, v8
    v_sub_u32 v9, v7, v9
    v_mul_u32_u24 v8, 1280, v8
    v_lshl_add_u32 v25, v9, 4, v8
    v_add_u32 v7, 128, v1
    v_mul_u32_u24 v8, 205, v7
    v_lshrrev_b32 v8, 11, v8
    v_mul_u32_u24 v9, 10, v8
    v_sub_u32 v9, v7, v9
    v_mul_u32_u24 v8, 1280, v8
    v_lshl_add_u32 v26, v9, 4, v8
    v_add_u32 v7, 192, v1
    v_mul_u32_u24 v8, 205, v7
    v_lshrrev_b32 v8, 11, v8
    v_mul_u32_u24 v9, 10, v8
    v_sub_u32 v9, v7, v9
    v_mul_u32_u24 v8, 1280, v8
    v_lshl_add_u32 v27, v9, 4, v8
    v_add_u32 v7, 256, v1
    v_mul_u32_u24 v8, 205, v7
    v_lshrrev_b32 v8, 11, v8
    v_mul_u32_u24 v9, 10, v8
    v_sub_u32 v9, v7, v9
    v_mul_u32_u24 v8, 1280, v8
    v_lshl_add_u32 v28, v9, 4, v8
    v_lshrrev_b32 v16, 4, v1
    v_bfe_u32 v17, v1, 2, 2
    v_and_b32 v18, 3, v1
    v_lshlrev_b32 v19, 3, v16
    v_lshrrev_b32 v20, 1, v16
    v_lshlrev_b32 v20, 4, v20
    v_and_b32 v21, 1, v16
    v_lshl_add_u32 v20, v21, 2, v20
    v_add_u32 v19, v19, v17
    v_mul_u32_u24 v19, 160, v19
    v_lshl_add_u32 v19, v18, 3, v19
    v_add_u32 v19, 137216, v19
    v_add_u32 v20, v20, v17
    v_mul_u32_u24 v20, 160, v20
    v_lshl_add_u32 v20, v18, 3, v20
    v_add_u32 v20, 137216, v20
    s_waitcnt lgkmcnt(0)
    s_setprio 0
    s_barrier
    s_barrier
    s_add_u32 s39, s36, 0
    s_cmp_ge_u32 s39, 68
    s_cbranch_scc1 L_noT_29
    s_mov_b32 s43, s37
    s_cmp_lt_u32 s39, 20
    s_cselect_b32 s28, s52, s60
    s_cselect_b32 s29, s53, s61
    s_mov_b32 s40, 819200
    s_cselect_b32 s30, s40, 1966080
    s_mov_b32 s31, 0x00020000
    s_cselect_b32 s40, 0, 20
    s_sub_u32 s40, s39, s40
    s_mul_i32 s40, s40, 40960
    s_mul_i32 s41, s43, 160
    s_add_u32 s40, s40, s41
    s_mov_b32 m0, 137216
    s_nop 0
    buffer_load_dwordx4 v24, s[28:31], s40 offen lds
    s_mov_b32 m0, 138240
    s_nop 0
    buffer_load_dwordx4 v25, s[28:31], s40 offen lds
    s_mov_b32 m0, 139264
    s_nop 0
    buffer_load_dwordx4 v26, s[28:31], s40 offen lds
    s_mov_b32 m0, 140288
    s_nop 0
    buffer_load_dwordx4 v27, s[28:31], s40 offen lds
    s_mov_b32 m0, 141312
    s_nop 0
    buffer_load_dwordx4 v28, s[28:31], s40 offen lds
L_noT_29:
    s_barrier
    s_add_u32 s39, s36, 0
    s_cmp_ge_u32 s39, 68
    s_cbranch_scc1 L_noT_30
    s_sub_u32 s43, s37, 4
    s_cmp_lt_u32 s39, 20
    s_cselect_b32 s28, s52, s60
    s_cselect_b32 s29, s53, s61
    s_mov_b32 s40, 819200
    s_cselect_b32 s30, s40, 1966080
    s_mov_b32 s31, 0x00020000
    s_cselect_b32 s40, 0, 20
    s_sub_u32 s40, s39, s40
    s_mul_i32 s40, s40, 40960
    s_mul_i32 s41, s43, 160
    s_add_u32 s40, s40, s41
    s_mov_b32 m0, 142336
    s_nop 0
    buffer_load_dwordx4 v24, s[28:31], s40 offen lds
    s_mov_b32 m0, 143360
    s_nop 0
    buffer_load_dwordx4 v25, s[28:31], s40 offen lds
    s_mov_b32 m0, 144384
    s_nop 0
    buffer_load_dwordx4 v26, s[28:31], s40 offen lds
    s_mov_b32 m0, 145408
    s_nop 0
    buffer_load_dwordx4 v27, s[28:31], s40 offen lds
    s_mov_b32 m0, 146432
    s_nop 0
    buffer_load_dwordx4 v28, s[28:31], s40 offen lds
L_noT_30:
    s_barrier
    s_add_u32 s39, s36, 32
    s_cmp_ge_u32 s39, 68
    s_cbranch_scc1 L_noT_31
    s_mov_b32 s43, s37
    s_cmp_lt_u32 s39, 20
    s_cselect_b32 s28, s52, s60
    s_cselect_b32 s29, s53, s61
    s_mov_b32 s40, 819200
    s_cselect_b32 s30, s40, 1966080
    s_mov_b32 s31, 0x00020000
    s_cselect_b32 s40, 0, 20
    s_sub_u32 s40, s39, s40
    s_mul_i32 s40, s40, 40960
    s_mul_i32 s41, s43, 160
    s_add_u32 s40, s40, s41
    s_mov_b32 m0, 147456
    s_nop 0
    buffer_load_dwordx4 v24, s[28:31], s40 offen lds
    s_mov_b32 m0, 148480
    s_nop 0
    buffer_load_dwordx4 v25, s[28:31], s40 offen lds
    s_mov_b32 m0, 149504
    s_nop 0
    buffer_load_dwordx4 v26, s[28:31], s40 offen lds
    s_mov_b32 m0, 150528
    s_nop 0
    buffer_load_dwordx4 v27, s[28:31], s40 offen lds
    s_mov_b32 m0, 151552
    s_nop 0
    buffer_load_dwordx4 v28, s[28:31], s40 offen lds
L_noT_31:
    s_barrier
    s_waitcnt vmcnt(15)
    v_readfirstlane_b32 s40, v170
    s_nop 3
    s_cmp_eq_u32 s40, 0
    s_cselect_b32 s76, s78, s40
    v_mov_b32 v16, 162816
    v_mov_b32 v17, s76
    ds_write_b32 v16, v17
    s_waitcnt lgkmcnt(0)
    s_add_u32 s39, s36, 32
    s_cmp_ge_u32 s39, 68
    s_cbranch_scc1 L_noT_32
    s_sub_u32 s43, s37, 4
    s_cmp_lt_u32 s39, 20
    s_cselect_b32 s28, s52, s60
    s_cselect_b32 s29, s53, s61
    s_mov_b32 s40, 819200
    s_cselect_b32 s30, s40, 1966080
    s_mov_b32 s31, 0x00020000
    s_cselect_b32 s40, 0, 20
    s_sub_u32 s40, s39, s40
    s_mul_i32 s40, s40, 40960
    s_mul_i32 s41, s43, 160
    s_add_u32 s40, s40, s41
    s_mov_b32 m0, 152576
    s_nop 0
    buffer_load_dwordx4 v24, s[28:31], s40 offen lds
    s_mov_b32 m0, 153600
    s_nop 0
    buffer_load_dwordx4 v25, s[28:31], s40 offen lds
    s_mov_b32 m0, 154624
    s_nop 0
    buffer_load_dwordx4 v26, s[28:31], s40 offen lds
    s_mov_b32 m0, 155648
    s_nop 0
    buffer_load_dwordx4 v27, s[28:31], s40 offen lds
    s_mov_b32 m0, 156672
    s_nop 0
    buffer_load_dwordx4 v28, s[28:31], s40 offen lds
L_noT_32:
    s_barrier
    s_add_u32 s39, s36, 64
    s_cmp_ge_u32 s39, 68
    s_cbranch_scc1 L_noT_33
    s_mov_b32 s43, s37
    s_cmp_lt_u32 s39, 20
    s_cselect_b32 s28, s52, s60
    s_cselect_b32 s29, s53, s61
    s_mov_b32 s40, 819200
    s_cselect_b32 s30, s40, 1966080
    s_mov_b32 s31, 0x00020000
    s_cselect_b32 s40, 0, 20
    s_sub_u32 s40, s39, s40
    s_mul_i32 s40, s40, 40960
    s_mul_i32 s41, s43, 160
    s_add_u32 s40, s40, s41
    s_mov_b32 m0, 157696
    s_nop 0
    buffer_load_dwordx4 v24, s[28:31], s40 offen lds
    s_mov_b32 m0, 158720
    s_nop 0
    buffer_load_dwordx4 v25, s[28:31], s40 offen lds
    s_mov_b32 m0, 159744
    s_nop 0
    buffer_load_dwordx4 v26, s[28:31], s40 offen lds
    s_mov_b32 m0, 160768
    s_nop 0
    buffer_load_dwordx4 v27, s[28:31], s40 offen lds
    s_mov_b32 m0, 161792
    s_nop 0
    buffer_load_dwordx4 v28, s[28:31], s40 offen lds
L_noT_33:
    s_barrier
    s_barrier
    s_barrier
    s_barrier
    s_waitcnt vmcnt(15)
    s_add_u32 s39, s36, 0
    s_cmp_ge_u32 s39, 68
    s_cbranch_scc1 L_noT2_34
    s_mov_b32 s43, s37
    s_cmp_lt_u32 s39, 20
    s_cselect_b64 vcc, -1, 0
    s_movk_i32 s40, 640
    s_cselect_b32 s40, s40, 1280
    v_cndmask_b32 v21, v20, v19, vcc
    v_add_u32 v22, s40, v21
    ds_read_b64_tr_b16 v[32:33], v21 offset:0
    ds_read_b64_tr_b16 v[34:35], v22 offset:0
    ds_read_b64_tr_b16 v[36:37], v21 offset:32
    ds_read_b64_tr_b16 v[38:39], v22 offset:32
    ds_read_b64_tr_b16 v[40:41], v21 offset:64
    ds_read_b64_tr_b16 v[42:43], v22 offset:64
    ds_read_b64_tr_b16 v[44:45], v21 offset:96
    ds_read_b64_tr_b16 v[46:47], v22 offset:96
    ds_read_b64_tr_b16 v[48:49], v21 offset:128
    ds_read_b64_tr_b16 v[50:51], v22 offset:128
    s_mul_i32 s40, s43, 68
    s_add_u32 s39, s39, s40
    s_mul_i32 s39, s39, 5120
    s_add_u32 s39, s39, 6455296
    s_add_u32 s40, s39, 4096
    s_waitcnt lgkmcnt(0)
    buffer_store_dwordx4 v[32:35], v2, s[24:27], s39 offen offset:0 sc1
    buffer_store_dwordx4 v[36:39], v2, s[24:27], s39 offen offset:1024 sc1
    buffer_store_dwordx4 v[40:43], v2, s[24:27], s39 offen offset:2048 sc1
    buffer_store_dwordx4 v[44:47], v2, s[24:27], s39 offen offset:3072 sc1
    buffer_store_dwordx4 v[48:51], v2, s[24:27], s40 offen sc1
L_noT2_34:
    s_barrier
    s_waitcnt vmcnt(15)
    s_add_u32 s39, s36, 0
    s_cmp_ge_u32 s39, 68
    s_cbranch_scc1 L_noT2_35
    s_sub_u32 s43, s37, 4
    s_cmp_lt_u32 s39, 20
    s_cselect_b64 vcc, -1, 0
    s_movk_i32 s40, 640
    s_cselect_b32 s40, s40, 1280
    v_cndmask_b32 v21, v20, v19, vcc
    v_add_u32 v22, s40, v21
    ds_read_b64_tr_b16 v[32:33], v21 offset:5120
    ds_read_b64_tr_b16 v[34:35], v22 offset:5120
    ds_read_b64_tr_b16 v[36:37], v21 offset:5152
    ds_read_b64_tr_b16 v[38:39], v22 offset:5152
    ds_read_b64_tr_b16 v[40:41], v21 offset:5184
    ds_read_b64_tr_b16 v[42:43], v22 offset:5184
    ds_read_b64_tr_b16 v[44:45], v21 offset:5216
    ds_read_b64_tr_b16 v[46:47], v22 offset:5216
    ds_read_b64_tr_b16 v[48:49], v21 offset:5248
    ds_read_b64_tr_b16 v[50:51], v22 offset:5248
    s_mul_i32 s40, s43, 68
    s_add_u32 s39, s39, s40
    s_mul_i32 s39, s39, 5120
    s_add_u32 s39, s39, 6455296
    s_add_u32 s40, s39, 4096
    s_waitcnt lgkmcnt(0)
    buffer_store_dwordx4 v[32:35], v2, s[24:27], s39 offen offset:0 sc1
    buffer_store_dwordx4 v[36:39], v2, s[24:27], s39 offen offset:1024 sc1
    buffer_store_dwordx4 v[40:43], v2, s[24:27], s39 offen offset:2048 sc1
    buffer_store_dwordx4 v[44:47], v2, s[24:27], s39 offen offset:3072 sc1
    buffer_store_dwordx4 v[48:51], v2, s[24:27], s40 offen sc1
L_noT2_35:
    s_add_u32 s39, s36, 64
    s_cmp_ge_u32 s39, 68
    s_cbranch_scc1 L_noT_36
    s_sub_u32 s43, s37, 4
    s_cmp_lt_u32 s39, 20
    s_cselect_b32 s28, s52, s60
    s_cselect_b32 s29, s53, s61
    s_mov_b32 s40, 819200
    s_cselect_b32 s30, s40, 1966080
    s_mov_b32 s31, 0x00020000
    s_cselect_b32 s40, 0, 20
    s_sub_u32 s40, s39, s40
    s_mul_i32 s40, s40, 40960
    s_mul_i32 s41, s43, 160
    s_add_u32 s40, s40, s41
    s_mov_b32 m0, 137216
    s_nop 0
    buffer_load_dwordx4 v24, s[28:31], s40 offen lds
    s_mov_b32 m0, 138240
    s_nop 0
    buffer_load_dwordx4 v25, s[28:31], s40 offen lds
    s_mov_b32 m0, 139264
    s_nop 0
    buffer_load_dwordx4 v26, s[28:31], s40 offen lds
    s_mov_b32 m0, 140288
    s_nop 0
    buffer_load_dwordx4 v27, s[28:31], s40 offen lds
    s_mov_b32 m0, 141312
    s_nop 0
    buffer_load_dwordx4 v28, s[28:31], s40 offen lds
L_noT_36:
    s_barrier
    s_waitcnt vmcnt(15)
    s_add_u32 s39, s36, 32
    s_cmp_ge_u32 s39, 68
    s_cbranch_scc1 L_noT2_37
    s_mov_b32 s43, s37
    s_cmp_lt_u32 s39, 20
    s_cselect_b64 vcc, -1, 0
    s_movk_i32 s40, 640
    s_cselect_b32 s40, s40, 1280
    v_cndmask_b32 v21, v20, v19, vcc
    v_add_u32 v22, s40, v21
    ds_read_b64_tr_b16 v[32:33], v21 offset:10240
    ds_read_b64_tr_b16 v[34:35], v22 offset:10240
    ds_read_b64_tr_b16 v[36:37], v21 offset:10272
    ds_read_b64_tr_b16 v[38:39], v22 offset:10272
    ds_read_b64_tr_b16 v[40:41], v21 offset:10304
    ds_read_b64_tr_b16 v[42:43], v22 offset:10304
    ds_read_b64_tr_b16 v[44:45], v21 offset:10336
    ds_read_b64_tr_b16 v[46:47], v22 offset:10336
    ds_read_b64_tr_b16 v[48:49], v21 offset:10368
    ds_read_b64_tr_b16 v[50:51], v22 offset:10368
    s_mul_i32 s40, s43, 68
    s_add_u32 s39, s39, s40
    s_mul_i32 s39, s39, 5120
    s_add_u32 s39, s39, 6455296
    s_add_u32 s40, s39, 4096
    s_waitcnt lgkmcnt(0)
    buffer_store_dwordx4 v[32:35], v2, s[24:27], s39 offen offset:0 sc1
    buffer_store_dwordx4 v[36:39], v2, s[24:27], s39 offen offset:1024 sc1
    buffer_store_dwordx4 v[40:43], v2, s[24:27], s39 offen offset:2048 sc1
    buffer_store_dwordx4 v[44:47], v2, s[24:27], s39 offen offset:3072 sc1
    buffer_store_dwordx4 v[48:51], v2, s[24:27], s40 offen sc1
L_noT2_37:
    s_barrier
    s_waitcnt vmcnt(15)
    s_add_u32 s39, s36, 32
    s_cmp_ge_u32 s39, 68
    s_cbranch_scc1 L_noT2_38
    s_sub_u32 s43, s37, 4
    s_cmp_lt_u32 s39, 20
    s_cselect_b64 vcc, -1, 0
    s_movk_i32 s40, 640
    s_cselect_b32 s40, s40, 1280
    v_cndmask_b32 v21, v20, v19, vcc
    v_add_u32 v22, s40, v21
    ds_read_b64_tr_b16 v[32:33], v21 offset:15360
    ds_read_b64_tr_b16 v[34:35], v22 offset:15360
    ds_read_b64_tr_b16 v[36:37], v21 offset:15392
    ds_read_b64_tr_b16 v[38:39], v22 offset:15392
    ds_read_b64_tr_b16 v[40:41], v21 offset:15424
    ds_read_b64_tr_b16 v[42:43], v22 offset:15424
    ds_read_b64_tr_b16 v[44:45], v21 offset:15456
    ds_read_b64_tr_b16 v[46:47], v22 offset:15456
    ds_read_b64_tr_b16 v[48:49], v21 offset:15488
    ds_read_b64_tr_b16 v[50:51], v22 offset:15488
    s_mul_i32 s40, s43, 68
    s_add_u32 s39, s39, s40
    s_mul_i32 s39, s39, 5120
    s_add_u32 s39, s39, 6455296
    s_add_u32 s40, s39, 4096
    s_waitcnt lgkmcnt(0)
    buffer_store_dwordx4 v[32:35], v2, s[24:27], s39 offen offset:0 sc1
    buffer_store_dwordx4 v[36:39], v2, s[24:27], s39 offen offset:1024 sc1
    buffer_store_dwordx4 v[40:43], v2, s[24:27], s39 offen offset:2048 sc1
    buffer_store_dwordx4 v[44:47], v2, s[24:27], s39 offen offset:3072 sc1
    buffer_store_dwordx4 v[48:51], v2, s[24:27], s40 offen sc1
L_noT2_38:
    s_barrier
    s_waitcnt vmcnt(15)
    s_add_u32 s39, s36, 64
    s_cmp_ge_u32 s39, 68
    s_cbranch_scc1 L_noT2_39
    s_mov_b32 s43, s37
    s_cmp_lt_u32 s39, 20
    s_cselect_b64 vcc, -1, 0
    s_movk_i32 s40, 640
    s_cselect_b32 s40, s40, 1280
    v_cndmask_b32 v21, v20, v19, vcc
    v_add_u32 v22, s40, v21
    ds_read_b64_tr_b16 v[32:33], v21 offset:20480
    ds_read_b64_tr_b16 v[34:35], v22 offset:20480
    ds_read_b64_tr_b16 v[36:37], v21 offset:20512
    ds_read_b64_tr_b16 v[38:39], v22 offset:20512
    ds_read_b64_tr_b16 v[40:41], v21 offset:20544
    ds_read_b64_tr_b16 v[42:43], v22 offset:20544
    ds_read_b64_tr_b16 v[44:45], v21 offset:20576
    ds_read_b64_tr_b16 v[46:47], v22 offset:20576
    ds_read_b64_tr_b16 v[48:49], v21 offset:20608
    ds_read_b64_tr_b16 v[50:51], v22 offset:20608
    s_mul_i32 s40, s43, 68
    s_add_u32 s39, s39, s40
    s_mul_i32 s39, s39, 5120
    s_add_u32 s39, s39, 6455296
    s_add_u32 s40, s39, 4096
    s_waitcnt lgkmcnt(0)
    buffer_store_dwordx4 v[32:35], v2, s[24:27], s39 offen offset:0 sc1
    buffer_store_dwordx4 v[36:39], v2, s[24:27], s39 offen offset:1024 sc1
    buffer_store_dwordx4 v[40:43], v2, s[24:27], s39 offen offset:2048 sc1
    buffer_store_dwordx4 v[44:47], v2, s[24:27], s39 offen offset:3072 sc1
    buffer_store_dwordx4 v[48:51], v2, s[24:27], s40 offen sc1
L_noT2_39:
    s_barrier
    s_barrier
    s_waitcnt vmcnt(0)
    s_add_u32 s39, s36, 64
    s_cmp_ge_u32 s39, 68
    s_cbranch_scc1 L_noT2_40
    s_sub_u32 s43, s37, 4
    s_cmp_lt_u32 s39, 20
    s_cselect_b64 vcc, -1, 0
    s_movk_i32 s40, 640
    s_cselect_b32 s40, s40, 1280
    v_cndmask_b32 v21, v20, v19, vcc
    v_add_u32 v22, s40, v21
    ds_read_b64_tr_b16 v[32:33], v21 offset:0
    ds_read_b64_tr_b16 v[34:35], v22 offset:0
    ds_read_b64_tr_b16 v[36:37], v21 offset:32
    ds_read_b64_tr_b16 v[38:39], v22 offset:32
    ds_read_b64_tr_b16 v[40:41], v21 offset:64
    ds_read_b64_tr_b16 v[42:43], v22 offset:64
    ds_read_b64_tr_b16 v[44:45], v21 offset:96
    ds_read_b64_tr_b16 v[46:47], v22 offset:96
    ds_read_b64_tr_b16 v[48:49], v21 offset:128
    ds_read_b64_tr_b16 v[50:51], v22 offset:128
    s_mul_i32 s40, s43, 68
    s_add_u32 s39, s39, s40
    s_mul_i32 s39, s39, 5120
    s_add_u32 s39, s39, 6455296
    s_add_u32 s40, s39, 4096
    s_waitcnt lgkmcnt(0)
    buffer_store_dwordx4 v[32:35], v2, s[24:27], s39 offen offset:0 sc1
    buffer_store_dwordx4 v[36:39], v2, s[24:27], s39 offen offset:1024 sc1
    buffer_store_dwordx4 v[40:43], v2, s[24:27], s39 offen offset:2048 sc1
    buffer_store_dwordx4 v[44:47], v2, s[24:27], s39 offen offset:3072 sc1
    buffer_store_dwordx4 v[48:51], v2, s[24:27], s40 offen sc1
L_noT2_40:
    s_barrier
    s_barrier
    s_mov_b32 s59, 0
L_poll_41:
    v_lshlrev_b32 v252, 2, v1
    v_add_u32 v252, 11862016, v252
    buffer_load_dword v253, v252, s[24:27], 0 offen sc1
    s_waitcnt vmcnt(0)
    v_xor_b32 v253, s76, v253
    v_cmp_ne_u32 vcc, 0, v253
    s_add_u32 s59, s59, 1
    s_nop 3
    s_cmp_eq_u64 vcc, 0
    s_cbranch_scc1 L_pollok_42
    s_cmp_gt_u32 s59, 20000
    s_cbranch_scc1 L_pollok_42
    s_sleep 4
    s_branch L_poll_41
L_pollok_42:
    s_barrier
    s_mov_b32 m0, 118784
    s_mov_b32 s58, 36864
    buffer_load_dwordx4 v2, s[24:27], s58 offen sc1 lds
    s_mov_b32 m0, 122880
    s_mov_b32 s58, 40960
    buffer_load_dwordx4 v2, s[24:27], s58 offen sc1 lds
    s_mov_b32 m0, 126976
    s_mov_b32 s58, 45056
    buffer_load_dwordx4 v2, s[24:27], s58 offen sc1 lds
    s_mov_b32 m0, 131072
    s_mov_b32 s58, 49152
    buffer_load_dwordx4 v2, s[24:27], s58 offen sc1 lds
    s_mov_b32 m0, 135168
    s_mov_b32 s58, 53248
    buffer_load_dwordx4 v2, s[24:27], s58 offen sc1 lds
    s_mov_b32 m0, 139264
    s_mov_b32 s58, 57344
    buffer_load_dwordx4 v2, s[24:27], s58 offen sc1 lds
    s_mov_b32 m0, 143360
    s_mov_b32 s58, 61440
    buffer_load_dwordx4 v2, s[24:27], s58 offen sc1 lds
    s_mov_b32 m0, 147456
    s_mov_b32 s58, 65536
    buffer_load_dwordx4 v2, s[24:27], s58 offen sc1 lds
    s_mov_b32 m0, 151552
    s_mov_b32 s58, 69632
    buffer_load_dwordx4 v2, s[24:27], s58 offen sc1 lds
    s_mov_b32 m0, 155648
    s_mov_b32 s58, 73728
    buffer_load_dwordx4 v2, s[24:27], s58 offen sc1 lds
    s_mov_b32 m0, 159744
    s_mov_b32 s58, 77824
    buffer_load_dwordx4 v2, s[24:27], s58 offen sc1 lds
    s_barrier
    s_mov_b32 m0, 81920
    s_mov_b32 s58, 0
    buffer_load_dwordx4 v2, s[24:27], s58 offen sc1 lds
    s_mov_b32 m0, 86016
    s_mov_b32 s58, 4096
    buffer_load_dwordx4 v2, s[24:27], s58 offen sc1 lds
    s_mov_b32 m0, 90112
    s_mov_b32 s58, 8192
    buffer_load_dwordx4 v2, s[24:27], s58 offen sc1 lds
    s_mov_b32 m0, 94208
    s_mov_b32 s58, 12288
    buffer_load_dwordx4 v2, s[24:27], s58 offen sc1 lds
    s_mov_b32 m0, 98304
    s_mov_b32 s58, 16384
    buffer_load_dwordx4 v2, s[24:27], s58 offen sc1 lds
    s_barrier
    s_mov_b32 m0, 100352
    s_mov_b32 s58, 18432
    buffer_load_dwordx4 v2, s[24:27], s58 offen sc1 lds
    s_mov_b32 m0, 104448
    s_mov_b32 s58, 22528
    buffer_load_dwordx4 v2, s[24:27], s58 offen sc1 lds
    s_mov_b32 m0, 108544
    s_mov_b32 s58, 26624
    buffer_load_dwordx4 v2, s[24:27], s58 offen sc1 lds
    s_mov_b32 m0, 112640
    s_mov_b32 s58, 30720
    buffer_load_dwordx4 v2, s[24:27], s58 offen sc1 lds
    s_mov_b32 m0, 116736
    s_mov_b32 s58, 34816
    buffer_load_dwordx4 v2, s[24:27], s58 offen sc1 lds
L_parallel_sum__grouped_kv_mqa__dense_activation_squared_relu__prompt_kernel_svcjoin:
    s_waitcnt vmcnt(0)
    s_barrier
    s_mov_b32 s59, 0
L_poll_43:
    v_lshlrev_b32 v252, 2, v1
    v_add_u32 v252, 11862272, v252
    buffer_load_dword v253, v252, s[24:27], 0 offen sc1
    s_waitcnt vmcnt(0)
    v_xor_b32 v253, s76, v253
    v_cmp_ne_u32 vcc, 0, v253
    s_add_u32 s59, s59, 1
    s_nop 3
    s_cmp_eq_u64 vcc, 0
    s_cbranch_scc1 L_pollok_44
    s_cmp_gt_u32 s59, 20000
    s_cbranch_scc1 L_pollok_44
    s_sleep 4
    s_branch L_poll_43
L_pollok_44:
    s_mov_b32 m0, 0
    s_mov_b32 s58, 81920
    buffer_load_dwordx4 v2, s[24:27], s58 offen sc1 lds
    s_mov_b32 m0, 4096
    s_mov_b32 s58, 86016
    buffer_load_dwordx4 v2, s[24:27], s58 offen sc1 lds
    s_mov_b32 m0, 8192
    s_mov_b32 s58, 90112
    buffer_load_dwordx4 v2, s[24:27], s58 offen sc1 lds
    s_mov_b32 m0, 12288
    s_mov_b32 s58, 94208
    buffer_load_dwordx4 v2, s[24:27], s58 offen sc1 lds
    s_mov_b32 m0, 16384
    s_mov_b32 s58, 98304
    buffer_load_dwordx4 v2, s[24:27], s58 offen sc1 lds
    s_mov_b32 m0, 20480
    s_mov_b32 s58, 102400
    buffer_load_dwordx4 v2, s[24:27], s58 offen sc1 lds
    s_mov_b32 m0, 24576
    s_mov_b32 s58, 106496
    buffer_load_dwordx4 v2, s[24:27], s58 offen sc1 lds
    s_mov_b32 m0, 28672
    s_mov_b32 s58, 110592
    buffer_load_dwordx4 v2, s[24:27], s58 offen sc1 lds
    s_mov_b32 m0, 32768
    s_mov_b32 s58, 114688
    buffer_load_dwordx4 v2, s[24:27], s58 offen sc1 lds
    s_mov_b32 m0, 36864
    s_mov_b32 s58, 118784
    buffer_load_dwordx4 v2, s[24:27], s58 offen sc1 lds
    s_mov_b32 m0, 40960
    s_mov_b32 s58, 122880
    buffer_load_dwordx4 v2, s[24:27], s58 offen sc1 lds
    s_mov_b32 m0, 45056
    s_mov_b32 s58, 126976
    buffer_load_dwordx4 v2, s[24:27], s58 offen sc1 lds
    s_mov_b32 m0, 49152
    s_mov_b32 s58, 131072
    buffer_load_dwordx4 v2, s[24:27], s58 offen sc1 lds
    s_mov_b32 m0, 53248
    s_mov_b32 s58, 135168
    buffer_load_dwordx4 v2, s[24:27], s58 offen sc1 lds
    s_mov_b32 m0, 57344
    s_mov_b32 s58, 139264
    buffer_load_dwordx4 v2, s[24:27], s58 offen sc1 lds
    s_mov_b32 m0, 61440
    s_mov_b32 s58, 143360
    buffer_load_dwordx4 v2, s[24:27], s58 offen sc1 lds
    s_mov_b32 m0, 65536
    s_mov_b32 s58, 147456
    buffer_load_dwordx4 v2, s[24:27], s58 offen sc1 lds
    s_mov_b32 m0, 69632
    s_mov_b32 s58, 151552
    buffer_load_dwordx4 v2, s[24:27], s58 offen sc1 lds
    s_mov_b32 m0, 73728
    s_mov_b32 s58, 155648
    buffer_load_dwordx4 v2, s[24:27], s58 offen sc1 lds
    s_mov_b32 m0, 77824
    s_mov_b32 s58, 159744
    buffer_load_dwordx4 v2, s[24:27], s58 offen sc1 lds
    s_barrier
    s_lshl_b32 s58, s36, 6
    s_add_u32 s58, s58, s37
    s_lshl_b32 s58, s58, 2
    s_add_u32 s58, s58, 11866112
    v_mov_b32 v252, 0
    v_mov_b32 v253, s76
    s_mov_b64 exec, 1
    buffer_store_dword v253, v252, s[24:27], s58 offen sc1
    s_mov_b64 exec, -1
    s_lshl_b32 s58, s37, 6
    s_add_u32 s58, s58, s36
    s_lshl_b32 s58, s58, 2
    s_add_u32 s58, s58, 11878400
    v_mov_b32 v252, 0
    v_mov_b32 v253, s76
    s_mov_b64 exec, 1
    buffer_store_dword v253, v252, s[24:27], s58 offen sc1
    s_mov_b64 exec, -1
    s_waitcnt vmcnt(0)
    s_barrier
    s_setprio 0
    s_mov_b32 s59, 0
L_poll_45:
    s_or_b32 s40, s37, 4
    s_lshl_b32 s40, s40, 8
    s_add_u32 s40, s40, 11878400
    s_lshl_b32 s39, s36, 8
    s_add_u32 s39, s39, 11866112
    v_lshlrev_b32 v252, 2, v1
    v_add_u32 v252, s40, v252
    v_and_b32 v255, 7, v1
    v_lshlrev_b32 v255, 2, v255
    v_add_u32 v255, s39, v255
    v_cmp_gt_u32 vcc, 32, v1
    s_nop 1
    v_cndmask_b32 v252, v255, v252, vcc
    buffer_load_dword v253, v252, s[24:27], 0 offen sc1
    s_waitcnt vmcnt(0)
    v_xor_b32 v253, s76, v253
    v_cmp_ne_u32 vcc, 0, v253
    s_add_u32 s59, s59, 1
    s_nop 3
    s_cmp_eq_u64 vcc, 0
    s_cbranch_scc1 L_pollok_46
    s_cmp_gt_u32 s59, 20000
    s_cbranch_scc1 L_pollok_46
    s_sleep 4
    s_branch L_poll_45
L_pollok_46:
    s_sub_u32 s42, s38, 4
    s_mul_i32 s54, s37, 68
    s_add_u32 s54, s54, s42
    s_add_u32 s54, s54, 20
    s_mul_i32 s54, s54, 5120
    s_add_u32 s54, s54, 6455296
    s_lshl_b32 s39, s36, 2
    s_add_u32 s39, s39, 0
    s_mul_i32 s39, s39, 48
    s_add_u32 s39, s39, s42
    s_lshl_b32 s39, s39, 10
    s_add_u32 s44, s39, 163840
    s_lshl_b32 s39, s36, 2
    s_add_u32 s39, s39, 1
    s_mul_i32 s39, s39, 48
    s_add_u32 s39, s39, s42
    s_lshl_b32 s39, s39, 10
    s_add_u32 s45, s39, 163840
    s_lshl_b32 s39, s36, 2
    s_add_u32 s39, s39, 2
    s_mul_i32 s39, s39, 48
    s_add_u32 s39, s39, s42
    s_lshl_b32 s39, s39, 10
    s_add_u32 s46, s39, 163840
    s_lshl_b32 s39, s36, 2
    s_add_u32 s39, s39, 3
    s_mul_i32 s39, s39, 48
    s_add_u32 s39, s39, s42
    s_lshl_b32 s39, s39, 10
    s_add_u32 s47, s39, 163840
    s_add_u32 s55, s54, 4096
    buffer_load_dwordx4 v[88:91], v2, s[24:27], s54 offen offset:0 sc1
    buffer_load_dwordx4 v[92:95], v2, s[24:27], s54 offen offset:1024 sc1
    buffer_load_dwordx4 v[96:99], v2, s[24:27], s54 offen offset:2048 sc1
    buffer_load_dwordx4 v[100:103], v2, s[24:27], s54 offen offset:3072 sc1
    buffer_load_dwordx4 v[104:107], v2, s[24:27], s55 offen sc1
    buffer_load_dwordx4 v[108:111], v2, s[24:27], s44 offen sc1
    buffer_load_dwordx4 v[112:115], v2, s[24:27], s45 offen sc1
    buffer_load_dwordx4 v[116:119], v2, s[24:27], s46 offen sc1
    buffer_load_dwordx4 v[120:123], v2, s[24:27], s47 offen sc1
    s_add_u32 s54, s54, 20480
    s_add_u32 s44, s44, 4096
    s_add_u32 s45, s45, 4096
    s_add_u32 s46, s46, 4096
    s_add_u32 s47, s47, 4096
    s_add_u32 s55, s54, 4096
    buffer_load_dwordx4 v[124:127], v2, s[24:27], s54 offen offset:0 sc1
    buffer_load_dwordx4 v[128:131], v2, s[24:27], s54 offen offset:1024 sc1
    buffer_load_dwordx4 v[132:135], v2, s[24:27], s54 offen offset:2048 sc1
    buffer_load_dwordx4 v[136:139], v2, s[24:27], s54 offen offset:3072 sc1
    buffer_load_dwordx4 v[140:143], v2, s[24:27], s55 offen sc1
    buffer_load_dwordx4 v[144:147], v2, s[24:27], s44 offen sc1
    buffer_load_dwordx4 v[148:151], v2, s[24:27], s45 offen sc1
    buffer_load_dwordx4 v[152:155], v2, s[24:27], s46 offen sc1
    buffer_load_dwordx4 v[156:159], v2, s[24:27], s47 offen sc1
    s_add_u32 s54, s54, 20480
    s_add_u32 s44, s44, 4096
    s_add_u32 s45, s45, 4096
    s_add_u32 s46, s46, 4096
    s_add_u32 s47, s47, 4096
    s_add_u32 s55, s54, 4096
    buffer_load_dwordx4 v[160:163], v2, s[24:27], s54 offen offset:0 sc1
    buffer_load_dwordx4 v[164:167], v2, s[24:27], s54 offen offset:1024 sc1
    buffer_load_dwordx4 v[168:171], v2, s[24:27], s54 offen offset:2048 sc1
    buffer_load_dwordx4 v[172:175], v2, s[24:27], s54 offen offset:3072 sc1
    buffer_load_dwordx4 v[176:179], v2, s[24:27], s55 offen sc1
    buffer_load_dwordx4 v[180:183], v2, s[24:27], s44 offen sc1
    buffer_load_dwordx4 v[184:187], v2, s[24:27], s45 offen sc1
    buffer_load_dwordx4 v[188:191], v2, s[24:27], s46 offen sc1
    buffer_load_dwordx4 v[192:195], v2, s[24:27], s47 offen sc1
    s_add_u32 s54, s54, 20480
    s_add_u32 s44, s44, 4096
    s_add_u32 s45, s45, 4096
    s_add_u32 s46, s46, 4096
    s_add_u32 s47, s47, 4096
    v_mov_b32 v8, 0
    v_mov_b32 v9, 0
    v_mov_b32 v10, 0
    v_mov_b32 v11, 0
    v_mov_b32 v12, 0
    v_mov_b32 v13, 0
    v_mov_b32 v14, 0
    v_mov_b32 v15, 0
    v_mov_b32 v16, 0
    v_mov_b32 v17, 0
    v_mov_b32 v18, 0
    v_mov_b32 v19, 0
    v_mov_b32 v20, 0
    v_mov_b32 v21, 0
    v_mov_b32 v22, 0
    v_mov_b32 v23, 0
    v_mov_b32 v24, 0
    v_mov_b32 v25, 0
    v_mov_b32 v26, 0
    v_mov_b32 v27, 0
    v_mov_b32 v28, 0
    v_mov_b32 v29, 0
    v_mov_b32 v30, 0
    v_mov_b32 v31, 0
    v_mov_b32 v32, 0
    v_mov_b32 v33, 0
    v_mov_b32 v34, 0
    v_mov_b32 v35, 0
    v_mov_b32 v36, 0
    v_mov_b32 v37, 0
    v_mov_b32 v38, 0
    v_mov_b32 v39, 0
    v_mov_b32 v40, 0
    v_mov_b32 v41, 0
    v_mov_b32 v42, 0
    v_mov_b32 v43, 0
    v_mov_b32 v44, 0
    v_mov_b32 v45, 0
    v_mov_b32 v46, 0
    v_mov_b32 v47, 0
    v_mov_b32 v48, 0
    v_mov_b32 v49, 0
    v_mov_b32 v50, 0
    v_mov_b32 v51, 0
    v_mov_b32 v52, 0
    v_mov_b32 v53, 0
    v_mov_b32 v54, 0
    v_mov_b32 v55, 0
    v_mov_b32 v56, 0
    v_mov_b32 v57, 0
    v_mov_b32 v58, 0
    v_mov_b32 v59, 0
    v_mov_b32 v60, 0
    v_mov_b32 v61, 0
    v_mov_b32 v62, 0
    v_mov_b32 v63, 0
    v_mov_b32 v64, 0
    v_mov_b32 v65, 0
    v_mov_b32 v66, 0
    v_mov_b32 v67, 0
    v_mov_b32 v68, 0
    v_mov_b32 v69, 0
    v_mov_b32 v70, 0
    v_mov_b32 v71, 0
    v_mov_b32 v72, 0
    v_mov_b32 v73, 0
    v_mov_b32 v74, 0
    v_mov_b32 v75, 0
    v_mov_b32 v76, 0
    v_mov_b32 v77, 0
    v_mov_b32 v78, 0
    v_mov_b32 v79, 0
    v_mov_b32 v80, 0
    v_mov_b32 v81, 0
    v_mov_b32 v82, 0
    v_mov_b32 v83, 0
    v_mov_b32 v84, 0
    v_mov_b32 v85, 0
    v_mov_b32 v86, 0
    v_mov_b32 v87, 0
    s_add_u32 s55, s54, 4096
    buffer_load_dwordx4 v[196:199], v2, s[24:27], s54 offen offset:0 sc1
    buffer_load_dwordx4 v[200:203], v2, s[24:27], s54 offen offset:1024 sc1
    buffer_load_dwordx4 v[204:207], v2, s[24:27], s54 offen offset:2048 sc1
    buffer_load_dwordx4 v[208:211], v2, s[24:27], s54 offen offset:3072 sc1
    buffer_load_dwordx4 v[212:215], v2, s[24:27], s55 offen sc1
    buffer_load_dwordx4 v[216:219], v2, s[24:27], s44 offen sc1
    buffer_load_dwordx4 v[220:223], v2, s[24:27], s45 offen sc1
    buffer_load_dwordx4 v[224:227], v2, s[24:27], s46 offen sc1
    buffer_load_dwordx4 v[228:231], v2, s[24:27], s47 offen sc1
    s_add_u32 s54, s54, 20480
    s_add_u32 s44, s44, 4096
    s_add_u32 s45, s45, 4096
    s_add_u32 s46, s46, 4096
    s_add_u32 s47, s47, 4096
    s_waitcnt vmcnt(27)
    v_mfma_f32_16x16x32_bf16 v[8:11], v[88:91], v[108:111], v[8:11]
    v_mfma_f32_16x16x32_bf16 v[12:15], v[92:95], v[108:111], v[12:15]
    v_mfma_f32_16x16x32_bf16 v[16:19], v[96:99], v[108:111], v[16:19]
    v_mfma_f32_16x16x32_bf16 v[20:23], v[100:103], v[108:111], v[20:23]
    v_mfma_f32_16x16x32_bf16 v[24:27], v[104:107], v[108:111], v[24:27]
    v_mfma_f32_16x16x32_bf16 v[28:31], v[88:91], v[112:115], v[28:31]
    v_mfma_f32_16x16x32_bf16 v[32:35], v[92:95], v[112:115], v[32:35]
    v_mfma_f32_16x16x32_bf16 v[36:39], v[96:99], v[112:115], v[36:39]
    v_mfma_f32_16x16x32_bf16 v[40:43], v[100:103], v[112:115], v[40:43]
    v_mfma_f32_16x16x32_bf16 v[44:47], v[104:107], v[112:115], v[44:47]
    v_mfma_f32_16x16x32_bf16 v[48:51], v[88:91], v[116:119], v[48:51]
    v_mfma_f32_16x16x32_bf16 v[52:55], v[92:95], v[116:119], v[52:55]
    v_mfma_f32_16x16x32_bf16 v[56:59], v[96:99], v[116:119], v[56:59]
    v_mfma_f32_16x16x32_bf16 v[60:63], v[100:103], v[116:119], v[60:63]
    v_mfma_f32_16x16x32_bf16 v[64:67], v[104:107], v[116:119], v[64:67]
    v_mfma_f32_16x16x32_bf16 v[68:71], v[88:91], v[120:123], v[68:71]
    v_mfma_f32_16x16x32_bf16 v[72:75], v[92:95], v[120:123], v[72:75]
    v_mfma_f32_16x16x32_bf16 v[76:79], v[96:99], v[120:123], v[76:79]
    v_mfma_f32_16x16x32_bf16 v[80:83], v[100:103], v[120:123], v[80:83]
    v_mfma_f32_16x16x32_bf16 v[84:87], v[104:107], v[120:123], v[84:87]
    s_add_u32 s55, s54, 4096
    buffer_load_dwordx4 v[88:91], v2, s[24:27], s54 offen offset:0 sc1
    buffer_load_dwordx4 v[92:95], v2, s[24:27], s54 offen offset:1024 sc1
    buffer_load_dwordx4 v[96:99], v2, s[24:27], s54 offen offset:2048 sc1
    buffer_load_dwordx4 v[100:103], v2, s[24:27], s54 offen offset:3072 sc1
    buffer_load_dwordx4 v[104:107], v2, s[24:27], s55 offen sc1
    buffer_load_dwordx4 v[108:111], v2, s[24:27], s44 offen sc1
    buffer_load_dwordx4 v[112:115], v2, s[24:27], s45 offen sc1
    buffer_load_dwordx4 v[116:119], v2, s[24:27], s46 offen sc1
    buffer_load_dwordx4 v[120:123], v2, s[24:27], s47 offen sc1
    s_add_u32 s54, s54, 20480
    s_add_u32 s44, s44, 4096
    s_add_u32 s45, s45, 4096
    s_add_u32 s46, s46, 4096
    s_add_u32 s47, s47, 4096
    s_waitcnt vmcnt(27)
    v_mfma_f32_16x16x32_bf16 v[8:11], v[124:127], v[144:147], v[8:11]
    v_mfma_f32_16x16x32_bf16 v[12:15], v[128:131], v[144:147], v[12:15]
    v_mfma_f32_16x16x32_bf16 v[16:19], v[132:135], v[144:147], v[16:19]
    v_mfma_f32_16x16x32_bf16 v[20:23], v[136:139], v[144:147], v[20:23]
    v_mfma_f32_16x16x32_bf16 v[24:27], v[140:143], v[144:147], v[24:27]
    v_mfma_f32_16x16x32_bf16 v[28:31], v[124:127], v[148:151], v[28:31]
    v_mfma_f32_16x16x32_bf16 v[32:35], v[128:131], v[148:151], v[32:35]
    v_mfma_f32_16x16x32_bf16 v[36:39], v[132:135], v[148:151], v[36:39]
    v_mfma_f32_16x16x32_bf16 v[40:43], v[136:139], v[148:151], v[40:43]
    v_mfma_f32_16x16x32_bf16 v[44:47], v[140:143], v[148:151], v[44:47]
    v_mfma_f32_16x16x32_bf16 v[48:51], v[124:127], v[152:155], v[48:51]
    v_mfma_f32_16x16x32_bf16 v[52:55], v[128:131], v[152:155], v[52:55]
    v_mfma_f32_16x16x32_bf16 v[56:59], v[132:135], v[152:155], v[56:59]
    v_mfma_f32_16x16x32_bf16 v[60:63], v[136:139], v[152:155], v[60:63]
    v_mfma_f32_16x16x32_bf16 v[64:67], v[140:143], v[152:155], v[64:67]
    v_mfma_f32_16x16x32_bf16 v[68:71], v[124:127], v[156:159], v[68:71]
    v_mfma_f32_16x16x32_bf16 v[72:75], v[128:131], v[156:159], v[72:75]
    v_mfma_f32_16x16x32_bf16 v[76:79], v[132:135], v[156:159], v[76:79]
    v_mfma_f32_16x16x32_bf16 v[80:83], v[136:139], v[156:159], v[80:83]
    v_mfma_f32_16x16x32_bf16 v[84:87], v[140:143], v[156:159], v[84:87]
    s_add_u32 s55, s54, 4096
    buffer_load_dwordx4 v[124:127], v2, s[24:27], s54 offen offset:0 sc1
    buffer_load_dwordx4 v[128:131], v2, s[24:27], s54 offen offset:1024 sc1
    buffer_load_dwordx4 v[132:135], v2, s[24:27], s54 offen offset:2048 sc1
    buffer_load_dwordx4 v[136:139], v2, s[24:27], s54 offen offset:3072 sc1
    buffer_load_dwordx4 v[140:143], v2, s[24:27], s55 offen sc1
    buffer_load_dwordx4 v[144:147], v2, s[24:27], s44 offen sc1
    buffer_load_dwordx4 v[148:151], v2, s[24:27], s45 offen sc1
    buffer_load_dwordx4 v[152:155], v2, s[24:27], s46 offen sc1
    buffer_load_dwordx4 v[156:159], v2, s[24:27], s47 offen sc1
    s_add_u32 s54, s54, 20480
    s_add_u32 s44, s44, 4096
    s_add_u32 s45, s45, 4096
    s_add_u32 s46, s46, 4096
    s_add_u32 s47, s47, 4096
    s_waitcnt vmcnt(27)
    v_mfma_f32_16x16x32_bf16 v[8:11], v[160:163], v[180:183], v[8:11]
    v_mfma_f32_16x16x32_bf16 v[12:15], v[164:167], v[180:183], v[12:15]
    v_mfma_f32_16x16x32_bf16 v[16:19], v[168:171], v[180:183], v[16:19]
    v_mfma_f32_16x16x32_bf16 v[20:23], v[172:175], v[180:183], v[20:23]
    v_mfma_f32_16x16x32_bf16 v[24:27], v[176:179], v[180:183], v[24:27]
    v_mfma_f32_16x16x32_bf16 v[28:31], v[160:163], v[184:187], v[28:31]
    v_mfma_f32_16x16x32_bf16 v[32:35], v[164:167], v[184:187], v[32:35]
    v_mfma_f32_16x16x32_bf16 v[36:39], v[168:171], v[184:187], v[36:39]
    v_mfma_f32_16x16x32_bf16 v[40:43], v[172:175], v[184:187], v[40:43]
    v_mfma_f32_16x16x32_bf16 v[44:47], v[176:179], v[184:187], v[44:47]
    v_mfma_f32_16x16x32_bf16 v[48:51], v[160:163], v[188:191], v[48:51]
    v_mfma_f32_16x16x32_bf16 v[52:55], v[164:167], v[188:191], v[52:55]
    v_mfma_f32_16x16x32_bf16 v[56:59], v[168:171], v[188:191], v[56:59]
    v_mfma_f32_16x16x32_bf16 v[60:63], v[172:175], v[188:191], v[60:63]
    v_mfma_f32_16x16x32_bf16 v[64:67], v[176:179], v[188:191], v[64:67]
    v_mfma_f32_16x16x32_bf16 v[68:71], v[160:163], v[192:195], v[68:71]
    v_mfma_f32_16x16x32_bf16 v[72:75], v[164:167], v[192:195], v[72:75]
    v_mfma_f32_16x16x32_bf16 v[76:79], v[168:171], v[192:195], v[76:79]
    v_mfma_f32_16x16x32_bf16 v[80:83], v[172:175], v[192:195], v[80:83]
    v_mfma_f32_16x16x32_bf16 v[84:87], v[176:179], v[192:195], v[84:87]
    s_add_u32 s55, s54, 4096
    buffer_load_dwordx4 v[160:163], v2, s[24:27], s54 offen offset:0 sc1
    buffer_load_dwordx4 v[164:167], v2, s[24:27], s54 offen offset:1024 sc1
    buffer_load_dwordx4 v[168:171], v2, s[24:27], s54 offen offset:2048 sc1
    buffer_load_dwordx4 v[172:175], v2, s[24:27], s54 offen offset:3072 sc1
    buffer_load_dwordx4 v[176:179], v2, s[24:27], s55 offen sc1
    buffer_load_dwordx4 v[180:183], v2, s[24:27], s44 offen sc1
    buffer_load_dwordx4 v[184:187], v2, s[24:27], s45 offen sc1
    buffer_load_dwordx4 v[188:191], v2, s[24:27], s46 offen sc1
    buffer_load_dwordx4 v[192:195], v2, s[24:27], s47 offen sc1
    s_add_u32 s54, s54, 20480
    s_add_u32 s44, s44, 4096
    s_add_u32 s45, s45, 4096
    s_add_u32 s46, s46, 4096
    s_add_u32 s47, s47, 4096
    s_waitcnt vmcnt(27)
    v_mfma_f32_16x16x32_bf16 v[8:11], v[196:199], v[216:219], v[8:11]
    v_mfma_f32_16x16x32_bf16 v[12:15], v[200:203], v[216:219], v[12:15]
    v_mfma_f32_16x16x32_bf16 v[16:19], v[204:207], v[216:219], v[16:19]
    v_mfma_f32_16x16x32_bf16 v[20:23], v[208:211], v[216:219], v[20:23]
    v_mfma_f32_16x16x32_bf16 v[24:27], v[212:215], v[216:219], v[24:27]
    v_mfma_f32_16x16x32_bf16 v[28:31], v[196:199], v[220:223], v[28:31]
    v_mfma_f32_16x16x32_bf16 v[32:35], v[200:203], v[220:223], v[32:35]
    v_mfma_f32_16x16x32_bf16 v[36:39], v[204:207], v[220:223], v[36:39]
    v_mfma_f32_16x16x32_bf16 v[40:43], v[208:211], v[220:223], v[40:43]
    v_mfma_f32_16x16x32_bf16 v[44:47], v[212:215], v[220:223], v[44:47]
    v_mfma_f32_16x16x32_bf16 v[48:51], v[196:199], v[224:227], v[48:51]
    v_mfma_f32_16x16x32_bf16 v[52:55], v[200:203], v[224:227], v[52:55]
    v_mfma_f32_16x16x32_bf16 v[56:59], v[204:207], v[224:227], v[56:59]
    v_mfma_f32_16x16x32_bf16 v[60:63], v[208:211], v[224:227], v[60:63]
    v_mfma_f32_16x16x32_bf16 v[64:67], v[212:215], v[224:227], v[64:67]
    v_mfma_f32_16x16x32_bf16 v[68:71], v[196:199], v[228:231], v[68:71]
    v_mfma_f32_16x16x32_bf16 v[72:75], v[200:203], v[228:231], v[72:75]
    v_mfma_f32_16x16x32_bf16 v[76:79], v[204:207], v[228:231], v[76:79]
    v_mfma_f32_16x16x32_bf16 v[80:83], v[208:211], v[228:231], v[80:83]
    v_mfma_f32_16x16x32_bf16 v[84:87], v[212:215], v[228:231], v[84:87]
    s_add_u32 s55, s54, 4096
    buffer_load_dwordx4 v[196:199], v2, s[24:27], s54 offen offset:0 sc1
    buffer_load_dwordx4 v[200:203], v2, s[24:27], s54 offen offset:1024 sc1
    buffer_load_dwordx4 v[204:207], v2, s[24:27], s54 offen offset:2048 sc1
    buffer_load_dwordx4 v[208:211], v2, s[24:27], s54 offen offset:3072 sc1
    buffer_load_dwordx4 v[212:215], v2, s[24:27], s55 offen sc1
    buffer_load_dwordx4 v[216:219], v2, s[24:27], s44 offen sc1
    buffer_load_dwordx4 v[220:223], v2, s[24:27], s45 offen sc1
    buffer_load_dwordx4 v[224:227], v2, s[24:27], s46 offen sc1
    buffer_load_dwordx4 v[228:231], v2, s[24:27], s47 offen sc1
    s_add_u32 s54, s54, 20480
    s_add_u32 s44, s44, 4096
    s_add_u32 s45, s45, 4096
    s_add_u32 s46, s46, 4096
    s_add_u32 s47, s47, 4096
    s_waitcnt vmcnt(27)
    v_mfma_f32_16x16x32_bf16 v[8:11], v[88:91], v[108:111], v[8:11]
    v_mfma_f32_16x16x32_bf16 v[12:15], v[92:95], v[108:111], v[12:15]
    v_mfma_f32_16x16x32_bf16 v[16:19], v[96:99], v[108:111], v[16:19]
    v_mfma_f32_16x16x32_bf16 v[20:23], v[100:103], v[108:111], v[20:23]
    v_mfma_f32_16x16x32_bf16 v[24:27], v[104:107], v[108:111], v[24:27]
    v_mfma_f32_16x16x32_bf16 v[28:31], v[88:91], v[112:115], v[28:31]
    v_mfma_f32_16x16x32_bf16 v[32:35], v[92:95], v[112:115], v[32:35]
    v_mfma_f32_16x16x32_bf16 v[36:39], v[96:99], v[112:115], v[36:39]
    v_mfma_f32_16x16x32_bf16 v[40:43], v[100:103], v[112:115], v[40:43]
    v_mfma_f32_16x16x32_bf16 v[44:47], v[104:107], v[112:115], v[44:47]
    v_mfma_f32_16x16x32_bf16 v[48:51], v[88:91], v[116:119], v[48:51]
    v_mfma_f32_16x16x32_bf16 v[52:55], v[92:95], v[116:119], v[52:55]
    v_mfma_f32_16x16x32_bf16 v[56:59], v[96:99], v[116:119], v[56:59]
    v_mfma_f32_16x16x32_bf16 v[60:63], v[100:103], v[116:119], v[60:63]
    v_mfma_f32_16x16x32_bf16 v[64:67], v[104:107], v[116:119], v[64:67]
    v_mfma_f32_16x16x32_bf16 v[68:71], v[88:91], v[120:123], v[68:71]
    v_mfma_f32_16x16x32_bf16 v[72:75], v[92:95], v[120:123], v[72:75]
    v_mfma_f32_16x16x32_bf16 v[76:79], v[96:99], v[120:123], v[76:79]
    v_mfma_f32_16x16x32_bf16 v[80:83], v[100:103], v[120:123], v[80:83]
    v_mfma_f32_16x16x32_bf16 v[84:87], v[104:107], v[120:123], v[84:87]
    s_add_u32 s55, s54, 4096
    buffer_load_dwordx4 v[88:91], v2, s[24:27], s54 offen offset:0 sc1
    buffer_load_dwordx4 v[92:95], v2, s[24:27], s54 offen offset:1024 sc1
    buffer_load_dwordx4 v[96:99], v2, s[24:27], s54 offen offset:2048 sc1
    buffer_load_dwordx4 v[100:103], v2, s[24:27], s54 offen offset:3072 sc1
    buffer_load_dwordx4 v[104:107], v2, s[24:27], s55 offen sc1
    buffer_load_dwordx4 v[108:111], v2, s[24:27], s44 offen sc1
    buffer_load_dwordx4 v[112:115], v2, s[24:27], s45 offen sc1
    buffer_load_dwordx4 v[116:119], v2, s[24:27], s46 offen sc1
    buffer_load_dwordx4 v[120:123], v2, s[24:27], s47 offen sc1
    s_add_u32 s54, s54, 20480
    s_add_u32 s44, s44, 4096
    s_add_u32 s45, s45, 4096
    s_add_u32 s46, s46, 4096
    s_add_u32 s47, s47, 4096
    s_waitcnt vmcnt(27)
    v_mfma_f32_16x16x32_bf16 v[8:11], v[124:127], v[144:147], v[8:11]
    v_mfma_f32_16x16x32_bf16 v[12:15], v[128:131], v[144:147], v[12:15]
    v_mfma_f32_16x16x32_bf16 v[16:19], v[132:135], v[144:147], v[16:19]
    v_mfma_f32_16x16x32_bf16 v[20:23], v[136:139], v[144:147], v[20:23]
    v_mfma_f32_16x16x32_bf16 v[24:27], v[140:143], v[144:147], v[24:27]
    v_mfma_f32_16x16x32_bf16 v[28:31], v[124:127], v[148:151], v[28:31]
    v_mfma_f32_16x16x32_bf16 v[32:35], v[128:131], v[148:151], v[32:35]
    v_mfma_f32_16x16x32_bf16 v[36:39], v[132:135], v[148:151], v[36:39]
    v_mfma_f32_16x16x32_bf16 v[40:43], v[136:139], v[148:151], v[40:43]
    v_mfma_f32_16x16x32_bf16 v[44:47], v[140:143], v[148:151], v[44:47]
    v_mfma_f32_16x16x32_bf16 v[48:51], v[124:127], v[152:155], v[48:51]
    v_mfma_f32_16x16x32_bf16 v[52:55], v[128:131], v[152:155], v[52:55]
    v_mfma_f32_16x16x32_bf16 v[56:59], v[132:135], v[152:155], v[56:59]
    v_mfma_f32_16x16x32_bf16 v[60:63], v[136:139], v[152:155], v[60:63]
    v_mfma_f32_16x16x32_bf16 v[64:67], v[140:143], v[152:155], v[64:67]
    v_mfma_f32_16x16x32_bf16 v[68:71], v[124:127], v[156:159], v[68:71]
    v_mfma_f32_16x16x32_bf16 v[72:75], v[128:131], v[156:159], v[72:75]
    v_mfma_f32_16x16x32_bf16 v[76:79], v[132:135], v[156:159], v[76:79]
    v_mfma_f32_16x16x32_bf16 v[80:83], v[136:139], v[156:159], v[80:83]
    v_mfma_f32_16x16x32_bf16 v[84:87], v[140:143], v[156:159], v[84:87]
    s_add_u32 s55, s54, 4096
    buffer_load_dwordx4 v[124:127], v2, s[24:27], s54 offen offset:0 sc1
    buffer_load_dwordx4 v[128:131], v2, s[24:27], s54 offen offset:1024 sc1
    buffer_load_dwordx4 v[132:135], v2, s[24:27], s54 offen offset:2048 sc1
    buffer_load_dwordx4 v[136:139], v2, s[24:27], s54 offen offset:3072 sc1
    buffer_load_dwordx4 v[140:143], v2, s[24:27], s55 offen sc1
    buffer_load_dwordx4 v[144:147], v2, s[24:27], s44 offen sc1
    buffer_load_dwordx4 v[148:151], v2, s[24:27], s45 offen sc1
    buffer_load_dwordx4 v[152:155], v2, s[24:27], s46 offen sc1
    buffer_load_dwordx4 v[156:159], v2, s[24:27], s47 offen sc1
    s_add_u32 s54, s54, 20480
    s_add_u32 s44, s44, 4096
    s_add_u32 s45, s45, 4096
    s_add_u32 s46, s46, 4096
    s_add_u32 s47, s47, 4096
    s_waitcnt vmcnt(27)
    v_mfma_f32_16x16x32_bf16 v[8:11], v[160:163], v[180:183], v[8:11]
    v_mfma_f32_16x16x32_bf16 v[12:15], v[164:167], v[180:183], v[12:15]
    v_mfma_f32_16x16x32_bf16 v[16:19], v[168:171], v[180:183], v[16:19]
    v_mfma_f32_16x16x32_bf16 v[20:23], v[172:175], v[180:183], v[20:23]
    v_mfma_f32_16x16x32_bf16 v[24:27], v[176:179], v[180:183], v[24:27]
    v_mfma_f32_16x16x32_bf16 v[28:31], v[160:163], v[184:187], v[28:31]
    v_mfma_f32_16x16x32_bf16 v[32:35], v[164:167], v[184:187], v[32:35]
    v_mfma_f32_16x16x32_bf16 v[36:39], v[168:171], v[184:187], v[36:39]
    v_mfma_f32_16x16x32_bf16 v[40:43], v[172:175], v[184:187], v[40:43]
    v_mfma_f32_16x16x32_bf16 v[44:47], v[176:179], v[184:187], v[44:47]
    v_mfma_f32_16x16x32_bf16 v[48:51], v[160:163], v[188:191], v[48:51]
    v_mfma_f32_16x16x32_bf16 v[52:55], v[164:167], v[188:191], v[52:55]
    v_mfma_f32_16x16x32_bf16 v[56:59], v[168:171], v[188:191], v[56:59]
    v_mfma_f32_16x16x32_bf16 v[60:63], v[172:175], v[188:191], v[60:63]
    v_mfma_f32_16x16x32_bf16 v[64:67], v[176:179], v[188:191], v[64:67]
    v_mfma_f32_16x16x32_bf16 v[68:71], v[160:163], v[192:195], v[68:71]
    v_mfma_f32_16x16x32_bf16 v[72:75], v[164:167], v[192:195], v[72:75]
    v_mfma_f32_16x16x32_bf16 v[76:79], v[168:171], v[192:195], v[76:79]
    v_mfma_f32_16x16x32_bf16 v[80:83], v[172:175], v[192:195], v[80:83]
    v_mfma_f32_16x16x32_bf16 v[84:87], v[176:179], v[192:195], v[84:87]
    s_add_u32 s55, s54, 4096
    buffer_load_dwordx4 v[160:163], v2, s[24:27], s54 offen offset:0 sc1
    buffer_load_dwordx4 v[164:167], v2, s[24:27], s54 offen offset:1024 sc1
    buffer_load_dwordx4 v[168:171], v2, s[24:27], s54 offen offset:2048 sc1
    buffer_load_dwordx4 v[172:175], v2, s[24:27], s54 offen offset:3072 sc1
    buffer_load_dwordx4 v[176:179], v2, s[24:27], s55 offen sc1
    buffer_load_dwordx4 v[180:183], v2, s[24:27], s44 offen sc1
    buffer_load_dwordx4 v[184:187], v2, s[24:27], s45 offen sc1
    buffer_load_dwordx4 v[188:191], v2, s[24:27], s46 offen sc1
    buffer_load_dwordx4 v[192:195], v2, s[24:27], s47 offen sc1
    s_add_u32 s54, s54, 20480
    s_add_u32 s44, s44, 4096
    s_add_u32 s45, s45, 4096
    s_add_u32 s46, s46, 4096
    s_add_u32 s47, s47, 4096
    s_waitcnt vmcnt(27)
    v_mfma_f32_16x16x32_bf16 v[8:11], v[196:199], v[216:219], v[8:11]
    v_mfma_f32_16x16x32_bf16 v[12:15], v[200:203], v[216:219], v[12:15]
    v_mfma_f32_16x16x32_bf16 v[16:19], v[204:207], v[216:219], v[16:19]
    v_mfma_f32_16x16x32_bf16 v[20:23], v[208:211], v[216:219], v[20:23]
    v_mfma_f32_16x16x32_bf16 v[24:27], v[212:215], v[216:219], v[24:27]
    v_mfma_f32_16x16x32_bf16 v[28:31], v[196:199], v[220:223], v[28:31]
    v_mfma_f32_16x16x32_bf16 v[32:35], v[200:203], v[220:223], v[32:35]
    v_mfma_f32_16x16x32_bf16 v[36:39], v[204:207], v[220:223], v[36:39]
    v_mfma_f32_16x16x32_bf16 v[40:43], v[208:211], v[220:223], v[40:43]
    v_mfma_f32_16x16x32_bf16 v[44:47], v[212:215], v[220:223], v[44:47]
    v_mfma_f32_16x16x32_bf16 v[48:51], v[196:199], v[224:227], v[48:51]
    v_mfma_f32_16x16x32_bf16 v[52:55], v[200:203], v[224:227], v[52:55]
    v_mfma_f32_16x16x32_bf16 v[56:59], v[204:207], v[224:227], v[56:59]
    v_mfma_f32_16x16x32_bf16 v[60:63], v[208:211], v[224:227], v[60:63]
    v_mfma_f32_16x16x32_bf16 v[64:67], v[212:215], v[224:227], v[64:67]
    v_mfma_f32_16x16x32_bf16 v[68:71], v[196:199], v[228:231], v[68:71]
    v_mfma_f32_16x16x32_bf16 v[72:75], v[200:203], v[228:231], v[72:75]
    v_mfma_f32_16x16x32_bf16 v[76:79], v[204:207], v[228:231], v[76:79]
    v_mfma_f32_16x16x32_bf16 v[80:83], v[208:211], v[228:231], v[80:83]
    v_mfma_f32_16x16x32_bf16 v[84:87], v[212:215], v[228:231], v[84:87]
    s_add_u32 s55, s54, 4096
    buffer_load_dwordx4 v[196:199], v2, s[24:27], s54 offen offset:0 sc1
    buffer_load_dwordx4 v[200:203], v2, s[24:27], s54 offen offset:1024 sc1
    buffer_load_dwordx4 v[204:207], v2, s[24:27], s54 offen offset:2048 sc1
    buffer_load_dwordx4 v[208:211], v2, s[24:27], s54 offen offset:3072 sc1
    buffer_load_dwordx4 v[212:215], v2, s[24:27], s55 offen sc1
    buffer_load_dwordx4 v[216:219], v2, s[24:27], s44 offen sc1
    buffer_load_dwordx4 v[220:223], v2, s[24:27], s45 offen sc1
    buffer_load_dwordx4 v[224:227], v2, s[24:27], s46 offen sc1
    buffer_load_dwordx4 v[228:231], v2, s[24:27], s47 offen sc1
    s_add_u32 s54, s54, 20480
    s_add_u32 s44, s44, 4096
    s_add_u32 s45, s45, 4096
    s_add_u32 s46, s46, 4096
    s_add_u32 s47, s47, 4096
    s_waitcnt vmcnt(27)
    v_mfma_f32_16x16x32_bf16 v[8:11], v[88:91], v[108:111], v[8:11]
    v_mfma_f32_16x16x32_bf16 v[12:15], v[92:95], v[108:111], v[12:15]
    v_mfma_f32_16x16x32_bf16 v[16:19], v[96:99], v[108:111], v[16:19]
    v_mfma_f32_16x16x32_bf16 v[20:23], v[100:103], v[108:111], v[20:23]
    v_mfma_f32_16x16x32_bf16 v[24:27], v[104:107], v[108:111], v[24:27]
    v_mfma_f32_16x16x32_bf16 v[28:31], v[88:91], v[112:115], v[28:31]
    v_mfma_f32_16x16x32_bf16 v[32:35], v[92:95], v[112:115], v[32:35]
    v_mfma_f32_16x16x32_bf16 v[36:39], v[96:99], v[112:115], v[36:39]
    v_mfma_f32_16x16x32_bf16 v[40:43], v[100:103], v[112:115], v[40:43]
    v_mfma_f32_16x16x32_bf16 v[44:47], v[104:107], v[112:115], v[44:47]
    v_mfma_f32_16x16x32_bf16 v[48:51], v[88:91], v[116:119], v[48:51]
    v_mfma_f32_16x16x32_bf16 v[52:55], v[92:95], v[116:119], v[52:55]
    v_mfma_f32_16x16x32_bf16 v[56:59], v[96:99], v[116:119], v[56:59]
    v_mfma_f32_16x16x32_bf16 v[60:63], v[100:103], v[116:119], v[60:63]
    v_mfma_f32_16x16x32_bf16 v[64:67], v[104:107], v[116:119], v[64:67]
    v_mfma_f32_16x16x32_bf16 v[68:71], v[88:91], v[120:123], v[68:71]
    v_mfma_f32_16x16x32_bf16 v[72:75], v[92:95], v[120:123], v[72:75]
    v_mfma_f32_16x16x32_bf16 v[76:79], v[96:99], v[120:123], v[76:79]
    v_mfma_f32_16x16x32_bf16 v[80:83], v[100:103], v[120:123], v[80:83]
    v_mfma_f32_16x16x32_bf16 v[84:87], v[104:107], v[120:123], v[84:87]
    s_mov_b32 s12, s62
    s_mov_b32 s13, s63
    s_mov_b32 s14, 1280
    s_mov_b32 s15, 0x00020000
    s_mov_b32 s16, s64
    s_mov_b32 s17, s65
    s_mov_b32 s18, 2621440
    s_mov_b32 s19, 0x00020000
    s_and_b32 s43, s38, 3
    v_and_b32 v3, 15, v1
    v_lshrrev_b32 v4, 4, v1
    v_mul_u32_u24 v5, 1280, v3
    v_lshl_add_u32 v5, v4, 3, v5
    v_lshlrev_b32 v6, 3, v4
    s_lshl_b32 s39, s36, 2
    s_add_u32 s39, s39, s43
    s_mul_i32 s39, s39, 20480
    s_mul_i32 s40, s37, 160
    s_add_u32 s52, s39, s40
    s_mov_b32 s53, s40
    buffer_load_dwordx2 v[232:233], v5, s[8:11], s52 offen offset:0
    buffer_load_dwordx2 v[234:235], v5, s[8:11], s52 offen offset:32
    buffer_load_dwordx2 v[236:237], v5, s[8:11], s52 offen offset:64
    buffer_load_dwordx2 v[238:239], v5, s[8:11], s52 offen offset:96
    buffer_load_dwordx2 v[240:241], v5, s[8:11], s52 offen offset:128
    buffer_load_dwordx2 v[242:243], v6, s[12:15], s53 offen offset:0
    buffer_load_dwordx2 v[244:245], v6, s[12:15], s53 offen offset:32
    buffer_load_dwordx2 v[246:247], v6, s[12:15], s53 offen offset:64
    buffer_load_dwordx2 v[248:249], v6, s[12:15], s53 offen offset:96
    buffer_load_dwordx2 v[6:7], v6, s[12:15], s53 offen offset:128
    s_barrier
    s_waitcnt vmcnt(28)
    v_mfma_f32_16x16x32_bf16 v[8:11], v[124:127], v[144:147], v[8:11]
    v_mfma_f32_16x16x32_bf16 v[12:15], v[128:131], v[144:147], v[12:15]
    v_mfma_f32_16x16x32_bf16 v[16:19], v[132:135], v[144:147], v[16:19]
    v_mfma_f32_16x16x32_bf16 v[20:23], v[136:139], v[144:147], v[20:23]
    v_mfma_f32_16x16x32_bf16 v[24:27], v[140:143], v[144:147], v[24:27]
    v_mfma_f32_16x16x32_bf16 v[28:31], v[124:127], v[148:151], v[28:31]
    v_mfma_f32_16x16x32_bf16 v[32:35], v[128:131], v[148:151], v[32:35]
    v_mfma_f32_16x16x32_bf16 v[36:39], v[132:135], v[148:151], v[36:39]
    v_mfma_f32_16x16x32_bf16 v[40:43], v[136:139], v[148:151], v[40:43]
    v_mfma_f32_16x16x32_bf16 v[44:47], v[140:143], v[148:151], v[44:47]
    v_mfma_f32_16x16x32_bf16 v[48:51], v[124:127], v[152:155], v[48:51]
    v_mfma_f32_16x16x32_bf16 v[52:55], v[128:131], v[152:155], v[52:55]
    v_mfma_f32_16x16x32_bf16 v[56:59], v[132:135], v[152:155], v[56:59]
    v_mfma_f32_16x16x32_bf16 v[60:63], v[136:139], v[152:155], v[60:63]
    v_mfma_f32_16x16x32_bf16 v[64:67], v[140:143], v[152:155], v[64:67]
    v_mfma_f32_16x16x32_bf16 v[68:71], v[124:127], v[156:159], v[68:71]
    v_mfma_f32_16x16x32_bf16 v[72:75], v[128:131], v[156:159], v[72:75]
    v_mfma_f32_16x16x32_bf16 v[76:79], v[132:135], v[156:159], v[76:79]
    v_mfma_f32_16x16x32_bf16 v[80:83], v[136:139], v[156:159], v[80:83]
    v_mfma_f32_16x16x32_bf16 v[84:87], v[140:143], v[156:159], v[84:87]
    s_waitcnt vmcnt(19)
    v_mfma_f32_16x16x32_bf16 v[8:11], v[160:163], v[180:183], v[8:11]
    v_mfma_f32_16x16x32_bf16 v[12:15], v[164:167], v[180:183], v[12:15]
    v_mfma_f32_16x16x32_bf16 v[16:19], v[168:171], v[180:183], v[16:19]
    v_mfma_f32_16x16x32_bf16 v[20:23], v[172:175], v[180:183], v[20:23]
    v_mfma_f32_16x16x32_bf16 v[24:27], v[176:179], v[180:183], v[24:27]
    v_mfma_f32_16x16x32_bf16 v[28:31], v[160:163], v[184:187], v[28:31]
    v_mfma_f32_16x16x32_bf16 v[32:35], v[164:167], v[184:187], v[32:35]
    v_mfma_f32_16x16x32_bf16 v[36:39], v[168:171], v[184:187], v[36:39]
    v_mfma_f32_16x16x32_bf16 v[40:43], v[172:175], v[184:187], v[40:43]
    v_mfma_f32_16x16x32_bf16 v[44:47], v[176:179], v[184:187], v[44:47]
    v_mfma_f32_16x16x32_bf16 v[48:51], v[160:163], v[188:191], v[48:51]
    v_mfma_f32_16x16x32_bf16 v[52:55], v[164:167], v[188:191], v[52:55]
    v_mfma_f32_16x16x32_bf16 v[56:59], v[168:171], v[188:191], v[56:59]
    v_mfma_f32_16x16x32_bf16 v[60:63], v[172:175], v[188:191], v[60:63]
    v_mfma_f32_16x16x32_bf16 v[64:67], v[176:179], v[188:191], v[64:67]
    v_mfma_f32_16x16x32_bf16 v[68:71], v[160:163], v[192:195], v[68:71]
    v_mfma_f32_16x16x32_bf16 v[72:75], v[164:167], v[192:195], v[72:75]
    v_mfma_f32_16x16x32_bf16 v[76:79], v[168:171], v[192:195], v[76:79]
    v_mfma_f32_16x16x32_bf16 v[80:83], v[172:175], v[192:195], v[80:83]
    v_mfma_f32_16x16x32_bf16 v[84:87], v[176:179], v[192:195], v[84:87]
    s_waitcnt vmcnt(10)
    v_mfma_f32_16x16x32_bf16 v[8:11], v[196:199], v[216:219], v[8:11]
    v_mfma_f32_16x16x32_bf16 v[12:15], v[200:203], v[216:219], v[12:15]
    v_mfma_f32_16x16x32_bf16 v[16:19], v[204:207], v[216:219], v[16:19]
    v_mfma_f32_16x16x32_bf16 v[20:23], v[208:211], v[216:219], v[20:23]
    v_mfma_f32_16x16x32_bf16 v[24:27], v[212:215], v[216:219], v[24:27]
    v_mfma_f32_16x16x32_bf16 v[28:31], v[196:199], v[220:223], v[28:31]
    v_mfma_f32_16x16x32_bf16 v[32:35], v[200:203], v[220:223], v[32:35]
    v_mfma_f32_16x16x32_bf16 v[36:39], v[204:207], v[220:223], v[36:39]
    v_mfma_f32_16x16x32_bf16 v[40:43], v[208:211], v[220:223], v[40:43]
    v_mfma_f32_16x16x32_bf16 v[44:47], v[212:215], v[220:223], v[44:47]
    v_mfma_f32_16x16x32_bf16 v[48:51], v[196:199], v[224:227], v[48:51]
    v_mfma_f32_16x16x32_bf16 v[52:55], v[200:203], v[224:227], v[52:55]
    v_mfma_f32_16x16x32_bf16 v[56:59], v[204:207], v[224:227], v[56:59]
    v_mfma_f32_16x16x32_bf16 v[60:63], v[208:211], v[224:227], v[60:63]
    v_mfma_f32_16x16x32_bf16 v[64:67], v[212:215], v[224:227], v[64:67]
    v_mfma_f32_16x16x32_bf16 v[68:71], v[196:199], v[228:231], v[68:71]
    v_mfma_f32_16x16x32_bf16 v[72:75], v[200:203], v[228:231], v[72:75]
    v_mfma_f32_16x16x32_bf16 v[76:79], v[204:207], v[228:231], v[76:79]
    v_mfma_f32_16x16x32_bf16 v[80:83], v[208:211], v[228:231], v[80:83]
    v_mfma_f32_16x16x32_bf16 v[84:87], v[212:215], v[228:231], v[84:87]
    s_setprio 0
    v_lshlrev_b32 v2, 4, v1
    s_and_b32 s42, s38, 3
    s_lshl_b32 s49, s36, 2
    s_add_u32 s49, s49, s42
    s_mul_i32 s49, s49, 20
    s_add_u32 s49, s49, 10
    s_lshl_b32 s49, s49, 10
    s_add_u32 s49, s49, 9240576
    s_nop 7
    s_add_u32 s39, s42, 1
    s_and_b32 s39, s39, 3
    s_mul_i32 s40, s39, 15360
    s_add_u32 s40, s40, 112640
    v_add_u32 v90, s40, v2
    s_cmp_eq_u32 s39, 0
    s_cbranch_scc0 L_wn_48
    ds_write_b128 v90, v[8:11] offset:0
    ds_write_b128 v90, v[12:15] offset:1024
    ds_write_b128 v90, v[16:19] offset:2048
    ds_write_b128 v90, v[20:23] offset:3072
    ds_write_b128 v90, v[24:27] offset:4096
    s_branch L_wdone_47
L_wn_48:
    s_cmp_eq_u32 s39, 1
    s_cbranch_scc0 L_wn_49
    ds_write_b128 v90, v[28:31] offset:0
    ds_write_b128 v90, v[32:35] offset:1024
    ds_write_b128 v90, v[36:39] offset:2048
    ds_write_b128 v90, v[40:43] offset:3072
    ds_write_b128 v90, v[44:47] offset:4096
    s_branch L_wdone_47
L_wn_49:
    s_cmp_eq_u32 s39, 2
    s_cbranch_scc0 L_wn_50
    ds_write_b128 v90, v[48:51] offset:0
    ds_write_b128 v90, v[52:55] offset:1024
    ds_write_b128 v90, v[56:59] offset:2048
    ds_write_b128 v90, v[60:63] offset:3072
    ds_write_b128 v90, v[64:67] offset:4096
    s_branch L_wdone_47
L_wn_50:
    s_cmp_eq_u32 s39, 3
    s_cbranch_scc0 L_wn_51
    ds_write_b128 v90, v[68:71] offset:0
    ds_write_b128 v90, v[72:75] offset:1024
    ds_write_b128 v90, v[76:79] offset:2048
    ds_write_b128 v90, v[80:83] offset:3072
    ds_write_b128 v90, v[84:87] offset:4096
    s_branch L_wdone_47
L_wn_51:
L_wdone_47:
    s_add_u32 s39, s42, 2
    s_and_b32 s39, s39, 3
    s_mul_i32 s40, s39, 15360
    s_add_u32 s40, s40, 107520
    v_add_u32 v90, s40, v2
    s_cmp_eq_u32 s39, 0
    s_cbranch_scc0 L_wn_53
    ds_write_b128 v90, v[8:11] offset:0
    ds_write_b128 v90, v[12:15] offset:1024
    ds_write_b128 v90, v[16:19] offset:2048
    ds_write_b128 v90, v[20:23] offset:3072
    ds_write_b128 v90, v[24:27] offset:4096
    s_branch L_wdone_52
L_wn_53:
    s_cmp_eq_u32 s39, 1
    s_cbranch_scc0 L_wn_54
    ds_write_b128 v90, v[28:31] offset:0
    ds_write_b128 v90, v[32:35] offset:1024
    ds_write_b128 v90, v[36:39] offset:2048
    ds_write_b128 v90, v[40:43] offset:3072
    ds_write_b128 v90, v[44:47] offset:4096
    s_branch L_wdone_52
L_wn_54:
    s_cmp_eq_u32 s39, 2
    s_cbranch_scc0 L_wn_55
    ds_write_b128 v90, v[48:51] offset:0
    ds_write_b128 v90, v[52:55] offset:1024
    ds_write_b128 v90, v[56:59] offset:2048
    ds_write_b128 v90, v[60:63] offset:3072
    ds_write_b128 v90, v[64:67] offset:4096
    s_branch L_wdone_52
L_wn_55:
    s_cmp_eq_u32 s39, 3
    s_cbranch_scc0 L_wn_56
    ds_write_b128 v90, v[68:71] offset:0
    ds_write_b128 v90, v[72:75] offset:1024
    ds_write_b128 v90, v[76:79] offset:2048
    ds_write_b128 v90, v[80:83] offset:3072
    ds_write_b128 v90, v[84:87] offset:4096
    s_branch L_wdone_52
L_wn_56:
L_wdone_52:
    s_add_u32 s39, s42, 3
    s_and_b32 s39, s39, 3
    s_mul_i32 s40, s39, 15360
    s_add_u32 s40, s40, 102400
    v_add_u32 v90, s40, v2
    s_cmp_eq_u32 s39, 0
    s_cbranch_scc0 L_wn_58
    ds_write_b128 v90, v[8:11] offset:0
    ds_write_b128 v90, v[12:15] offset:1024
    ds_write_b128 v90, v[16:19] offset:2048
    ds_write_b128 v90, v[20:23] offset:3072
    ds_write_b128 v90, v[24:27] offset:4096
    s_branch L_wdone_57
L_wn_58:
    s_cmp_eq_u32 s39, 1
    s_cbranch_scc0 L_wn_59
    ds_write_b128 v90, v[28:31] offset:0
    ds_write_b128 v90, v[32:35] offset:1024
    ds_write_b128 v90, v[36:39] offset:2048
    ds_write_b128 v90, v[40:43] offset:3072
    ds_write_b128 v90, v[44:47] offset:4096
    s_branch L_wdone_57
L_wn_59:
    s_cmp_eq_u32 s39, 2
    s_cbranch_scc0 L_wn_60
    ds_write_b128 v90, v[48:51] offset:0
    ds_write_b128 v90, v[52:55] offset:1024
    ds_write_b128 v90, v[56:59] offset:2048
    ds_write_b128 v90, v[60:63] offset:3072
    ds_write_b128 v90, v[64:67] offset:4096
    s_branch L_wdone_57
L_wn_60:
    s_cmp_eq_u32 s39, 3
    s_cbranch_scc0 L_wn_61
    ds_write_b128 v90, v[68:71] offset:0
    ds_write_b128 v90, v[72:75] offset:1024
    ds_write_b128 v90, v[76:79] offset:2048
    ds_write_b128 v90, v[80:83] offset:3072
    ds_write_b128 v90, v[84:87] offset:4096
    s_branch L_wdone_57
L_wn_61:
L_wdone_57:
    s_cmp_eq_u32 s42, 0
    s_cbranch_scc0 L_mn_63
    v_mov_b32 v112, v8
    v_mov_b32 v113, v9
    v_mov_b32 v114, v10
    v_mov_b32 v115, v11
    v_mov_b32 v116, v12
    v_mov_b32 v117, v13
    v_mov_b32 v118, v14
    v_mov_b32 v119, v15
    v_mov_b32 v120, v16
    v_mov_b32 v121, v17
    v_mov_b32 v122, v18
    v_mov_b32 v123, v19
    v_mov_b32 v124, v20
    v_mov_b32 v125, v21
    v_mov_b32 v126, v22
    v_mov_b32 v127, v23
    v_mov_b32 v128, v24
    v_mov_b32 v129, v25
    v_mov_b32 v130, v26
    v_mov_b32 v131, v27
    s_branch L_mdone_62
L_mn_63:
    s_cmp_eq_u32 s42, 1
    s_cbranch_scc0 L_mn_64
    v_mov_b32 v112, v28
    v_mov_b32 v113, v29
    v_mov_b32 v114, v30
    v_mov_b32 v115, v31
    v_mov_b32 v116, v32
    v_mov_b32 v117, v33
    v_mov_b32 v118, v34
    v_mov_b32 v119, v35
    v_mov_b32 v120, v36
    v_mov_b32 v121, v37
    v_mov_b32 v122, v38
    v_mov_b32 v123, v39
    v_mov_b32 v124, v40
    v_mov_b32 v125, v41
    v_mov_b32 v126, v42
    v_mov_b32 v127, v43
    v_mov_b32 v128, v44
    v_mov_b32 v129, v45
    v_mov_b32 v130, v46
    v_mov_b32 v131, v47
    s_branch L_mdone_62
L_mn_64:
    s_cmp_eq_u32 s42, 2
    s_cbranch_scc0 L_mn_65
    v_mov_b32 v112, v48
    v_mov_b32 v113, v49
    v_mov_b32 v114, v50
    v_mov_b32 v115, v51
    v_mov_b32 v116, v52
    v_mov_b32 v117, v53
    v_mov_b32 v118, v54
    v_mov_b32 v119, v55
    v_mov_b32 v120, v56
    v_mov_b32 v121, v57
    v_mov_b32 v122, v58
    v_mov_b32 v123, v59
    v_mov_b32 v124, v60
    v_mov_b32 v125, v61
    v_mov_b32 v126, v62
    v_mov_b32 v127, v63
    v_mov_b32 v128, v64
    v_mov_b32 v129, v65
    v_mov_b32 v130, v66
    v_mov_b32 v131, v67
    s_branch L_mdone_62
L_mn_65:
    s_cmp_eq_u32 s42, 3
    s_cbranch_scc0 L_mn_66
    v_mov_b32 v112, v68
    v_mov_b32 v113, v69
    v_mov_b32 v114, v70
    v_mov_b32 v115, v71
    v_mov_b32 v116, v72
    v_mov_b32 v117, v73
    v_mov_b32 v118, v74
    v_mov_b32 v119, v75
    v_mov_b32 v120, v76
    v_mov_b32 v121, v77
    v_mov_b32 v122, v78
    v_mov_b32 v123, v79
    v_mov_b32 v124, v80
    v_mov_b32 v125, v81
    v_mov_b32 v126, v82
    v_mov_b32 v127, v83
    v_mov_b32 v128, v84
    v_mov_b32 v129, v85
    v_mov_b32 v130, v86
    v_mov_b32 v131, v87
    s_branch L_mdone_62
L_mn_66:
L_mdone_62:
    s_waitcnt lgkmcnt(0)
    s_barrier
    s_mul_i32 s40, s42, 15360
    s_add_u32 s40, s40, 102400
    v_add_u32 v90, s40, v2
    ds_read_b128 v[172:175], v90 offset:0
    ds_read_b128 v[176:179], v90 offset:1024
    ds_read_b128 v[180:183], v90 offset:2048
    ds_read_b128 v[184:187], v90 offset:3072
    ds_read_b128 v[188:191], v90 offset:4096
    ds_read_b128 v[192:195], v90 offset:5120
    ds_read_b128 v[196:199], v90 offset:6144
    ds_read_b128 v[200:203], v90 offset:7168
    ds_read_b128 v[204:207], v90 offset:8192
    ds_read_b128 v[208:211], v90 offset:9216
    ds_read_b128 v[212:215], v90 offset:10240
    ds_read_b128 v[216:219], v90 offset:11264
    ds_read_b128 v[220:223], v90 offset:12288
    ds_read_b128 v[224:227], v90 offset:13312
    ds_read_b128 v[228:231], v90 offset:14336
    s_waitcnt vmcnt(0) lgkmcnt(0)
    v_add_f32 v112, v112, v172
    v_add_f32 v192, v192, v212
    v_add_f32 v113, v113, v173
    v_add_f32 v193, v193, v213
    v_add_f32 v114, v114, v174
    v_add_f32 v194, v194, v214
    v_add_f32 v115, v115, v175
    v_add_f32 v195, v195, v215
    v_add_f32 v116, v116, v176
    v_add_f32 v196, v196, v216
    v_add_f32 v117, v117, v177
    v_add_f32 v197, v197, v217
    v_add_f32 v118, v118, v178
    v_add_f32 v198, v198, v218
    v_add_f32 v119, v119, v179
    v_add_f32 v199, v199, v219
    v_add_f32 v120, v120, v180
    v_add_f32 v200, v200, v220
    v_add_f32 v121, v121, v181
    v_add_f32 v201, v201, v221
    v_add_f32 v122, v122, v182
    v_add_f32 v202, v202, v222
    v_add_f32 v123, v123, v183
    v_add_f32 v203, v203, v223
    v_add_f32 v124, v124, v184
    v_add_f32 v204, v204, v224
    v_add_f32 v125, v125, v185
    v_add_f32 v205, v205, v225
    v_add_f32 v126, v126, v186
    v_add_f32 v206, v206, v226
    v_add_f32 v127, v127, v187
    v_add_f32 v207, v207, v227
    v_add_f32 v128, v128, v188
    v_add_f32 v208, v208, v228
    v_add_f32 v129, v129, v189
    v_add_f32 v209, v209, v229
    v_add_f32 v130, v130, v190
    v_add_f32 v210, v210, v230
    v_add_f32 v131, v131, v191
    v_add_f32 v211, v211, v231
    v_add_f32 v112, v112, v192
    v_add_f32 v113, v113, v193
    v_add_f32 v114, v114, v194
    v_add_f32 v115, v115, v195
    v_add_f32 v116, v116, v196
    v_add_f32 v117, v117, v197
    v_add_f32 v118, v118, v198
    v_add_f32 v119, v119, v199
    v_add_f32 v120, v120, v200
    v_add_f32 v121, v121, v201
    v_add_f32 v122, v122, v202
    v_add_f32 v123, v123, v203
    v_add_f32 v124, v124, v204
    v_add_f32 v125, v125, v205
    v_add_f32 v126, v126, v206
    v_add_f32 v127, v127, v207
    v_add_f32 v128, v128, v208
    v_add_f32 v129, v129, v209
    v_add_f32 v130, v130, v210
    v_add_f32 v131, v131, v211
    v_lshlrev_b32 v8, 16, v232
    v_and_b32 v9, 0xffff0000, v232
    v_lshlrev_b32 v10, 16, v242
    v_and_b32 v11, 0xffff0000, v242
    v_add_f32 v112, v112, v8
    v_add_f32 v113, v113, v9
    v_add_f32 v112, v112, v10
    v_add_f32 v113, v113, v11
    v_lshlrev_b32 v8, 16, v233
    v_and_b32 v9, 0xffff0000, v233
    v_lshlrev_b32 v10, 16, v243
    v_and_b32 v11, 0xffff0000, v243
    v_add_f32 v114, v114, v8
    v_add_f32 v115, v115, v9
    v_add_f32 v114, v114, v10
    v_add_f32 v115, v115, v11
    v_lshlrev_b32 v8, 16, v234
    v_and_b32 v9, 0xffff0000, v234
    v_lshlrev_b32 v10, 16, v244
    v_and_b32 v11, 0xffff0000, v244
    v_add_f32 v116, v116, v8
    v_add_f32 v117, v117, v9
    v_add_f32 v116, v116, v10
    v_add_f32 v117, v117, v11
    v_lshlrev_b32 v8, 16, v235
    v_and_b32 v9, 0xffff0000, v235
    v_lshlrev_b32 v10, 16, v245
    v_and_b32 v11, 0xffff0000, v245
    v_add_f32 v118, v118, v8
    v_add_f32 v119, v119, v9
    v_add_f32 v118, v118, v10
    v_add_f32 v119, v119, v11
    v_lshlrev_b32 v8, 16, v236
    v_and_b32 v9, 0xffff0000, v236
    v_lshlrev_b32 v10, 16, v246
    v_and_b32 v11, 0xffff0000, v246
    v_add_f32 v120, v120, v8
    v_add_f32 v121, v121, v9
    v_add_f32 v120, v120, v10
    v_add_f32 v121, v121, v11
    v_lshlrev_b32 v8, 16, v237
    v_and_b32 v9, 0xffff0000, v237
    v_lshlrev_b32 v10, 16, v247
    v_and_b32 v11, 0xffff0000, v247
    v_add_f32 v122, v122, v8
    v_add_f32 v123, v123, v9
    v_add_f32 v122, v122, v10
    v_add_f32 v123, v123, v11
    v_lshlrev_b32 v8, 16, v238
    v_and_b32 v9, 0xffff0000, v238
    v_lshlrev_b32 v10, 16, v248
    v_and_b32 v11, 0xffff0000, v248
    v_add_f32 v124, v124, v8
    v_add_f32 v125, v125, v9
    v_add_f32 v124, v124, v10
    v_add_f32 v125, v125, v11
    v_lshlrev_b32 v8, 16, v239
    v_and_b32 v9, 0xffff0000, v239
    v_lshlrev_b32 v10, 16, v249
    v_and_b32 v11, 0xffff0000, v249
    v_add_f32 v126, v126, v8
    v_add_f32 v127, v127, v9
    v_add_f32 v126, v126, v10
    v_add_f32 v127, v127, v11
    v_lshlrev_b32 v8, 16, v240
    v_and_b32 v9, 0xffff0000, v240
    v_lshlrev_b32 v10, 16, v6
    v_and_b32 v11, 0xffff0000, v6
    v_add_f32 v128, v128, v8
    v_add_f32 v129, v129, v9
    v_add_f32 v128, v128, v10
    v_add_f32 v129, v129, v11
    v_lshlrev_b32 v8, 16, v241
    v_and_b32 v9, 0xffff0000, v241
    v_lshlrev_b32 v10, 16, v7
    v_and_b32 v11, 0xffff0000, v7
    v_add_f32 v130, v130, v8
    v_add_f32 v131, v131, v9
    v_add_f32 v130, v130, v10
    v_add_f32 v131, v131, v11
    v_add_u32 v12, 51200, v2
    s_barrier
    s_setprio 0
    s_mov_b32 s41, s49
    buffer_load_dwordx4 v[132:135], v2, s[24:27], s41 offen offset:0 sc1
    buffer_load_dwordx4 v[136:139], v2, s[24:27], s41 offen offset:1024 sc1
    buffer_load_dwordx4 v[140:143], v2, s[24:27], s41 offen offset:2048 sc1
    buffer_load_dwordx4 v[144:147], v2, s[24:27], s41 offen offset:3072 sc1
    s_add_u32 s41, s41, 4096
    buffer_load_dwordx4 v[148:151], v2, s[24:27], s41 offen offset:0 sc1
    buffer_load_dwordx4 v[152:155], v2, s[24:27], s41 offen offset:1024 sc1
    buffer_load_dwordx4 v[156:159], v2, s[24:27], s41 offen offset:2048 sc1
    buffer_load_dwordx4 v[160:163], v2, s[24:27], s41 offen offset:3072 sc1
    s_add_u32 s41, s41, 4096
    buffer_load_dwordx4 v[164:167], v2, s[24:27], s41 offen offset:0 sc1
    buffer_load_dwordx4 v[168:171], v2, s[24:27], s41 offen offset:1024 sc1
    ds_read_b128 v[172:175], v12 offset:0
    ds_read_b128 v[176:179], v12 offset:1024
    ds_read_b128 v[180:183], v12 offset:2048
    ds_read_b128 v[184:187], v12 offset:3072
    ds_read_b128 v[188:191], v12 offset:4096
    ds_read_b128 v[192:195], v12 offset:5120
    ds_read_b128 v[196:199], v12 offset:6144
    ds_read_b128 v[200:203], v12 offset:7168
    ds_read_b128 v[204:207], v12 offset:8192
    ds_read_b128 v[208:211], v12 offset:9216
    s_waitcnt vmcnt(9) lgkmcnt(5)
    v_mfma_f32_16x16x32_bf16 v[112:115], v[172:175], v[132:135], v[112:115]
    v_mfma_f32_16x16x32_bf16 v[116:119], v[176:179], v[132:135], v[116:119]
    v_mfma_f32_16x16x32_bf16 v[120:123], v[180:183], v[132:135], v[120:123]
    v_mfma_f32_16x16x32_bf16 v[124:127], v[184:187], v[132:135], v[124:127]
    v_mfma_f32_16x16x32_bf16 v[128:131], v[188:191], v[132:135], v[128:131]
    ds_read_b128 v[172:175], v12 offset:10240
    ds_read_b128 v[176:179], v12 offset:11264
    ds_read_b128 v[180:183], v12 offset:12288
    ds_read_b128 v[184:187], v12 offset:13312
    ds_read_b128 v[188:191], v12 offset:14336
    s_waitcnt vmcnt(8) lgkmcnt(5)
    v_mfma_f32_16x16x32_bf16 v[112:115], v[192:195], v[136:139], v[112:115]
    v_mfma_f32_16x16x32_bf16 v[116:119], v[196:199], v[136:139], v[116:119]
    v_mfma_f32_16x16x32_bf16 v[120:123], v[200:203], v[136:139], v[120:123]
    v_mfma_f32_16x16x32_bf16 v[124:127], v[204:207], v[136:139], v[124:127]
    v_mfma_f32_16x16x32_bf16 v[128:131], v[208:211], v[136:139], v[128:131]
    ds_read_b128 v[192:195], v12 offset:15360
    ds_read_b128 v[196:199], v12 offset:16384
    ds_read_b128 v[200:203], v12 offset:17408
    ds_read_b128 v[204:207], v12 offset:18432
    ds_read_b128 v[208:211], v12 offset:19456
    s_waitcnt vmcnt(7) lgkmcnt(5)
    v_mfma_f32_16x16x32_bf16 v[112:115], v[172:175], v[140:143], v[112:115]
    v_mfma_f32_16x16x32_bf16 v[116:119], v[176:179], v[140:143], v[116:119]
    v_mfma_f32_16x16x32_bf16 v[120:123], v[180:183], v[140:143], v[120:123]
    v_mfma_f32_16x16x32_bf16 v[124:127], v[184:187], v[140:143], v[124:127]
    v_mfma_f32_16x16x32_bf16 v[128:131], v[188:191], v[140:143], v[128:131]
    ds_read_b128 v[172:175], v12 offset:20480
    ds_read_b128 v[176:179], v12 offset:21504
    ds_read_b128 v[180:183], v12 offset:22528
    ds_read_b128 v[184:187], v12 offset:23552
    ds_read_b128 v[188:191], v12 offset:24576
    s_waitcnt vmcnt(6) lgkmcnt(5)
    v_mfma_f32_16x16x32_bf16 v[112:115], v[192:195], v[144:147], v[112:115]
    v_mfma_f32_16x16x32_bf16 v[116:119], v[196:199], v[144:147], v[116:119]
    v_mfma_f32_16x16x32_bf16 v[120:123], v[200:203], v[144:147], v[120:123]
    v_mfma_f32_16x16x32_bf16 v[124:127], v[204:207], v[144:147], v[124:127]
    v_mfma_f32_16x16x32_bf16 v[128:131], v[208:211], v[144:147], v[128:131]
    ds_read_b128 v[192:195], v12 offset:25600
    ds_read_b128 v[196:199], v12 offset:26624
    ds_read_b128 v[200:203], v12 offset:27648
    ds_read_b128 v[204:207], v12 offset:28672
    ds_read_b128 v[208:211], v12 offset:29696
    s_waitcnt vmcnt(5) lgkmcnt(5)
    v_mfma_f32_16x16x32_bf16 v[112:115], v[172:175], v[148:151], v[112:115]
    v_mfma_f32_16x16x32_bf16 v[116:119], v[176:179], v[148:151], v[116:119]
    v_mfma_f32_16x16x32_bf16 v[120:123], v[180:183], v[148:151], v[120:123]
    v_mfma_f32_16x16x32_bf16 v[124:127], v[184:187], v[148:151], v[124:127]
    v_mfma_f32_16x16x32_bf16 v[128:131], v[188:191], v[148:151], v[128:131]
    ds_read_b128 v[172:175], v12 offset:30720
    ds_read_b128 v[176:179], v12 offset:31744
    ds_read_b128 v[180:183], v12 offset:32768
    ds_read_b128 v[184:187], v12 offset:33792
    ds_read_b128 v[188:191], v12 offset:34816
    s_waitcnt vmcnt(4) lgkmcnt(5)
    v_mfma_f32_16x16x32_bf16 v[112:115], v[192:195], v[152:155], v[112:115]
    v_mfma_f32_16x16x32_bf16 v[116:119], v[196:199], v[152:155], v[116:119]
    v_mfma_f32_16x16x32_bf16 v[120:123], v[200:203], v[152:155], v[120:123]
    v_mfma_f32_16x16x32_bf16 v[124:127], v[204:207], v[152:155], v[124:127]
    v_mfma_f32_16x16x32_bf16 v[128:131], v[208:211], v[152:155], v[128:131]
    ds_read_b128 v[192:195], v12 offset:35840
    ds_read_b128 v[196:199], v12 offset:36864
    ds_read_b128 v[200:203], v12 offset:37888
    ds_read_b128 v[204:207], v12 offset:38912
    ds_read_b128 v[208:211], v12 offset:39936
    s_waitcnt vmcnt(3) lgkmcnt(5)
    v_mfma_f32_16x16x32_bf16 v[112:115], v[172:175], v[156:159], v[112:115]
    v_mfma_f32_16x16x32_bf16 v[116:119], v[176:179], v[156:159], v[116:119]
    v_mfma_f32_16x16x32_bf16 v[120:123], v[180:183], v[156:159], v[120:123]
    v_mfma_f32_16x16x32_bf16 v[124:127], v[184:187], v[156:159], v[124:127]
    v_mfma_f32_16x16x32_bf16 v[128:131], v[188:191], v[156:159], v[128:131]
    ds_read_b128 v[172:175], v12 offset:40960
    ds_read_b128 v[176:179], v12 offset:41984
    ds_read_b128 v[180:183], v12 offset:43008
    ds_read_b128 v[184:187], v12 offset:44032
    ds_read_b128 v[188:191], v12 offset:45056
    s_waitcnt vmcnt(2) lgkmcnt(5)
    v_mfma_f32_16x16x32_bf16 v[112:115], v[192:195], v[160:163], v[112:115]
    v_mfma_f32_16x16x32_bf16 v[116:119], v[196:199], v[160:163], v[116:119]
    v_mfma_f32_16x16x32_bf16 v[120:123], v[200:203], v[160:163], v[120:123]
    v_mfma_f32_16x16x32_bf16 v[124:127], v[204:207], v[160:163], v[124:127]
    v_mfma_f32_16x16x32_bf16 v[128:131], v[208:211], v[160:163], v[128:131]
    ds_read_b128 v[192:195], v12 offset:46080
    ds_read_b128 v[196:199], v12 offset:47104
    ds_read_b128 v[200:203], v12 offset:48128
    ds_read_b128 v[204:207], v12 offset:49152
    ds_read_b128 v[208:211], v12 offset:50176
    s_waitcnt vmcnt(1) lgkmcnt(5)
    v_mfma_f32_16x16x32_bf16 v[112:115], v[172:175], v[164:167], v[112:115]
    v_mfma_f32_16x16x32_bf16 v[116:119], v[176:179], v[164:167], v[116:119]
    v_mfma_f32_16x16x32_bf16 v[120:123], v[180:183], v[164:167], v[120:123]
    v_mfma_f32_16x16x32_bf16 v[124:127], v[184:187], v[164:167], v[124:127]
    v_mfma_f32_16x16x32_bf16 v[128:131], v[188:191], v[164:167], v[128:131]
    s_waitcnt vmcnt(0) lgkmcnt(0)
    v_mfma_f32_16x16x32_bf16 v[112:115], v[192:195], v[168:171], v[112:115]
    v_mfma_f32_16x16x32_bf16 v[116:119], v[196:199], v[168:171], v[116:119]
    v_mfma_f32_16x16x32_bf16 v[120:123], v[200:203], v[168:171], v[120:123]
    v_mfma_f32_16x16x32_bf16 v[124:127], v[204:207], v[168:171], v[124:127]
    v_mfma_f32_16x16x32_bf16 v[128:131], v[208:211], v[168:171], v[128:131]
    s_mul_i32 s40, s42, 5120
    s_add_u32 s40, s40, 102400
    v_add_u32 v90, s40, v2
    s_nop 7
    s_barrier
    ds_read_b128 v[172:175], v90 offset:0
    ds_read_b128 v[176:179], v90 offset:1024
    ds_read_b128 v[180:183], v90 offset:2048
    ds_read_b128 v[184:187], v90 offset:3072
    ds_read_b128 v[188:191], v90 offset:4096
    s_waitcnt lgkmcnt(0)
    v_add_f32 v112, v112, v172
    v_add_f32 v113, v113, v173
    v_add_f32 v114, v114, v174
    v_add_f32 v115, v115, v175
    v_add_f32 v116, v116, v176
    v_add_f32 v117, v117, v177
    v_add_f32 v118, v118, v178
    v_add_f32 v119, v119, v179
    v_add_f32 v120, v120, v180
    v_add_f32 v121, v121, v181
    v_add_f32 v122, v122, v182
    v_add_f32 v123, v123, v183
    v_add_f32 v124, v124, v184
    v_add_f32 v125, v125, v185
    v_add_f32 v126, v126, v186
    v_add_f32 v127, v127, v187
    v_add_f32 v128, v128, v188
    v_add_f32 v129, v129, v189
    v_add_f32 v130, v130, v190
    v_add_f32 v131, v131, v191
    v_cvt_pk_bf16_f32 v192, v112, v113
    v_cvt_pk_bf16_f32 v193, v114, v115
    buffer_store_dwordx2 v[192:193], v5, s[16:19], s52 offen offset:0
    v_cvt_pk_bf16_f32 v194, v116, v117
    v_cvt_pk_bf16_f32 v195, v118, v119
    buffer_store_dwordx2 v[194:195], v5, s[16:19], s52 offen offset:32
    v_cvt_pk_bf16_f32 v196, v120, v121
    v_cvt_pk_bf16_f32 v197, v122, v123
    buffer_store_dwordx2 v[196:197], v5, s[16:19], s52 offen offset:64
    v_cvt_pk_bf16_f32 v198, v124, v125
    v_cvt_pk_bf16_f32 v199, v126, v127
    buffer_store_dwordx2 v[198:199], v5, s[16:19], s52 offen offset:96
    v_cvt_pk_bf16_f32 v200, v128, v129
    v_cvt_pk_bf16_f32 v201, v130, v131
    buffer_store_dwordx2 v[200:201], v5, s[16:19], s52 offen offset:128
    s_endpgm
L_parallel_sum__grouped_kv_mqa__dense_activation_squared_relu__prompt_kernel_loader:
    s_cmp_eq_u32 s38, 7
    s_cbranch_scc1 L_isq_67
    s_sub_u32 s39, s38, 5
    s_mul_i32 s39, s39, 384
    s_add_u32 s39, s39, 0
    v_add_u32 v7, s39, v1
    v_mul_u32_u24 v8, 683, v7
    v_lshrrev_b32 v8, 14, v8
    v_mul_u32_u24 v9, 24, v8
    v_sub_u32 v9, v7, v9
    v_bfe_u32 v10, v8, 1, 1
    v_lshlrev_b32 v10, 2, v10
    v_xor_b32 v9, v9, v10
    v_mul_u32_u24 v8, 3072, v8
    v_lshl_add_u32 v40, v9, 4, v8
    s_sub_u32 s39, s38, 5
    s_mul_i32 s39, s39, 384
    s_add_u32 s39, s39, 64
    v_add_u32 v7, s39, v1
    v_mul_u32_u24 v8, 683, v7
    v_lshrrev_b32 v8, 14, v8
    v_mul_u32_u24 v9, 24, v8
    v_sub_u32 v9, v7, v9
    v_bfe_u32 v10, v8, 1, 1
    v_lshlrev_b32 v10, 2, v10
    v_xor_b32 v9, v9, v10
    v_mul_u32_u24 v8, 3072, v8
    v_lshl_add_u32 v41, v9, 4, v8
    s_sub_u32 s39, s38, 5
    s_mul_i32 s39, s39, 384
    s_add_u32 s39, s39, 128
    v_add_u32 v7, s39, v1
    v_mul_u32_u24 v8, 683, v7
    v_lshrrev_b32 v8, 14, v8
    v_mul_u32_u24 v9, 24, v8
    v_sub_u32 v9, v7, v9
    v_bfe_u32 v10, v8, 1, 1
    v_lshlrev_b32 v10, 2, v10
    v_xor_b32 v9, v9, v10
    v_mul_u32_u24 v8, 3072, v8
    v_lshl_add_u32 v42, v9, 4, v8
    s_sub_u32 s39, s38, 5
    s_mul_i32 s39, s39, 384
    s_add_u32 s39, s39, 192
    v_add_u32 v7, s39, v1
    v_mul_u32_u24 v8, 683, v7
    v_lshrrev_b32 v8, 14, v8
    v_mul_u32_u24 v9, 24, v8
    v_sub_u32 v9, v7, v9
    v_bfe_u32 v10, v8, 1, 1
    v_lshlrev_b32 v10, 2, v10
    v_xor_b32 v9, v9, v10
    v_mul_u32_u24 v8, 3072, v8
    v_lshl_add_u32 v43, v9, 4, v8
    s_sub_u32 s39, s38, 5
    s_mul_i32 s39, s39, 384
    s_add_u32 s39, s39, 256
    v_add_u32 v7, s39, v1
    v_mul_u32_u24 v8, 683, v7
    v_lshrrev_b32 v8, 14, v8
    v_mul_u32_u24 v9, 24, v8
    v_sub_u32 v9, v7, v9
    v_bfe_u32 v10, v8, 1, 1
    v_lshlrev_b32 v10, 2, v10
    v_xor_b32 v9, v9, v10
    v_mul_u32_u24 v8, 3072, v8
    v_lshl_add_u32 v44, v9, 4, v8
    s_sub_u32 s39, s38, 5
    s_mul_i32 s39, s39, 384
    s_add_u32 s39, s39, 320
    v_add_u32 v7, s39, v1
    v_mul_u32_u24 v8, 683, v7
    v_lshrrev_b32 v8, 14, v8
    v_mul_u32_u24 v9, 24, v8
    v_sub_u32 v9, v7, v9
    v_bfe_u32 v10, v8, 1, 1
    v_lshlrev_b32 v10, 2, v10
    v_xor_b32 v9, v9, v10
    v_mul_u32_u24 v8, 3072, v8
    v_lshl_add_u32 v45, v9, 4, v8
    s_branch L_setup_done_68
L_isq_67:
    v_add_u32 v7, 0, v1
    v_mul_u32_u24 v8, 171, v7
    v_lshrrev_b32 v8, 11, v8
    v_mul_u32_u24 v9, 12, v8
    v_sub_u32 v9, v7, v9
    v_mul_u32_u24 v8, 1280, v8
    v_lshl_add_u32 v40, v9, 4, v8
    v_cmp_lt_u32 vcc, 9, v9
    v_mov_b32 v10, 1073741824
    s_nop 0
    v_cndmask_b32 v40, v40, v10, vcc
    v_add_u32 v7, 64, v1
    v_mul_u32_u24 v8, 171, v7
    v_lshrrev_b32 v8, 11, v8
    v_mul_u32_u24 v9, 12, v8
    v_sub_u32 v9, v7, v9
    v_mul_u32_u24 v8, 1280, v8
    v_lshl_add_u32 v41, v9, 4, v8
    v_cmp_lt_u32 vcc, 9, v9
    v_mov_b32 v10, 1073741824
    s_nop 0
    v_cndmask_b32 v41, v41, v10, vcc
    v_add_u32 v7, 128, v1
    v_mul_u32_u24 v8, 171, v7
    v_lshrrev_b32 v8, 11, v8
    v_mul_u32_u24 v9, 12, v8
    v_sub_u32 v9, v7, v9
    v_mul_u32_u24 v8, 1280, v8
    v_lshl_add_u32 v42, v9, 4, v8
    v_cmp_lt_u32 vcc, 9, v9
    v_mov_b32 v10, 1073741824
    s_nop 0
    v_cndmask_b32 v42, v42, v10, vcc
    v_add_u32 v7, 192, v1
    v_mul_u32_u24 v8, 171, v7
    v_lshrrev_b32 v8, 11, v8
    v_mul_u32_u24 v9, 12, v8
    v_sub_u32 v9, v7, v9
    v_mul_u32_u24 v8, 1280, v8
    v_lshl_add_u32 v43, v9, 4, v8
    v_cmp_lt_u32 vcc, 9, v9
    v_mov_b32 v10, 1073741824
    s_nop 0
    v_cndmask_b32 v43, v43, v10, vcc
    v_add_u32 v7, 256, v1
    v_mul_u32_u24 v8, 171, v7
    v_lshrrev_b32 v8, 11, v8
    v_mul_u32_u24 v9, 12, v8
    v_sub_u32 v9, v7, v9
    v_mul_u32_u24 v8, 1280, v8
    v_lshl_add_u32 v44, v9, 4, v8
    v_cmp_lt_u32 vcc, 9, v9
    v_mov_b32 v10, 1073741824
    s_nop 0
    v_cndmask_b32 v44, v44, v10, vcc
    v_add_u32 v7, 320, v1
    v_mul_u32_u24 v8, 171, v7
    v_lshrrev_b32 v8, 11, v8
    v_mul_u32_u24 v9, 12, v8
    v_sub_u32 v9, v7, v9
    v_mul_u32_u24 v8, 1280, v8
    v_lshl_add_u32 v45, v9, 4, v8
    v_cmp_lt_u32 vcc, 9, v9
    v_mov_b32 v10, 1073741824
    s_nop 0
    v_cndmask_b32 v45, v45, v10, vcc
L_setup_done_68:
    v_mov_b32 v144, 0x3f803f80
    v_mov_b32 v146, 0
    v_mov_b32 v147, 0
    v_mov_b32 v148, 0
    v_mov_b32 v149, 0
    v_mov_b32 v150, 0
    v_mov_b32 v151, 0
    v_mov_b32 v152, 0
    v_mov_b32 v153, 0
    v_add_u32 v7, 0, v5
    v_and_b32 v8, 15, v7
    v_xor_b32 v8, v8, v4
    v_mul_u32_u24 v7, 1280, v7
    v_lshl_add_u32 v154, v8, 4, v7
    v_add_u32 v7, 4, v5
    v_and_b32 v8, 15, v7
    v_xor_b32 v8, v8, v4
    v_mul_u32_u24 v7, 1280, v7
    v_lshl_add_u32 v155, v8, 4, v7
    s_cmp_eq_u32 s77, 0
    s_cbranch_scc1 L_nd_69
    s_sub_u32 s39, s38, 4
    s_mul_i32 s39, s39, 10
    s_and_b32 s40, s79, 1
    s_mul_i32 s40, s40, 40960
    v_and_b32 v20, 31, v1
    v_lshrrev_b32 v21, 5, v1
    v_and_b32 v22, 15, v20
    v_xor_b32 v22, v22, v21
    v_mul_u32_u24 v16, 1280, v20
    v_lshl_add_u32 v16, v22, 4, v16
    v_lshrrev_b32 v20, 5, v1
    v_bfe_u32 v22, v1, 2, 2
    v_lshl_add_u32 v20, v20, 3, v22
    v_bfe_u32 v21, v1, 4, 1
    v_lshlrev_b32 v21, 5, v21
    v_and_b32 v23, 3, v1
    v_lshl_add_u32 v21, v23, 3, v21
    v_mul_u32_u24 v17, 40, v20
    v_add_u32 v17, v17, v21
    v_add_u32 v17, 137216, v17
    s_add_u32 s41, s39, 0
    s_and_b32 s42, s41, 7
    s_lshl_b32 s42, s42, 5
    s_lshr_b32 s43, s41, 3
    s_lshl_b32 s43, s43, 8
    s_add_u32 s43, s43, s40
    v_xor_b32 v46, s42, v16
    v_add_u32 v46, s43, v46
    s_mul_i32 s41, s41, 640
    v_add_u32 v160, s41, v17
    s_add_u32 s41, s39, 1
    s_and_b32 s42, s41, 7
    s_lshl_b32 s42, s42, 5
    s_lshr_b32 s43, s41, 3
    s_lshl_b32 s43, s43, 8
    s_add_u32 s43, s43, s40
    v_xor_b32 v47, s42, v16
    v_add_u32 v47, s43, v47
    s_mul_i32 s41, s41, 640
    v_add_u32 v161, s41, v17
    s_add_u32 s41, s39, 2
    s_and_b32 s42, s41, 7
    s_lshl_b32 s42, s42, 5
    s_lshr_b32 s43, s41, 3
    s_lshl_b32 s43, s43, 8
    s_add_u32 s43, s43, s40
    v_xor_b32 v48, s42, v16
    v_add_u32 v48, s43, v48
    s_mul_i32 s41, s41, 640
    v_add_u32 v162, s41, v17
    s_add_u32 s41, s39, 3
    s_and_b32 s42, s41, 7
    s_lshl_b32 s42, s42, 5
    s_lshr_b32 s43, s41, 3
    s_lshl_b32 s43, s43, 8
    s_add_u32 s43, s43, s40
    v_xor_b32 v49, s42, v16
    v_add_u32 v49, s43, v49
    s_mul_i32 s41, s41, 640
    v_add_u32 v163, s41, v17
    s_add_u32 s41, s39, 4
    s_and_b32 s42, s41, 7
    s_lshl_b32 s42, s42, 5
    s_lshr_b32 s43, s41, 3
    s_lshl_b32 s43, s43, 8
    s_add_u32 s43, s43, s40
    v_xor_b32 v50, s42, v16
    v_add_u32 v50, s43, v50
    s_mul_i32 s41, s41, 640
    v_add_u32 v164, s41, v17
    s_add_u32 s41, s39, 5
    s_and_b32 s42, s41, 7
    s_lshl_b32 s42, s42, 5
    s_lshr_b32 s43, s41, 3
    s_lshl_b32 s43, s43, 8
    s_add_u32 s43, s43, s40
    v_xor_b32 v51, s42, v16
    v_add_u32 v51, s43, v51
    s_mul_i32 s41, s41, 640
    v_add_u32 v165, s41, v17
    s_add_u32 s41, s39, 6
    s_and_b32 s42, s41, 7
    s_lshl_b32 s42, s42, 5
    s_lshr_b32 s43, s41, 3
    s_lshl_b32 s43, s43, 8
    s_add_u32 s43, s43, s40
    v_xor_b32 v52, s42, v16
    v_add_u32 v52, s43, v52
    s_mul_i32 s41, s41, 640
    v_add_u32 v166, s41, v17
    s_add_u32 s41, s39, 7
    s_and_b32 s42, s41, 7
    s_lshl_b32 s42, s42, 5
    s_lshr_b32 s43, s41, 3
    s_lshl_b32 s43, s43, 8
    s_add_u32 s43, s43, s40
    v_xor_b32 v53, s42, v16
    v_add_u32 v53, s43, v53
    s_mul_i32 s41, s41, 640
    v_add_u32 v167, s41, v17
    s_add_u32 s41, s39, 8
    s_and_b32 s42, s41, 7
    s_lshl_b32 s42, s42, 5
    s_lshr_b32 s43, s41, 3
    s_lshl_b32 s43, s43, 8
    s_add_u32 s43, s43, s40
    v_xor_b32 v54, s42, v16
    v_add_u32 v54, s43, v54
    s_mul_i32 s41, s41, 640
    v_add_u32 v168, s41, v17
    s_add_u32 s41, s39, 9
    s_and_b32 s42, s41, 7
    s_lshl_b32 s42, s42, 5
    s_lshr_b32 s43, s41, 3
    s_lshl_b32 s43, s43, 8
    s_add_u32 s43, s43, s40
    v_xor_b32 v55, s42, v16
    v_add_u32 v55, s43, v55
    s_mul_i32 s41, s41, 640
    v_add_u32 v169, s41, v17
    v_mov_b32 v64, 0
    v_mov_b32 v65, 0
    v_mov_b32 v66, 0
    v_mov_b32 v67, 0
    v_mov_b32 v68, 0
    v_mov_b32 v69, 0
    v_mov_b32 v70, 0
    v_mov_b32 v71, 0
    v_mov_b32 v72, 0
    v_mov_b32 v73, 0
    v_mov_b32 v74, 0
    v_mov_b32 v75, 0
    v_mov_b32 v76, 0
    v_mov_b32 v77, 0
    v_mov_b32 v78, 0
    v_mov_b32 v79, 0
L_nd_69:
    s_waitcnt lgkmcnt(0)
    s_mov_b32 s8, s44
    s_mov_b32 s9, s45
    s_mov_b32 s10, 2621440
    s_mov_b32 s11, 0x00020000
    s_mov_b32 s12, s46
    s_mov_b32 s13, s47
    s_mov_b32 s14, 819200
    s_mov_b32 s15, 0x00020000
    s_mov_b32 s16, s56
    s_mov_b32 s17, s57
    s_mov_b32 s18, 1966080
    s_mov_b32 s19, 0x00020000
    s_mov_b32 s24, s68
    s_mov_b32 s25, s69
    s_mov_b32 s26, 13008896
    s_mov_b32 s27, 0x00020000
    s_mov_b32 s32, s58
    s_mov_b32 s33, s59
    s_mov_b32 s34, 3072
    s_mov_b32 s35, 0x00020000
    s_cmp_lt_u32 s79, 2
    s_cselect_b32 s20, s48, s50
    s_cselect_b32 s21, s49, s51
    s_mov_b32 s22, 25600
    s_mov_b32 s23, 0x00020000
    s_cmp_eq_u32 s38, 7
    s_cselect_b32 s28, s12, s16
    s_cselect_b32 s29, s13, s17
    s_cselect_b32 s30, s14, s18
    s_cselect_b32 s31, s15, s19
    s_movk_i32 s39, 160
    s_cselect_b32 s46, s39, 384
    s_mul_i32 s46, s46, s37
    s_mov_b32 s39, 40960
    s_cselect_b32 s47, s39, 98304
    s_sub_u32 s48, s38, 5
    s_mul_i32 s48, s48, 6144
    s_add_u32 s48, s48, 81920
    s_mul_i32 s39, s36, 81920
    s_add_u32 s40, s39, 5120
    buffer_load_dwordx4 v[80:83], v249, s[8:11], s39 offen offset:0
    buffer_load_dwordx4 v[84:87], v249, s[8:11], s39 offen offset:256
    buffer_load_dwordx4 v[88:91], v249, s[8:11], s39 offen offset:512
    buffer_load_dwordx4 v[92:95], v249, s[8:11], s39 offen offset:768
    buffer_load_dwordx4 v[96:99], v249, s[8:11], s39 offen offset:1024
    buffer_load_dwordx4 v[100:103], v249, s[8:11], s40 offen offset:0
    buffer_load_dwordx4 v[104:107], v249, s[8:11], s40 offen offset:256
    buffer_load_dwordx4 v[108:111], v249, s[8:11], s40 offen offset:512
    buffer_load_dwordx4 v[112:115], v249, s[8:11], s40 offen offset:768
    buffer_load_dwordx4 v[116:119], v249, s[8:11], s40 offen offset:1024
    s_add_u32 m0, s48, 0
    s_nop 0
    buffer_load_dwordx4 v40, s[28:31], s46 offen lds
    s_add_u32 m0, s48, 1024
    s_nop 0
    buffer_load_dwordx4 v41, s[28:31], s46 offen lds
    s_add_u32 m0, s48, 2048
    s_nop 0
    buffer_load_dwordx4 v42, s[28:31], s46 offen lds
    s_add_u32 m0, s48, 3072
    s_nop 0
    buffer_load_dwordx4 v43, s[28:31], s46 offen lds
    s_add_u32 m0, s48, 4096
    s_nop 0
    buffer_load_dwordx4 v44, s[28:31], s46 offen lds
    s_add_u32 m0, s48, 5120
    s_nop 0
    buffer_load_dwordx4 v45, s[28:31], s46 offen lds
    s_add_u32 s46, s46, s47
    s_cmp_eq_u32 s77, 0
    s_cbranch_scc1 L_nokvw_70
    v_lshlrev_b32 v255, 4, v1
    s_lshl_b32 s39, s38, 10
    s_add_u32 m0, s39, 137216
    s_add_u32 s40, s39, 0
    buffer_load_dwordx4 v255, s[20:23], s40 offen lds
    s_add_u32 m0, s39, 145408
    s_add_u32 s40, s39, 8192
    buffer_load_dwordx4 v255, s[20:23], s40 offen lds
    s_add_u32 m0, s39, 153600
    s_add_u32 s40, s39, 16384
    buffer_load_dwordx4 v255, s[20:23], s40 offen lds
    s_add_u32 m0, s39, 161792
    s_add_u32 s40, s39, 24576
    buffer_load_dwordx4 v255, s[20:23], s40 offen lds
L_nokvw_70:
    s_cmp_eq_u32 s77, 0
    s_cbranch_scc1 L_wx1_71
    s_waitcnt vmcnt(10)
    s_branch L_wx2_72
L_wx1_71:
    s_waitcnt vmcnt(6)
L_wx2_72:
    v_dot2_f32_bf16 v146, v80, v144, v146
    v_dot2_f32_bf16 v148, v80, v80, v148
    v_dot2_f32_bf16 v147, v81, v144, v147
    v_dot2_f32_bf16 v149, v81, v81, v149
    v_dot2_f32_bf16 v146, v82, v144, v146
    v_dot2_f32_bf16 v148, v82, v82, v148
    v_dot2_f32_bf16 v147, v83, v144, v147
    v_dot2_f32_bf16 v149, v83, v83, v149
    v_dot2_f32_bf16 v146, v84, v144, v146
    v_dot2_f32_bf16 v148, v84, v84, v148
    v_dot2_f32_bf16 v147, v85, v144, v147
    v_dot2_f32_bf16 v149, v85, v85, v149
    v_dot2_f32_bf16 v146, v86, v144, v146
    v_dot2_f32_bf16 v148, v86, v86, v148
    v_dot2_f32_bf16 v147, v87, v144, v147
    v_dot2_f32_bf16 v149, v87, v87, v149
    v_dot2_f32_bf16 v146, v88, v144, v146
    v_dot2_f32_bf16 v148, v88, v88, v148
    v_dot2_f32_bf16 v147, v89, v144, v147
    v_dot2_f32_bf16 v149, v89, v89, v149
    v_dot2_f32_bf16 v146, v90, v144, v146
    v_dot2_f32_bf16 v148, v90, v90, v148
    v_dot2_f32_bf16 v147, v91, v144, v147
    v_dot2_f32_bf16 v149, v91, v91, v149
    v_dot2_f32_bf16 v146, v92, v144, v146
    v_dot2_f32_bf16 v148, v92, v92, v148
    v_dot2_f32_bf16 v147, v93, v144, v147
    v_dot2_f32_bf16 v149, v93, v93, v149
    v_dot2_f32_bf16 v146, v94, v144, v146
    v_dot2_f32_bf16 v148, v94, v94, v148
    v_dot2_f32_bf16 v147, v95, v144, v147
    v_dot2_f32_bf16 v149, v95, v95, v149
    v_dot2_f32_bf16 v146, v96, v144, v146
    v_dot2_f32_bf16 v148, v96, v96, v148
    v_dot2_f32_bf16 v147, v97, v144, v147
    v_dot2_f32_bf16 v149, v97, v97, v149
    v_dot2_f32_bf16 v146, v98, v144, v146
    v_dot2_f32_bf16 v148, v98, v98, v148
    v_dot2_f32_bf16 v147, v99, v144, v147
    v_dot2_f32_bf16 v149, v99, v99, v149
    v_dot2_f32_bf16 v150, v100, v144, v150
    v_dot2_f32_bf16 v152, v100, v100, v152
    v_dot2_f32_bf16 v151, v101, v144, v151
    v_dot2_f32_bf16 v153, v101, v101, v153
    v_dot2_f32_bf16 v150, v102, v144, v150
    v_dot2_f32_bf16 v152, v102, v102, v152
    v_dot2_f32_bf16 v151, v103, v144, v151
    v_dot2_f32_bf16 v153, v103, v103, v153
    v_dot2_f32_bf16 v150, v104, v144, v150
    v_dot2_f32_bf16 v152, v104, v104, v152
    v_dot2_f32_bf16 v151, v105, v144, v151
    v_dot2_f32_bf16 v153, v105, v105, v153
    v_dot2_f32_bf16 v150, v106, v144, v150
    v_dot2_f32_bf16 v152, v106, v106, v152
    v_dot2_f32_bf16 v151, v107, v144, v151
    v_dot2_f32_bf16 v153, v107, v107, v153
    v_dot2_f32_bf16 v150, v108, v144, v150
    v_dot2_f32_bf16 v152, v108, v108, v152
    v_dot2_f32_bf16 v151, v109, v144, v151
    v_dot2_f32_bf16 v153, v109, v109, v153
    v_dot2_f32_bf16 v150, v110, v144, v150
    v_dot2_f32_bf16 v152, v110, v110, v152
    v_dot2_f32_bf16 v151, v111, v144, v151
    v_dot2_f32_bf16 v153, v111, v111, v153
    v_dot2_f32_bf16 v150, v112, v144, v150
    v_dot2_f32_bf16 v152, v112, v112, v152
    v_dot2_f32_bf16 v151, v113, v144, v151
    v_dot2_f32_bf16 v153, v113, v113, v153
    v_dot2_f32_bf16 v150, v114, v144, v150
    v_dot2_f32_bf16 v152, v114, v114, v152
    v_dot2_f32_bf16 v151, v115, v144, v151
    v_dot2_f32_bf16 v153, v115, v115, v153
    v_dot2_f32_bf16 v150, v116, v144, v150
    v_dot2_f32_bf16 v152, v116, v116, v152
    v_dot2_f32_bf16 v151, v117, v144, v151
    v_dot2_f32_bf16 v153, v117, v117, v153
    v_dot2_f32_bf16 v150, v118, v144, v150
    v_dot2_f32_bf16 v152, v118, v118, v152
    v_dot2_f32_bf16 v151, v119, v144, v151
    v_dot2_f32_bf16 v153, v119, v119, v153
    s_mov_b32 s39, 986500301
    s_mov_b32 s40, 925353388
    s_nop 1
    v_add_f32 v146, v146, v147
    v_add_f32 v148, v148, v149
    v_add_f32 v150, v150, v151
    v_add_f32 v152, v152, v153
    s_nop 0
    v_add_f32_dpp v146, v146, v146 row_ror:8 row_mask:0xf bank_mask:0xf
    v_add_f32_dpp v148, v148, v148 row_ror:8 row_mask:0xf bank_mask:0xf
    v_add_f32_dpp v150, v150, v150 row_ror:8 row_mask:0xf bank_mask:0xf
    v_add_f32_dpp v152, v152, v152 row_ror:8 row_mask:0xf bank_mask:0xf
    v_add_f32_dpp v146, v146, v146 row_ror:4 row_mask:0xf bank_mask:0xf
    v_add_f32_dpp v148, v148, v148 row_ror:4 row_mask:0xf bank_mask:0xf
    v_add_f32_dpp v150, v150, v150 row_ror:4 row_mask:0xf bank_mask:0xf
    v_add_f32_dpp v152, v152, v152 row_ror:4 row_mask:0xf bank_mask:0xf
    v_add_f32_dpp v146, v146, v146 row_ror:2 row_mask:0xf bank_mask:0xf
    v_add_f32_dpp v148, v148, v148 row_ror:2 row_mask:0xf bank_mask:0xf
    v_add_f32_dpp v150, v150, v150 row_ror:2 row_mask:0xf bank_mask:0xf
    v_add_f32_dpp v152, v152, v152 row_ror:2 row_mask:0xf bank_mask:0xf
    v_add_f32_dpp v146, v146, v146 row_ror:1 row_mask:0xf bank_mask:0xf
    v_add_f32_dpp v148, v148, v148 row_ror:1 row_mask:0xf bank_mask:0xf
    v_add_f32_dpp v150, v150, v150 row_ror:1 row_mask:0xf bank_mask:0xf
    v_add_f32_dpp v152, v152, v152 row_ror:1 row_mask:0xf bank_mask:0xf
    v_mul_f32 v146, s39, v146
    v_mul_f32 v148, s39, v148
    v_mul_f32 v150, s39, v150
    v_mul_f32 v152, s39, v152
    v_fma_f32 v148, -v146, v146, v148
    v_fma_f32 v152, -v150, v150, v152
    v_max_f32 v148, 0, v148
    v_max_f32 v152, 0, v152
    v_add_f32 v148, s40, v148
    v_add_f32 v152, s40, v152
    v_rsq_f32 v148, v148
    v_rsq_f32 v152, v152
    s_nop 0
    v_mul_f32 v149, -v146, v148
    v_mul_f32 v153, -v150, v152
    v_lshlrev_b32 v156, 16, v80
    v_and_b32 v157, 0xffff0000, v80
    v_pk_fma_f32 v[156:157], v[156:157], v[148:149], v[148:149] op_sel:[0,0,1] op_sel_hi:[1,0,1]
    v_cvt_pk_bf16_f32 v80, v156, v157
    v_lshlrev_b32 v158, 16, v81
    v_and_b32 v159, 0xffff0000, v81
    v_pk_fma_f32 v[158:159], v[158:159], v[148:149], v[148:149] op_sel:[0,0,1] op_sel_hi:[1,0,1]
    v_cvt_pk_bf16_f32 v81, v158, v159
    v_lshlrev_b32 v156, 16, v82
    v_and_b32 v157, 0xffff0000, v82
    v_pk_fma_f32 v[156:157], v[156:157], v[148:149], v[148:149] op_sel:[0,0,1] op_sel_hi:[1,0,1]
    v_cvt_pk_bf16_f32 v82, v156, v157
    v_lshlrev_b32 v158, 16, v83
    v_and_b32 v159, 0xffff0000, v83
    v_pk_fma_f32 v[158:159], v[158:159], v[148:149], v[148:149] op_sel:[0,0,1] op_sel_hi:[1,0,1]
    v_cvt_pk_bf16_f32 v83, v158, v159
    ds_write_b128 v154, v[80:83] offset:0
    v_lshlrev_b32 v156, 16, v84
    v_and_b32 v157, 0xffff0000, v84
    v_pk_fma_f32 v[156:157], v[156:157], v[148:149], v[148:149] op_sel:[0,0,1] op_sel_hi:[1,0,1]
    v_cvt_pk_bf16_f32 v84, v156, v157
    v_lshlrev_b32 v158, 16, v85
    v_and_b32 v159, 0xffff0000, v85
    v_pk_fma_f32 v[158:159], v[158:159], v[148:149], v[148:149] op_sel:[0,0,1] op_sel_hi:[1,0,1]
    v_cvt_pk_bf16_f32 v85, v158, v159
    v_lshlrev_b32 v156, 16, v86
    v_and_b32 v157, 0xffff0000, v86
    v_pk_fma_f32 v[156:157], v[156:157], v[148:149], v[148:149] op_sel:[0,0,1] op_sel_hi:[1,0,1]
    v_cvt_pk_bf16_f32 v86, v156, v157
    v_lshlrev_b32 v158, 16, v87
    v_and_b32 v159, 0xffff0000, v87
    v_pk_fma_f32 v[158:159], v[158:159], v[148:149], v[148:149] op_sel:[0,0,1] op_sel_hi:[1,0,1]
    v_cvt_pk_bf16_f32 v87, v158, v159
    ds_write_b128 v154, v[84:87] offset:256
    v_lshlrev_b32 v156, 16, v88
    v_and_b32 v157, 0xffff0000, v88
    v_pk_fma_f32 v[156:157], v[156:157], v[148:149], v[148:149] op_sel:[0,0,1] op_sel_hi:[1,0,1]
    v_cvt_pk_bf16_f32 v88, v156, v157
    v_lshlrev_b32 v158, 16, v89
    v_and_b32 v159, 0xffff0000, v89
    v_pk_fma_f32 v[158:159], v[158:159], v[148:149], v[148:149] op_sel:[0,0,1] op_sel_hi:[1,0,1]
    v_cvt_pk_bf16_f32 v89, v158, v159
    v_lshlrev_b32 v156, 16, v90
    v_and_b32 v157, 0xffff0000, v90
    v_pk_fma_f32 v[156:157], v[156:157], v[148:149], v[148:149] op_sel:[0,0,1] op_sel_hi:[1,0,1]
    v_cvt_pk_bf16_f32 v90, v156, v157
    v_lshlrev_b32 v158, 16, v91
    v_and_b32 v159, 0xffff0000, v91
    v_pk_fma_f32 v[158:159], v[158:159], v[148:149], v[148:149] op_sel:[0,0,1] op_sel_hi:[1,0,1]
    v_cvt_pk_bf16_f32 v91, v158, v159
    ds_write_b128 v154, v[88:91] offset:512
    v_lshlrev_b32 v156, 16, v92
    v_and_b32 v157, 0xffff0000, v92
    v_pk_fma_f32 v[156:157], v[156:157], v[148:149], v[148:149] op_sel:[0,0,1] op_sel_hi:[1,0,1]
    v_cvt_pk_bf16_f32 v92, v156, v157
    v_lshlrev_b32 v158, 16, v93
    v_and_b32 v159, 0xffff0000, v93
    v_pk_fma_f32 v[158:159], v[158:159], v[148:149], v[148:149] op_sel:[0,0,1] op_sel_hi:[1,0,1]
    v_cvt_pk_bf16_f32 v93, v158, v159
    v_lshlrev_b32 v156, 16, v94
    v_and_b32 v157, 0xffff0000, v94
    v_pk_fma_f32 v[156:157], v[156:157], v[148:149], v[148:149] op_sel:[0,0,1] op_sel_hi:[1,0,1]
    v_cvt_pk_bf16_f32 v94, v156, v157
    v_lshlrev_b32 v158, 16, v95
    v_and_b32 v159, 0xffff0000, v95
    v_pk_fma_f32 v[158:159], v[158:159], v[148:149], v[148:149] op_sel:[0,0,1] op_sel_hi:[1,0,1]
    v_cvt_pk_bf16_f32 v95, v158, v159
    ds_write_b128 v154, v[92:95] offset:768
    v_lshlrev_b32 v156, 16, v96
    v_and_b32 v157, 0xffff0000, v96
    v_pk_fma_f32 v[156:157], v[156:157], v[148:149], v[148:149] op_sel:[0,0,1] op_sel_hi:[1,0,1]
    v_cvt_pk_bf16_f32 v96, v156, v157
    v_lshlrev_b32 v158, 16, v97
    v_and_b32 v159, 0xffff0000, v97
    v_pk_fma_f32 v[158:159], v[158:159], v[148:149], v[148:149] op_sel:[0,0,1] op_sel_hi:[1,0,1]
    v_cvt_pk_bf16_f32 v97, v158, v159
    v_lshlrev_b32 v156, 16, v98
    v_and_b32 v157, 0xffff0000, v98
    v_pk_fma_f32 v[156:157], v[156:157], v[148:149], v[148:149] op_sel:[0,0,1] op_sel_hi:[1,0,1]
    v_cvt_pk_bf16_f32 v98, v156, v157
    v_lshlrev_b32 v158, 16, v99
    v_and_b32 v159, 0xffff0000, v99
    v_pk_fma_f32 v[158:159], v[158:159], v[148:149], v[148:149] op_sel:[0,0,1] op_sel_hi:[1,0,1]
    v_cvt_pk_bf16_f32 v99, v158, v159
    ds_write_b128 v154, v[96:99] offset:1024
    v_lshlrev_b32 v156, 16, v100
    v_and_b32 v157, 0xffff0000, v100
    v_pk_fma_f32 v[156:157], v[156:157], v[152:153], v[152:153] op_sel:[0,0,1] op_sel_hi:[1,0,1]
    v_cvt_pk_bf16_f32 v100, v156, v157
    v_lshlrev_b32 v158, 16, v101
    v_and_b32 v159, 0xffff0000, v101
    v_pk_fma_f32 v[158:159], v[158:159], v[152:153], v[152:153] op_sel:[0,0,1] op_sel_hi:[1,0,1]
    v_cvt_pk_bf16_f32 v101, v158, v159
    v_lshlrev_b32 v156, 16, v102
    v_and_b32 v157, 0xffff0000, v102
    v_pk_fma_f32 v[156:157], v[156:157], v[152:153], v[152:153] op_sel:[0,0,1] op_sel_hi:[1,0,1]
    v_cvt_pk_bf16_f32 v102, v156, v157
    v_lshlrev_b32 v158, 16, v103
    v_and_b32 v159, 0xffff0000, v103
    v_pk_fma_f32 v[158:159], v[158:159], v[152:153], v[152:153] op_sel:[0,0,1] op_sel_hi:[1,0,1]
    v_cvt_pk_bf16_f32 v103, v158, v159
    ds_write_b128 v155, v[100:103] offset:0
    v_lshlrev_b32 v156, 16, v104
    v_and_b32 v157, 0xffff0000, v104
    v_pk_fma_f32 v[156:157], v[156:157], v[152:153], v[152:153] op_sel:[0,0,1] op_sel_hi:[1,0,1]
    v_cvt_pk_bf16_f32 v104, v156, v157
    v_lshlrev_b32 v158, 16, v105
    v_and_b32 v159, 0xffff0000, v105
    v_pk_fma_f32 v[158:159], v[158:159], v[152:153], v[152:153] op_sel:[0,0,1] op_sel_hi:[1,0,1]
    v_cvt_pk_bf16_f32 v105, v158, v159
    v_lshlrev_b32 v156, 16, v106
    v_and_b32 v157, 0xffff0000, v106
    v_pk_fma_f32 v[156:157], v[156:157], v[152:153], v[152:153] op_sel:[0,0,1] op_sel_hi:[1,0,1]
    v_cvt_pk_bf16_f32 v106, v156, v157
    v_lshlrev_b32 v158, 16, v107
    v_and_b32 v159, 0xffff0000, v107
    v_pk_fma_f32 v[158:159], v[158:159], v[152:153], v[152:153] op_sel:[0,0,1] op_sel_hi:[1,0,1]
    v_cvt_pk_bf16_f32 v107, v158, v159
    ds_write_b128 v155, v[104:107] offset:256
    v_lshlrev_b32 v156, 16, v108
    v_and_b32 v157, 0xffff0000, v108
    v_pk_fma_f32 v[156:157], v[156:157], v[152:153], v[152:153] op_sel:[0,0,1] op_sel_hi:[1,0,1]
    v_cvt_pk_bf16_f32 v108, v156, v157
    v_lshlrev_b32 v158, 16, v109
    v_and_b32 v159, 0xffff0000, v109
    v_pk_fma_f32 v[158:159], v[158:159], v[152:153], v[152:153] op_sel:[0,0,1] op_sel_hi:[1,0,1]
    v_cvt_pk_bf16_f32 v109, v158, v159
    v_lshlrev_b32 v156, 16, v110
    v_and_b32 v157, 0xffff0000, v110
    v_pk_fma_f32 v[156:157], v[156:157], v[152:153], v[152:153] op_sel:[0,0,1] op_sel_hi:[1,0,1]
    v_cvt_pk_bf16_f32 v110, v156, v157
    v_lshlrev_b32 v158, 16, v111
    v_and_b32 v159, 0xffff0000, v111
    v_pk_fma_f32 v[158:159], v[158:159], v[152:153], v[152:153] op_sel:[0,0,1] op_sel_hi:[1,0,1]
    v_cvt_pk_bf16_f32 v111, v158, v159
    ds_write_b128 v155, v[108:111] offset:512
    v_lshlrev_b32 v156, 16, v112
    v_and_b32 v157, 0xffff0000, v112
    v_pk_fma_f32 v[156:157], v[156:157], v[152:153], v[152:153] op_sel:[0,0,1] op_sel_hi:[1,0,1]
    v_cvt_pk_bf16_f32 v112, v156, v157
    v_lshlrev_b32 v158, 16, v113
    v_and_b32 v159, 0xffff0000, v113
    v_pk_fma_f32 v[158:159], v[158:159], v[152:153], v[152:153] op_sel:[0,0,1] op_sel_hi:[1,0,1]
    v_cvt_pk_bf16_f32 v113, v158, v159
    v_lshlrev_b32 v156, 16, v114
    v_and_b32 v157, 0xffff0000, v114
    v_pk_fma_f32 v[156:157], v[156:157], v[152:153], v[152:153] op_sel:[0,0,1] op_sel_hi:[1,0,1]
    v_cvt_pk_bf16_f32 v114, v156, v157
    v_lshlrev_b32 v158, 16, v115
    v_and_b32 v159, 0xffff0000, v115
    v_pk_fma_f32 v[158:159], v[158:159], v[152:153], v[152:153] op_sel:[0,0,1] op_sel_hi:[1,0,1]
    v_cvt_pk_bf16_f32 v115, v158, v159
    ds_write_b128 v155, v[112:115] offset:768
    v_lshlrev_b32 v156, 16, v116
    v_and_b32 v157, 0xffff0000, v116
    v_pk_fma_f32 v[156:157], v[156:157], v[152:153], v[152:153] op_sel:[0,0,1] op_sel_hi:[1,0,1]
    v_cvt_pk_bf16_f32 v116, v156, v157
    v_lshlrev_b32 v158, 16, v117
    v_and_b32 v159, 0xffff0000, v117
    v_pk_fma_f32 v[158:159], v[158:159], v[152:153], v[152:153] op_sel:[0,0,1] op_sel_hi:[1,0,1]
    v_cvt_pk_bf16_f32 v117, v158, v159
    v_lshlrev_b32 v156, 16, v118
    v_and_b32 v157, 0xffff0000, v118
    v_pk_fma_f32 v[156:157], v[156:157], v[152:153], v[152:153] op_sel:[0,0,1] op_sel_hi:[1,0,1]
    v_cvt_pk_bf16_f32 v118, v156, v157
    v_lshlrev_b32 v158, 16, v119
    v_and_b32 v159, 0xffff0000, v119
    v_pk_fma_f32 v[158:159], v[158:159], v[152:153], v[152:153] op_sel:[0,0,1] op_sel_hi:[1,0,1]
    v_cvt_pk_bf16_f32 v119, v158, v159
    ds_write_b128 v155, v[116:119] offset:1024
    s_add_u32 m0, s48, 18432
    s_nop 0
    buffer_load_dwordx4 v40, s[28:31], s46 offen lds
    s_add_u32 m0, s48, 19456
    s_nop 0
    buffer_load_dwordx4 v41, s[28:31], s46 offen lds
    s_add_u32 m0, s48, 20480
    s_nop 0
    buffer_load_dwordx4 v42, s[28:31], s46 offen lds
    s_add_u32 m0, s48, 21504
    s_nop 0
    buffer_load_dwordx4 v43, s[28:31], s46 offen lds
    s_add_u32 m0, s48, 22528
    s_nop 0
    buffer_load_dwordx4 v44, s[28:31], s46 offen lds
    s_add_u32 m0, s48, 23552
    s_nop 0
    buffer_load_dwordx4 v45, s[28:31], s46 offen lds
    s_add_u32 s46, s46, s47
    s_add_u32 m0, s48, 36864
    s_nop 0
    buffer_load_dwordx4 v40, s[28:31], s46 offen lds
    s_add_u32 m0, s48, 37888
    s_nop 0
    buffer_load_dwordx4 v41, s[28:31], s46 offen lds
    s_add_u32 m0, s48, 38912
    s_nop 0
    buffer_load_dwordx4 v42, s[28:31], s46 offen lds
    s_add_u32 m0, s48, 39936
    s_nop 0
    buffer_load_dwordx4 v43, s[28:31], s46 offen lds
    s_add_u32 m0, s48, 40960
    s_nop 0
    buffer_load_dwordx4 v44, s[28:31], s46 offen lds
    s_add_u32 m0, s48, 41984
    s_nop 0
    buffer_load_dwordx4 v45, s[28:31], s46 offen lds
    s_add_u32 s46, s46, s47
    s_waitcnt vmcnt(12) lgkmcnt(0)
    s_setprio 0
    s_barrier
    s_cmp_eq_u32 s77, 0
    s_cbranch_scc1 L_nd_73
    ds_read_b128 v[80:83], v46
    ds_read_b64_tr_b16 v[84:85], v160
    ds_read_b64_tr_b16 v[86:87], v160 offset:160
    ds_read_b128 v[88:91], v47
    ds_read_b64_tr_b16 v[92:93], v161
    ds_read_b64_tr_b16 v[94:95], v161 offset:160
    ds_read_b128 v[96:99], v48
    ds_read_b64_tr_b16 v[100:101], v162
    ds_read_b64_tr_b16 v[102:103], v162 offset:160
    ds_read_b128 v[104:107], v49
    ds_read_b64_tr_b16 v[108:109], v163
    ds_read_b64_tr_b16 v[110:111], v163 offset:160
    ds_read_b128 v[112:115], v50
    ds_read_b64_tr_b16 v[116:117], v164
    ds_read_b64_tr_b16 v[118:119], v164 offset:160
    ds_read_b128 v[120:123], v51
    ds_read_b64_tr_b16 v[124:125], v165
    ds_read_b64_tr_b16 v[126:127], v165 offset:160
    ds_read_b128 v[128:131], v52
    ds_read_b64_tr_b16 v[132:133], v166
    ds_read_b64_tr_b16 v[134:135], v166 offset:160
    ds_read_b128 v[136:139], v53
    ds_read_b64_tr_b16 v[140:141], v167
    ds_read_b64_tr_b16 v[142:143], v167 offset:160
    ds_read_b128 v[144:147], v54
    ds_read_b64_tr_b16 v[148:149], v168
    ds_read_b64_tr_b16 v[150:151], v168 offset:160
    ds_read_b128 v[152:155], v55
    ds_read_b64_tr_b16 v[156:157], v169
    ds_read_b64_tr_b16 v[158:159], v169 offset:160
L_nd_73:
    s_waitcnt vmcnt(6)
    s_barrier
    s_add_u32 m0, s48, 0
    s_nop 0
    buffer_load_dwordx4 v40, s[28:31], s46 offen lds
    s_add_u32 m0, s48, 1024
    s_nop 0
    buffer_load_dwordx4 v41, s[28:31], s46 offen lds
    s_add_u32 m0, s48, 2048
    s_nop 0
    buffer_load_dwordx4 v42, s[28:31], s46 offen lds
    s_add_u32 m0, s48, 3072
    s_nop 0
    buffer_load_dwordx4 v43, s[28:31], s46 offen lds
    s_add_u32 m0, s48, 4096
    s_nop 0
    buffer_load_dwordx4 v44, s[28:31], s46 offen lds
    s_add_u32 m0, s48, 5120
    s_nop 0
    buffer_load_dwordx4 v45, s[28:31], s46 offen lds
    s_add_u32 s46, s46, s47
    s_cmp_eq_u32 s77, 0
    s_cbranch_scc1 L_nd_74
    s_waitcnt lgkmcnt(0)
    v_mfma_f32_32x32x16_bf16 v[64:79], v[84:87], v[80:83], v[64:79]
    v_mfma_f32_32x32x16_bf16 v[64:79], v[92:95], v[88:91], v[64:79]
    v_mfma_f32_32x32x16_bf16 v[64:79], v[100:103], v[96:99], v[64:79]
    v_mfma_f32_32x32x16_bf16 v[64:79], v[108:111], v[104:107], v[64:79]
    v_mfma_f32_32x32x16_bf16 v[64:79], v[116:119], v[112:115], v[64:79]
    v_mfma_f32_32x32x16_bf16 v[64:79], v[124:127], v[120:123], v[64:79]
    v_mfma_f32_32x32x16_bf16 v[64:79], v[132:135], v[128:131], v[64:79]
    v_mfma_f32_32x32x16_bf16 v[64:79], v[140:143], v[136:139], v[64:79]
    v_mfma_f32_32x32x16_bf16 v[64:79], v[148:151], v[144:147], v[64:79]
    v_mfma_f32_32x32x16_bf16 v[64:79], v[156:159], v[152:155], v[64:79]
    s_sub_u32 s39, s38, 5
    s_lshl_b32 s39, s39, 12
    s_add_u32 s39, s39, 137216
    v_add_u32 v16, s39, v2
L_nd_74:
    s_waitcnt vmcnt(6)
    s_barrier
    s_add_u32 m0, s48, 18432
    s_nop 0
    buffer_load_dwordx4 v40, s[28:31], s46 offen lds
    s_add_u32 m0, s48, 19456
    s_nop 0
    buffer_load_dwordx4 v41, s[28:31], s46 offen lds
    s_add_u32 m0, s48, 20480
    s_nop 0
    buffer_load_dwordx4 v42, s[28:31], s46 offen lds
    s_add_u32 m0, s48, 21504
    s_nop 0
    buffer_load_dwordx4 v43, s[28:31], s46 offen lds
    s_add_u32 m0, s48, 22528
    s_nop 0
    buffer_load_dwordx4 v44, s[28:31], s46 offen lds
    s_add_u32 m0, s48, 23552
    s_nop 0
    buffer_load_dwordx4 v45, s[28:31], s46 offen lds
    s_add_u32 s46, s46, s47
    s_cmp_eq_u32 s77, 0
    s_cbranch_scc1 L_nd_75
    ds_write_b128 v16, v[64:67] offset:0
    ds_write_b128 v16, v[68:71] offset:1024
    ds_write_b128 v16, v[72:75] offset:2048
    ds_write_b128 v16, v[76:79] offset:3072
    s_waitcnt lgkmcnt(0)
L_nd_75:
    s_waitcnt vmcnt(6)
    s_barrier
    s_add_u32 m0, s48, 36864
    s_nop 0
    buffer_load_dwordx4 v40, s[28:31], s46 offen lds
    s_add_u32 m0, s48, 37888
    s_nop 0
    buffer_load_dwordx4 v41, s[28:31], s46 offen lds
    s_add_u32 m0, s48, 38912
    s_nop 0
    buffer_load_dwordx4 v42, s[28:31], s46 offen lds
    s_add_u32 m0, s48, 39936
    s_nop 0
    buffer_load_dwordx4 v43, s[28:31], s46 offen lds
    s_add_u32 m0, s48, 40960
    s_nop 0
    buffer_load_dwordx4 v44, s[28:31], s46 offen lds
    s_add_u32 m0, s48, 41984
    s_nop 0
    buffer_load_dwordx4 v45, s[28:31], s46 offen lds
    s_add_u32 s46, s46, s47
    s_waitcnt vmcnt(6)
    s_barrier
    s_add_u32 m0, s48, 0
    s_nop 0
    buffer_load_dwordx4 v40, s[28:31], s46 offen lds
    s_add_u32 m0, s48, 1024
    s_nop 0
    buffer_load_dwordx4 v41, s[28:31], s46 offen lds
    s_add_u32 m0, s48, 2048
    s_nop 0
    buffer_load_dwordx4 v42, s[28:31], s46 offen lds
    s_add_u32 m0, s48, 3072
    s_nop 0
    buffer_load_dwordx4 v43, s[28:31], s46 offen lds
    s_add_u32 m0, s48, 4096
    s_nop 0
    buffer_load_dwordx4 v44, s[28:31], s46 offen lds
    s_add_u32 m0, s48, 5120
    s_nop 0
    buffer_load_dwordx4 v45, s[28:31], s46 offen lds
    s_add_u32 s46, s46, s47
    s_waitcnt vmcnt(6)
    s_barrier
    s_add_u32 m0, s48, 18432
    s_nop 0
    buffer_load_dwordx4 v40, s[28:31], s46 offen lds
    s_add_u32 m0, s48, 19456
    s_nop 0
    buffer_load_dwordx4 v41, s[28:31], s46 offen lds
    s_add_u32 m0, s48, 20480
    s_nop 0
    buffer_load_dwordx4 v42, s[28:31], s46 offen lds
    s_add_u32 m0, s48, 21504
    s_nop 0
    buffer_load_dwordx4 v43, s[28:31], s46 offen lds
    s_add_u32 m0, s48, 22528
    s_nop 0
    buffer_load_dwordx4 v44, s[28:31], s46 offen lds
    s_add_u32 m0, s48, 23552
    s_nop 0
    buffer_load_dwordx4 v45, s[28:31], s46 offen lds
    s_add_u32 s46, s46, s47
    s_waitcnt vmcnt(6)
    s_barrier
    s_add_u32 m0, s48, 36864
    s_nop 0
    buffer_load_dwordx4 v40, s[28:31], s46 offen lds
    s_add_u32 m0, s48, 37888
    s_nop 0
    buffer_load_dwordx4 v41, s[28:31], s46 offen lds
    s_add_u32 m0, s48, 38912
    s_nop 0
    buffer_load_dwordx4 v42, s[28:31], s46 offen lds
    s_add_u32 m0, s48, 39936
    s_nop 0
    buffer_load_dwordx4 v43, s[28:31], s46 offen lds
    s_add_u32 m0, s48, 40960
    s_nop 0
    buffer_load_dwordx4 v44, s[28:31], s46 offen lds
    s_add_u32 m0, s48, 41984
    s_nop 0
    buffer_load_dwordx4 v45, s[28:31], s46 offen lds
    s_add_u32 s46, s46, s47
    s_waitcnt vmcnt(6)
    s_barrier
    s_add_u32 m0, s48, 0
    s_nop 0
    buffer_load_dwordx4 v40, s[28:31], s46 offen lds
    s_add_u32 m0, s48, 1024
    s_nop 0
    buffer_load_dwordx4 v41, s[28:31], s46 offen lds
    s_add_u32 m0, s48, 2048
    s_nop 0
    buffer_load_dwordx4 v42, s[28:31], s46 offen lds
    s_add_u32 m0, s48, 3072
    s_nop 0
    buffer_load_dwordx4 v43, s[28:31], s46 offen lds
    s_add_u32 m0, s48, 4096
    s_nop 0
    buffer_load_dwordx4 v44, s[28:31], s46 offen lds
    s_add_u32 m0, s48, 5120
    s_nop 0
    buffer_load_dwordx4 v45, s[28:31], s46 offen lds
    s_add_u32 s46, s46, s47
    s_waitcnt vmcnt(6)
    s_barrier
    s_add_u32 m0, s48, 18432
    s_nop 0
    buffer_load_dwordx4 v40, s[28:31], s46 offen lds
    s_add_u32 m0, s48, 19456
    s_nop 0
    buffer_load_dwordx4 v41, s[28:31], s46 offen lds
    s_add_u32 m0, s48, 20480
    s_nop 0
    buffer_load_dwordx4 v42, s[28:31], s46 offen lds
    s_add_u32 m0, s48, 21504
    s_nop 0
    buffer_load_dwordx4 v43, s[28:31], s46 offen lds
    s_add_u32 m0, s48, 22528
    s_nop 0
    buffer_load_dwordx4 v44, s[28:31], s46 offen lds
    s_add_u32 m0, s48, 23552
    s_nop 0
    buffer_load_dwordx4 v45, s[28:31], s46 offen lds
    s_add_u32 s46, s46, s47
    s_waitcnt vmcnt(6)
    s_barrier
    s_add_u32 m0, s48, 36864
    s_nop 0
    buffer_load_dwordx4 v40, s[28:31], s46 offen lds
    s_add_u32 m0, s48, 37888
    s_nop 0
    buffer_load_dwordx4 v41, s[28:31], s46 offen lds
    s_add_u32 m0, s48, 38912
    s_nop 0
    buffer_load_dwordx4 v42, s[28:31], s46 offen lds
    s_add_u32 m0, s48, 39936
    s_nop 0
    buffer_load_dwordx4 v43, s[28:31], s46 offen lds
    s_add_u32 m0, s48, 40960
    s_nop 0
    buffer_load_dwordx4 v44, s[28:31], s46 offen lds
    s_add_u32 m0, s48, 41984
    s_nop 0
    buffer_load_dwordx4 v45, s[28:31], s46 offen lds
    s_add_u32 s46, s46, s47
    s_waitcnt vmcnt(6)
    s_barrier
    s_add_u32 m0, s48, 0
    s_nop 0
    buffer_load_dwordx4 v40, s[28:31], s46 offen lds
    s_add_u32 m0, s48, 1024
    s_nop 0
    buffer_load_dwordx4 v41, s[28:31], s46 offen lds
    s_add_u32 m0, s48, 2048
    s_nop 0
    buffer_load_dwordx4 v42, s[28:31], s46 offen lds
    s_add_u32 m0, s48, 3072
    s_nop 0
    buffer_load_dwordx4 v43, s[28:31], s46 offen lds
    s_add_u32 m0, s48, 4096
    s_nop 0
    buffer_load_dwordx4 v44, s[28:31], s46 offen lds
    s_add_u32 m0, s48, 5120
    s_nop 0
    buffer_load_dwordx4 v45, s[28:31], s46 offen lds
    s_add_u32 s46, s46, s47
    v_mov_b32 v16, 162816
    ds_read_b32 v17, v16
    s_waitcnt lgkmcnt(0)
    v_readfirstlane_b32 s76, v17
    s_waitcnt vmcnt(6)
    s_barrier
    s_add_u32 m0, s48, 18432
    s_nop 0
    buffer_load_dwordx4 v40, s[28:31], s46 offen lds
    s_add_u32 m0, s48, 19456
    s_nop 0
    buffer_load_dwordx4 v41, s[28:31], s46 offen lds
    s_add_u32 m0, s48, 20480
    s_nop 0
    buffer_load_dwordx4 v42, s[28:31], s46 offen lds
    s_add_u32 m0, s48, 21504
    s_nop 0
    buffer_load_dwordx4 v43, s[28:31], s46 offen lds
    s_add_u32 m0, s48, 22528
    s_nop 0
    buffer_load_dwordx4 v44, s[28:31], s46 offen lds
    s_add_u32 m0, s48, 23552
    s_nop 0
    buffer_load_dwordx4 v45, s[28:31], s46 offen lds
    s_add_u32 s46, s46, s47
    s_waitcnt vmcnt(6)
    s_barrier
    s_add_u32 m0, s48, 36864
    s_nop 0
    buffer_load_dwordx4 v40, s[28:31], s46 offen lds
    s_add_u32 m0, s48, 37888
    s_nop 0
    buffer_load_dwordx4 v41, s[28:31], s46 offen lds
    s_add_u32 m0, s48, 38912
    s_nop 0
    buffer_load_dwordx4 v42, s[28:31], s46 offen lds
    s_add_u32 m0, s48, 39936
    s_nop 0
    buffer_load_dwordx4 v43, s[28:31], s46 offen lds
    s_add_u32 m0, s48, 40960
    s_nop 0
    buffer_load_dwordx4 v44, s[28:31], s46 offen lds
    s_add_u32 m0, s48, 41984
    s_nop 0
    buffer_load_dwordx4 v45, s[28:31], s46 offen lds
    s_add_u32 s46, s46, s47
    s_waitcnt vmcnt(6)
    s_barrier
    s_add_u32 m0, s48, 0
    s_nop 0
    buffer_load_dwordx4 v40, s[28:31], s46 offen lds
    s_add_u32 m0, s48, 1024
    s_nop 0
    buffer_load_dwordx4 v41, s[28:31], s46 offen lds
    s_add_u32 m0, s48, 2048
    s_nop 0
    buffer_load_dwordx4 v42, s[28:31], s46 offen lds
    s_add_u32 m0, s48, 3072
    s_nop 0
    buffer_load_dwordx4 v43, s[28:31], s46 offen lds
    s_add_u32 m0, s48, 4096
    s_nop 0
    buffer_load_dwordx4 v44, s[28:31], s46 offen lds
    s_add_u32 m0, s48, 5120
    s_nop 0
    buffer_load_dwordx4 v45, s[28:31], s46 offen lds
    s_add_u32 s46, s46, s47
    s_waitcnt vmcnt(6)
    s_barrier
    s_add_u32 m0, s48, 18432
    s_nop 0
    buffer_load_dwordx4 v40, s[28:31], s46 offen lds
    s_add_u32 m0, s48, 19456
    s_nop 0
    buffer_load_dwordx4 v41, s[28:31], s46 offen lds
    s_add_u32 m0, s48, 20480
    s_nop 0
    buffer_load_dwordx4 v42, s[28:31], s46 offen lds
    s_add_u32 m0, s48, 21504
    s_nop 0
    buffer_load_dwordx4 v43, s[28:31], s46 offen lds
    s_add_u32 m0, s48, 22528
    s_nop 0
    buffer_load_dwordx4 v44, s[28:31], s46 offen lds
    s_add_u32 m0, s48, 23552
    s_nop 0
    buffer_load_dwordx4 v45, s[28:31], s46 offen lds
    s_add_u32 s46, s46, s47
    s_waitcnt vmcnt(6)
    s_barrier
    s_add_u32 m0, s48, 36864
    s_nop 0
    buffer_load_dwordx4 v40, s[28:31], s46 offen lds
    s_add_u32 m0, s48, 37888
    s_nop 0
    buffer_load_dwordx4 v41, s[28:31], s46 offen lds
    s_add_u32 m0, s48, 38912
    s_nop 0
    buffer_load_dwordx4 v42, s[28:31], s46 offen lds
    s_add_u32 m0, s48, 39936
    s_nop 0
    buffer_load_dwordx4 v43, s[28:31], s46 offen lds
    s_add_u32 m0, s48, 40960
    s_nop 0
    buffer_load_dwordx4 v44, s[28:31], s46 offen lds
    s_add_u32 m0, s48, 41984
    s_nop 0
    buffer_load_dwordx4 v45, s[28:31], s46 offen lds
    s_add_u32 s46, s46, s47
    s_waitcnt vmcnt(6)
    s_barrier
    s_add_u32 m0, s48, 0
    s_nop 0
    buffer_load_dwordx4 v40, s[28:31], s46 offen lds
    s_add_u32 m0, s48, 1024
    s_nop 0
    buffer_load_dwordx4 v41, s[28:31], s46 offen lds
    s_add_u32 m0, s48, 2048
    s_nop 0
    buffer_load_dwordx4 v42, s[28:31], s46 offen lds
    s_add_u32 m0, s48, 3072
    s_nop 0
    buffer_load_dwordx4 v43, s[28:31], s46 offen lds
    s_add_u32 m0, s48, 4096
    s_nop 0
    buffer_load_dwordx4 v44, s[28:31], s46 offen lds
    s_add_u32 m0, s48, 5120
    s_nop 0
    buffer_load_dwordx4 v45, s[28:31], s46 offen lds
    s_add_u32 s46, s46, s47
    s_waitcnt vmcnt(6)
    s_barrier
    s_add_u32 m0, s48, 18432
    s_nop 0
    buffer_load_dwordx4 v40, s[28:31], s46 offen lds
    s_add_u32 m0, s48, 19456
    s_nop 0
    buffer_load_dwordx4 v41, s[28:31], s46 offen lds
    s_add_u32 m0, s48, 20480
    s_nop 0
    buffer_load_dwordx4 v42, s[28:31], s46 offen lds
    s_add_u32 m0, s48, 21504
    s_nop 0
    buffer_load_dwordx4 v43, s[28:31], s46 offen lds
    s_add_u32 m0, s48, 22528
    s_nop 0
    buffer_load_dwordx4 v44, s[28:31], s46 offen lds
    s_add_u32 m0, s48, 23552
    s_nop 0
    buffer_load_dwordx4 v45, s[28:31], s46 offen lds
    s_add_u32 s46, s46, s47
    s_waitcnt vmcnt(6)
    s_barrier
    s_cmp_eq_u32 s38, 5
    s_cbranch_scc0 L_kvn_77
    s_mov_b32 m0, 119808
    s_mov_b32 s58, 37888
    buffer_load_dwordx4 v2, s[24:27], s58 offen sc1 lds
    s_mov_b32 m0, 123904
    s_mov_b32 s58, 41984
    buffer_load_dwordx4 v2, s[24:27], s58 offen sc1 lds
    s_mov_b32 m0, 128000
    s_mov_b32 s58, 46080
    buffer_load_dwordx4 v2, s[24:27], s58 offen sc1 lds
    s_mov_b32 m0, 132096
    s_mov_b32 s58, 50176
    buffer_load_dwordx4 v2, s[24:27], s58 offen sc1 lds
    s_mov_b32 m0, 136192
    s_mov_b32 s58, 54272
    buffer_load_dwordx4 v2, s[24:27], s58 offen sc1 lds
    s_mov_b32 m0, 140288
    s_mov_b32 s58, 58368
    buffer_load_dwordx4 v2, s[24:27], s58 offen sc1 lds
    s_mov_b32 m0, 144384
    s_mov_b32 s58, 62464
    buffer_load_dwordx4 v2, s[24:27], s58 offen sc1 lds
    s_mov_b32 m0, 148480
    s_mov_b32 s58, 66560
    buffer_load_dwordx4 v2, s[24:27], s58 offen sc1 lds
    s_mov_b32 m0, 152576
    s_mov_b32 s58, 70656
    buffer_load_dwordx4 v2, s[24:27], s58 offen sc1 lds
    s_mov_b32 m0, 156672
    s_mov_b32 s58, 74752
    buffer_load_dwordx4 v2, s[24:27], s58 offen sc1 lds
    s_mov_b32 m0, 160768
    s_mov_b32 s58, 78848
    buffer_load_dwordx4 v2, s[24:27], s58 offen sc1 lds
    s_branch L_kvd_76
L_kvn_77:
    s_cmp_eq_u32 s38, 6
    s_cbranch_scc0 L_kvn_78
    s_mov_b32 m0, 120832
    s_mov_b32 s58, 38912
    buffer_load_dwordx4 v2, s[24:27], s58 offen sc1 lds
    s_mov_b32 m0, 124928
    s_mov_b32 s58, 43008
    buffer_load_dwordx4 v2, s[24:27], s58 offen sc1 lds
    s_mov_b32 m0, 129024
    s_mov_b32 s58, 47104
    buffer_load_dwordx4 v2, s[24:27], s58 offen sc1 lds
    s_mov_b32 m0, 133120
    s_mov_b32 s58, 51200
    buffer_load_dwordx4 v2, s[24:27], s58 offen sc1 lds
    s_mov_b32 m0, 137216
    s_mov_b32 s58, 55296
    buffer_load_dwordx4 v2, s[24:27], s58 offen sc1 lds
    s_mov_b32 m0, 141312
    s_mov_b32 s58, 59392
    buffer_load_dwordx4 v2, s[24:27], s58 offen sc1 lds
    s_mov_b32 m0, 145408
    s_mov_b32 s58, 63488
    buffer_load_dwordx4 v2, s[24:27], s58 offen sc1 lds
    s_mov_b32 m0, 149504
    s_mov_b32 s58, 67584
    buffer_load_dwordx4 v2, s[24:27], s58 offen sc1 lds
    s_mov_b32 m0, 153600
    s_mov_b32 s58, 71680
    buffer_load_dwordx4 v2, s[24:27], s58 offen sc1 lds
    s_mov_b32 m0, 157696
    s_mov_b32 s58, 75776
    buffer_load_dwordx4 v2, s[24:27], s58 offen sc1 lds
    s_mov_b32 m0, 161792
    s_mov_b32 s58, 79872
    buffer_load_dwordx4 v2, s[24:27], s58 offen sc1 lds
    s_branch L_kvd_76
L_kvn_78:
    s_cmp_eq_u32 s38, 7
    s_cbranch_scc0 L_kvn_79
    s_mov_b32 m0, 121856
    s_mov_b32 s58, 39936
    buffer_load_dwordx4 v2, s[24:27], s58 offen sc1 lds
    s_mov_b32 m0, 125952
    s_mov_b32 s58, 44032
    buffer_load_dwordx4 v2, s[24:27], s58 offen sc1 lds
    s_mov_b32 m0, 130048
    s_mov_b32 s58, 48128
    buffer_load_dwordx4 v2, s[24:27], s58 offen sc1 lds
    s_mov_b32 m0, 134144
    s_mov_b32 s58, 52224
    buffer_load_dwordx4 v2, s[24:27], s58 offen sc1 lds
    s_mov_b32 m0, 138240
    s_mov_b32 s58, 56320
    buffer_load_dwordx4 v2, s[24:27], s58 offen sc1 lds
    s_mov_b32 m0, 142336
    s_mov_b32 s58, 60416
    buffer_load_dwordx4 v2, s[24:27], s58 offen sc1 lds
    s_mov_b32 m0, 146432
    s_mov_b32 s58, 64512
    buffer_load_dwordx4 v2, s[24:27], s58 offen sc1 lds
    s_mov_b32 m0, 150528
    s_mov_b32 s58, 68608
    buffer_load_dwordx4 v2, s[24:27], s58 offen sc1 lds
    s_mov_b32 m0, 154624
    s_mov_b32 s58, 72704
    buffer_load_dwordx4 v2, s[24:27], s58 offen sc1 lds
    s_mov_b32 m0, 158720
    s_mov_b32 s58, 76800
    buffer_load_dwordx4 v2, s[24:27], s58 offen sc1 lds
    s_mov_b32 m0, 162816
    s_mov_b32 s58, 80896
    buffer_load_dwordx4 v2, s[24:27], s58 offen sc1 lds
    s_branch L_kvd_76
L_kvn_79:
L_kvd_76:
    s_waitcnt vmcnt(11)
    s_barrier
    s_cmp_eq_u32 s38, 5
    s_cbranch_scc0 L_kvn_81
    s_mov_b32 m0, 82944
    s_mov_b32 s58, 1024
    buffer_load_dwordx4 v2, s[24:27], s58 offen sc1 lds
    s_mov_b32 m0, 87040
    s_mov_b32 s58, 5120
    buffer_load_dwordx4 v2, s[24:27], s58 offen sc1 lds
    s_mov_b32 m0, 91136
    s_mov_b32 s58, 9216
    buffer_load_dwordx4 v2, s[24:27], s58 offen sc1 lds
    s_mov_b32 m0, 95232
    s_mov_b32 s58, 13312
    buffer_load_dwordx4 v2, s[24:27], s58 offen sc1 lds
    s_mov_b32 m0, 99328
    s_mov_b32 s58, 17408
    buffer_load_dwordx4 v2, s[24:27], s58 offen sc1 lds
    s_branch L_kvd_80
L_kvn_81:
    s_cmp_eq_u32 s38, 6
    s_cbranch_scc0 L_kvn_82
    s_mov_b32 m0, 83968
    s_mov_b32 s58, 2048
    buffer_load_dwordx4 v2, s[24:27], s58 offen sc1 lds
    s_mov_b32 m0, 88064
    s_mov_b32 s58, 6144
    buffer_load_dwordx4 v2, s[24:27], s58 offen sc1 lds
    s_mov_b32 m0, 92160
    s_mov_b32 s58, 10240
    buffer_load_dwordx4 v2, s[24:27], s58 offen sc1 lds
    s_mov_b32 m0, 96256
    s_mov_b32 s58, 14336
    buffer_load_dwordx4 v2, s[24:27], s58 offen sc1 lds
    s_branch L_kvd_80
L_kvn_82:
    s_cmp_eq_u32 s38, 7
    s_cbranch_scc0 L_kvn_83
    s_mov_b32 m0, 84992
    s_mov_b32 s58, 3072
    buffer_load_dwordx4 v2, s[24:27], s58 offen sc1 lds
    s_mov_b32 m0, 89088
    s_mov_b32 s58, 7168
    buffer_load_dwordx4 v2, s[24:27], s58 offen sc1 lds
    s_mov_b32 m0, 93184
    s_mov_b32 s58, 11264
    buffer_load_dwordx4 v2, s[24:27], s58 offen sc1 lds
    s_mov_b32 m0, 97280
    s_mov_b32 s58, 15360
    buffer_load_dwordx4 v2, s[24:27], s58 offen sc1 lds
    s_branch L_kvd_80
L_kvn_83:
L_kvd_80:
    s_barrier
    s_cmp_eq_u32 s38, 5
    s_cbranch_scc0 L_kvn_85
    s_mov_b32 m0, 101376
    s_mov_b32 s58, 19456
    buffer_load_dwordx4 v2, s[24:27], s58 offen sc1 lds
    s_mov_b32 m0, 105472
    s_mov_b32 s58, 23552
    buffer_load_dwordx4 v2, s[24:27], s58 offen sc1 lds
    s_mov_b32 m0, 109568
    s_mov_b32 s58, 27648
    buffer_load_dwordx4 v2, s[24:27], s58 offen sc1 lds
    s_mov_b32 m0, 113664
    s_mov_b32 s58, 31744
    buffer_load_dwordx4 v2, s[24:27], s58 offen sc1 lds
    s_mov_b32 m0, 117760
    s_mov_b32 s58, 35840
    buffer_load_dwordx4 v2, s[24:27], s58 offen sc1 lds
    s_branch L_kvd_84
L_kvn_85:
    s_cmp_eq_u32 s38, 6
    s_cbranch_scc0 L_kvn_86
    s_mov_b32 m0, 102400
    s_mov_b32 s58, 20480
    buffer_load_dwordx4 v2, s[24:27], s58 offen sc1 lds
    s_mov_b32 m0, 106496
    s_mov_b32 s58, 24576
    buffer_load_dwordx4 v2, s[24:27], s58 offen sc1 lds
    s_mov_b32 m0, 110592
    s_mov_b32 s58, 28672
    buffer_load_dwordx4 v2, s[24:27], s58 offen sc1 lds
    s_mov_b32 m0, 114688
    s_mov_b32 s58, 32768
    buffer_load_dwordx4 v2, s[24:27], s58 offen sc1 lds
    s_branch L_kvd_84
L_kvn_86:
    s_cmp_eq_u32 s38, 7
    s_cbranch_scc0 L_kvn_87
    s_mov_b32 m0, 103424
    s_mov_b32 s58, 21504
    buffer_load_dwordx4 v2, s[24:27], s58 offen sc1 lds
    s_mov_b32 m0, 107520
    s_mov_b32 s58, 25600
    buffer_load_dwordx4 v2, s[24:27], s58 offen sc1 lds
    s_mov_b32 m0, 111616
    s_mov_b32 s58, 29696
    buffer_load_dwordx4 v2, s[24:27], s58 offen sc1 lds
    s_mov_b32 m0, 115712
    s_mov_b32 s58, 33792
    buffer_load_dwordx4 v2, s[24:27], s58 offen sc1 lds
    s_branch L_kvd_84
L_kvn_87:
L_kvd_84:
    s_waitcnt vmcnt(0)
    s_barrier
    s_mov_b32 s59, 0
L_poll_88:
    v_lshlrev_b32 v252, 2, v1
    v_add_u32 v252, 11862272, v252
    buffer_load_dword v253, v252, s[24:27], 0 offen sc1
    s_waitcnt vmcnt(0)
    v_xor_b32 v253, s76, v253
    v_cmp_ne_u32 vcc, 0, v253
    s_add_u32 s59, s59, 1
    s_nop 3
    s_cmp_eq_u64 vcc, 0
    s_cbranch_scc1 L_pollok_89
    s_cmp_gt_u32 s59, 20000
    s_cbranch_scc1 L_pollok_89
    s_sleep 4
    s_branch L_poll_88
L_pollok_89:
    s_cmp_eq_u32 s38, 5
    s_cbranch_scc0 L_kvn_91
    s_mov_b32 m0, 1024
    s_mov_b32 s58, 82944
    buffer_load_dwordx4 v2, s[24:27], s58 offen sc1 lds
    s_mov_b32 m0, 5120
    s_mov_b32 s58, 87040
    buffer_load_dwordx4 v2, s[24:27], s58 offen sc1 lds
    s_mov_b32 m0, 9216
    s_mov_b32 s58, 91136
    buffer_load_dwordx4 v2, s[24:27], s58 offen sc1 lds
    s_mov_b32 m0, 13312
    s_mov_b32 s58, 95232
    buffer_load_dwordx4 v2, s[24:27], s58 offen sc1 lds
    s_mov_b32 m0, 17408
    s_mov_b32 s58, 99328
    buffer_load_dwordx4 v2, s[24:27], s58 offen sc1 lds
    s_mov_b32 m0, 21504
    s_mov_b32 s58, 103424
    buffer_load_dwordx4 v2, s[24:27], s58 offen sc1 lds
    s_mov_b32 m0, 25600
    s_mov_b32 s58, 107520
    buffer_load_dwordx4 v2, s[24:27], s58 offen sc1 lds
    s_mov_b32 m0, 29696
    s_mov_b32 s58, 111616
    buffer_load_dwordx4 v2, s[24:27], s58 offen sc1 lds
    s_mov_b32 m0, 33792
    s_mov_b32 s58, 115712
    buffer_load_dwordx4 v2, s[24:27], s58 offen sc1 lds
    s_mov_b32 m0, 37888
    s_mov_b32 s58, 119808
    buffer_load_dwordx4 v2, s[24:27], s58 offen sc1 lds
    s_mov_b32 m0, 41984
    s_mov_b32 s58, 123904
    buffer_load_dwordx4 v2, s[24:27], s58 offen sc1 lds
    s_mov_b32 m0, 46080
    s_mov_b32 s58, 128000
    buffer_load_dwordx4 v2, s[24:27], s58 offen sc1 lds
    s_mov_b32 m0, 50176
    s_mov_b32 s58, 132096
    buffer_load_dwordx4 v2, s[24:27], s58 offen sc1 lds
    s_mov_b32 m0, 54272
    s_mov_b32 s58, 136192
    buffer_load_dwordx4 v2, s[24:27], s58 offen sc1 lds
    s_mov_b32 m0, 58368
    s_mov_b32 s58, 140288
    buffer_load_dwordx4 v2, s[24:27], s58 offen sc1 lds
    s_mov_b32 m0, 62464
    s_mov_b32 s58, 144384
    buffer_load_dwordx4 v2, s[24:27], s58 offen sc1 lds
    s_mov_b32 m0, 66560
    s_mov_b32 s58, 148480
    buffer_load_dwordx4 v2, s[24:27], s58 offen sc1 lds
    s_mov_b32 m0, 70656
    s_mov_b32 s58, 152576
    buffer_load_dwordx4 v2, s[24:27], s58 offen sc1 lds
    s_mov_b32 m0, 74752
    s_mov_b32 s58, 156672
    buffer_load_dwordx4 v2, s[24:27], s58 offen sc1 lds
    s_mov_b32 m0, 78848
    s_mov_b32 s58, 160768
    buffer_load_dwordx4 v2, s[24:27], s58 offen sc1 lds
    s_branch L_kvd_90
L_kvn_91:
    s_cmp_eq_u32 s38, 6
    s_cbranch_scc0 L_kvn_92
    s_mov_b32 m0, 2048
    s_mov_b32 s58, 83968
    buffer_load_dwordx4 v2, s[24:27], s58 offen sc1 lds
    s_mov_b32 m0, 6144
    s_mov_b32 s58, 88064
    buffer_load_dwordx4 v2, s[24:27], s58 offen sc1 lds
    s_mov_b32 m0, 10240
    s_mov_b32 s58, 92160
    buffer_load_dwordx4 v2, s[24:27], s58 offen sc1 lds
    s_mov_b32 m0, 14336
    s_mov_b32 s58, 96256
    buffer_load_dwordx4 v2, s[24:27], s58 offen sc1 lds
    s_mov_b32 m0, 18432
    s_mov_b32 s58, 100352
    buffer_load_dwordx4 v2, s[24:27], s58 offen sc1 lds
    s_mov_b32 m0, 22528
    s_mov_b32 s58, 104448
    buffer_load_dwordx4 v2, s[24:27], s58 offen sc1 lds
    s_mov_b32 m0, 26624
    s_mov_b32 s58, 108544
    buffer_load_dwordx4 v2, s[24:27], s58 offen sc1 lds
    s_mov_b32 m0, 30720
    s_mov_b32 s58, 112640
    buffer_load_dwordx4 v2, s[24:27], s58 offen sc1 lds
    s_mov_b32 m0, 34816
    s_mov_b32 s58, 116736
    buffer_load_dwordx4 v2, s[24:27], s58 offen sc1 lds
    s_mov_b32 m0, 38912
    s_mov_b32 s58, 120832
    buffer_load_dwordx4 v2, s[24:27], s58 offen sc1 lds
    s_mov_b32 m0, 43008
    s_mov_b32 s58, 124928
    buffer_load_dwordx4 v2, s[24:27], s58 offen sc1 lds
    s_mov_b32 m0, 47104
    s_mov_b32 s58, 129024
    buffer_load_dwordx4 v2, s[24:27], s58 offen sc1 lds
    s_mov_b32 m0, 51200
    s_mov_b32 s58, 133120
    buffer_load_dwordx4 v2, s[24:27], s58 offen sc1 lds
    s_mov_b32 m0, 55296
    s_mov_b32 s58, 137216
    buffer_load_dwordx4 v2, s[24:27], s58 offen sc1 lds
    s_mov_b32 m0, 59392
    s_mov_b32 s58, 141312
    buffer_load_dwordx4 v2, s[24:27], s58 offen sc1 lds
    s_mov_b32 m0, 63488
    s_mov_b32 s58, 145408
    buffer_load_dwordx4 v2, s[24:27], s58 offen sc1 lds
    s_mov_b32 m0, 67584
    s_mov_b32 s58, 149504
    buffer_load_dwordx4 v2, s[24:27], s58 offen sc1 lds
    s_mov_b32 m0, 71680
    s_mov_b32 s58, 153600
    buffer_load_dwordx4 v2, s[24:27], s58 offen sc1 lds
    s_mov_b32 m0, 75776
    s_mov_b32 s58, 157696
    buffer_load_dwordx4 v2, s[24:27], s58 offen sc1 lds
    s_mov_b32 m0, 79872
    s_mov_b32 s58, 161792
    buffer_load_dwordx4 v2, s[24:27], s58 offen sc1 lds
    s_branch L_kvd_90
L_kvn_92:
    s_cmp_eq_u32 s38, 7
    s_cbranch_scc0 L_kvn_93
    s_mov_b32 m0, 3072
    s_mov_b32 s58, 84992
    buffer_load_dwordx4 v2, s[24:27], s58 offen sc1 lds
    s_mov_b32 m0, 7168
    s_mov_b32 s58, 89088
    buffer_load_dwordx4 v2, s[24:27], s58 offen sc1 lds
    s_mov_b32 m0, 11264
    s_mov_b32 s58, 93184
    buffer_load_dwordx4 v2, s[24:27], s58 offen sc1 lds
    s_mov_b32 m0, 15360
    s_mov_b32 s58, 97280
    buffer_load_dwordx4 v2, s[24:27], s58 offen sc1 lds
    s_mov_b32 m0, 19456
    s_mov_b32 s58, 101376
    buffer_load_dwordx4 v2, s[24:27], s58 offen sc1 lds
    s_mov_b32 m0, 23552
    s_mov_b32 s58, 105472
    buffer_load_dwordx4 v2, s[24:27], s58 offen sc1 lds
    s_mov_b32 m0, 27648
    s_mov_b32 s58, 109568
    buffer_load_dwordx4 v2, s[24:27], s58 offen sc1 lds
    s_mov_b32 m0, 31744
    s_mov_b32 s58, 113664
    buffer_load_dwordx4 v2, s[24:27], s58 offen sc1 lds
    s_mov_b32 m0, 35840
    s_mov_b32 s58, 117760
    buffer_load_dwordx4 v2, s[24:27], s58 offen sc1 lds
    s_mov_b32 m0, 39936
    s_mov_b32 s58, 121856
    buffer_load_dwordx4 v2, s[24:27], s58 offen sc1 lds
    s_mov_b32 m0, 44032
    s_mov_b32 s58, 125952
    buffer_load_dwordx4 v2, s[24:27], s58 offen sc1 lds
    s_mov_b32 m0, 48128
    s_mov_b32 s58, 130048
    buffer_load_dwordx4 v2, s[24:27], s58 offen sc1 lds
    s_mov_b32 m0, 52224
    s_mov_b32 s58, 134144
    buffer_load_dwordx4 v2, s[24:27], s58 offen sc1 lds
    s_mov_b32 m0, 56320
    s_mov_b32 s58, 138240
    buffer_load_dwordx4 v2, s[24:27], s58 offen sc1 lds
    s_mov_b32 m0, 60416
    s_mov_b32 s58, 142336
    buffer_load_dwordx4 v2, s[24:27], s58 offen sc1 lds
    s_mov_b32 m0, 64512
    s_mov_b32 s58, 146432
    buffer_load_dwordx4 v2, s[24:27], s58 offen sc1 lds
    s_mov_b32 m0, 68608
    s_mov_b32 s58, 150528
    buffer_load_dwordx4 v2, s[24:27], s58 offen sc1 lds
    s_mov_b32 m0, 72704
    s_mov_b32 s58, 154624
    buffer_load_dwordx4 v2, s[24:27], s58 offen sc1 lds
    s_mov_b32 m0, 76800
    s_mov_b32 s58, 158720
    buffer_load_dwordx4 v2, s[24:27], s58 offen sc1 lds
    s_mov_b32 m0, 80896
    s_mov_b32 s58, 162816
    buffer_load_dwordx4 v2, s[24:27], s58 offen sc1 lds
    s_branch L_kvd_90
L_kvn_93:
L_kvd_90:
    s_barrier
    s_waitcnt vmcnt(0)
    s_barrier
    s_setprio 0
    s_mov_b32 s59, 0
L_poll_94:
    s_or_b32 s40, s37, 4
    s_lshl_b32 s40, s40, 8
    s_add_u32 s40, s40, 11878400
    s_lshl_b32 s39, s36, 8
    s_add_u32 s39, s39, 11866112
    v_lshlrev_b32 v252, 2, v1
    v_add_u32 v252, s40, v252
    v_and_b32 v255, 7, v1
    v_lshlrev_b32 v255, 2, v255
    v_add_u32 v255, s39, v255
    v_cmp_gt_u32 vcc, 32, v1
    s_nop 1
    v_cndmask_b32 v252, v255, v252, vcc
    buffer_load_dword v253, v252, s[24:27], 0 offen sc1
    s_waitcnt vmcnt(0)
    v_xor_b32 v253, s76, v253
    v_cmp_ne_u32 vcc, 0, v253
    s_add_u32 s59, s59, 1
    s_nop 3
    s_cmp_eq_u64 vcc, 0
    s_cbranch_scc1 L_pollok_95
    s_cmp_gt_u32 s59, 20000
    s_cbranch_scc1 L_pollok_95
    s_sleep 4
    s_branch L_poll_94
L_pollok_95:
    s_sub_u32 s42, s38, 4
    s_mul_i32 s54, s37, 68
    s_add_u32 s54, s54, s42
    s_add_u32 s54, s54, 20
    s_mul_i32 s54, s54, 5120
    s_add_u32 s54, s54, 6455296
    s_lshl_b32 s39, s36, 2
    s_add_u32 s39, s39, 0
    s_mul_i32 s39, s39, 48
    s_add_u32 s39, s39, s42
    s_lshl_b32 s39, s39, 10
    s_add_u32 s44, s39, 163840
    s_lshl_b32 s39, s36, 2
    s_add_u32 s39, s39, 1
    s_mul_i32 s39, s39, 48
    s_add_u32 s39, s39, s42
    s_lshl_b32 s39, s39, 10
    s_add_u32 s45, s39, 163840
    s_lshl_b32 s39, s36, 2
    s_add_u32 s39, s39, 2
    s_mul_i32 s39, s39, 48
    s_add_u32 s39, s39, s42
    s_lshl_b32 s39, s39, 10
    s_add_u32 s46, s39, 163840
    s_lshl_b32 s39, s36, 2
    s_add_u32 s39, s39, 3
    s_mul_i32 s39, s39, 48
    s_add_u32 s39, s39, s42
    s_lshl_b32 s39, s39, 10
    s_add_u32 s47, s39, 163840
    s_add_u32 s55, s54, 4096
    buffer_load_dwordx4 v[88:91], v2, s[24:27], s54 offen offset:0 sc1
    buffer_load_dwordx4 v[92:95], v2, s[24:27], s54 offen offset:1024 sc1
    buffer_load_dwordx4 v[96:99], v2, s[24:27], s54 offen offset:2048 sc1
    buffer_load_dwordx4 v[100:103], v2, s[24:27], s54 offen offset:3072 sc1
    buffer_load_dwordx4 v[104:107], v2, s[24:27], s55 offen sc1
    buffer_load_dwordx4 v[108:111], v2, s[24:27], s44 offen sc1
    buffer_load_dwordx4 v[112:115], v2, s[24:27], s45 offen sc1
    buffer_load_dwordx4 v[116:119], v2, s[24:27], s46 offen sc1
    buffer_load_dwordx4 v[120:123], v2, s[24:27], s47 offen sc1
    s_add_u32 s54, s54, 20480
    s_add_u32 s44, s44, 4096
    s_add_u32 s45, s45, 4096
    s_add_u32 s46, s46, 4096
    s_add_u32 s47, s47, 4096
    s_add_u32 s55, s54, 4096
    buffer_load_dwordx4 v[124:127], v2, s[24:27], s54 offen offset:0 sc1
    buffer_load_dwordx4 v[128:131], v2, s[24:27], s54 offen offset:1024 sc1
    buffer_load_dwordx4 v[132:135], v2, s[24:27], s54 offen offset:2048 sc1
    buffer_load_dwordx4 v[136:139], v2, s[24:27], s54 offen offset:3072 sc1
    buffer_load_dwordx4 v[140:143], v2, s[24:27], s55 offen sc1
    buffer_load_dwordx4 v[144:147], v2, s[24:27], s44 offen sc1
    buffer_load_dwordx4 v[148:151], v2, s[24:27], s45 offen sc1
    buffer_load_dwordx4 v[152:155], v2, s[24:27], s46 offen sc1
    buffer_load_dwordx4 v[156:159], v2, s[24:27], s47 offen sc1
    s_add_u32 s54, s54, 20480
    s_add_u32 s44, s44, 4096
    s_add_u32 s45, s45, 4096
    s_add_u32 s46, s46, 4096
    s_add_u32 s47, s47, 4096
    s_add_u32 s55, s54, 4096
    buffer_load_dwordx4 v[160:163], v2, s[24:27], s54 offen offset:0 sc1
    buffer_load_dwordx4 v[164:167], v2, s[24:27], s54 offen offset:1024 sc1
    buffer_load_dwordx4 v[168:171], v2, s[24:27], s54 offen offset:2048 sc1
    buffer_load_dwordx4 v[172:175], v2, s[24:27], s54 offen offset:3072 sc1
    buffer_load_dwordx4 v[176:179], v2, s[24:27], s55 offen sc1
    buffer_load_dwordx4 v[180:183], v2, s[24:27], s44 offen sc1
    buffer_load_dwordx4 v[184:187], v2, s[24:27], s45 offen sc1
    buffer_load_dwordx4 v[188:191], v2, s[24:27], s46 offen sc1
    buffer_load_dwordx4 v[192:195], v2, s[24:27], s47 offen sc1
    s_add_u32 s54, s54, 20480
    s_add_u32 s44, s44, 4096
    s_add_u32 s45, s45, 4096
    s_add_u32 s46, s46, 4096
    s_add_u32 s47, s47, 4096
    v_mov_b32 v8, 0
    v_mov_b32 v9, 0
    v_mov_b32 v10, 0
    v_mov_b32 v11, 0
    v_mov_b32 v12, 0
    v_mov_b32 v13, 0
    v_mov_b32 v14, 0
    v_mov_b32 v15, 0
    v_mov_b32 v16, 0
    v_mov_b32 v17, 0
    v_mov_b32 v18, 0
    v_mov_b32 v19, 0
    v_mov_b32 v20, 0
    v_mov_b32 v21, 0
    v_mov_b32 v22, 0
    v_mov_b32 v23, 0
    v_mov_b32 v24, 0
    v_mov_b32 v25, 0
    v_mov_b32 v26, 0
    v_mov_b32 v27, 0
    v_mov_b32 v28, 0
    v_mov_b32 v29, 0
    v_mov_b32 v30, 0
    v_mov_b32 v31, 0
    v_mov_b32 v32, 0
    v_mov_b32 v33, 0
    v_mov_b32 v34, 0
    v_mov_b32 v35, 0
    v_mov_b32 v36, 0
    v_mov_b32 v37, 0
    v_mov_b32 v38, 0
    v_mov_b32 v39, 0
    v_mov_b32 v40, 0
    v_mov_b32 v41, 0
    v_mov_b32 v42, 0
    v_mov_b32 v43, 0
    v_mov_b32 v44, 0
    v_mov_b32 v45, 0
    v_mov_b32 v46, 0
    v_mov_b32 v47, 0
    v_mov_b32 v48, 0
    v_mov_b32 v49, 0
    v_mov_b32 v50, 0
    v_mov_b32 v51, 0
    v_mov_b32 v52, 0
    v_mov_b32 v53, 0
    v_mov_b32 v54, 0
    v_mov_b32 v55, 0
    v_mov_b32 v56, 0
    v_mov_b32 v57, 0
    v_mov_b32 v58, 0
    v_mov_b32 v59, 0
    v_mov_b32 v60, 0
    v_mov_b32 v61, 0
    v_mov_b32 v62, 0
    v_mov_b32 v63, 0
    v_mov_b32 v64, 0
    v_mov_b32 v65, 0
    v_mov_b32 v66, 0
    v_mov_b32 v67, 0
    v_mov_b32 v68, 0
    v_mov_b32 v69, 0
    v_mov_b32 v70, 0
    v_mov_b32 v71, 0
    v_mov_b32 v72, 0
    v_mov_b32 v73, 0
    v_mov_b32 v74, 0
    v_mov_b32 v75, 0
    v_mov_b32 v76, 0
    v_mov_b32 v77, 0
    v_mov_b32 v78, 0
    v_mov_b32 v79, 0
    v_mov_b32 v80, 0
    v_mov_b32 v81, 0
    v_mov_b32 v82, 0
    v_mov_b32 v83, 0
    v_mov_b32 v84, 0
    v_mov_b32 v85, 0
    v_mov_b32 v86, 0
    v_mov_b32 v87, 0
    s_add_u32 s55, s54, 4096
    buffer_load_dwordx4 v[196:199], v2, s[24:27], s54 offen offset:0 sc1
    buffer_load_dwordx4 v[200:203], v2, s[24:27], s54 offen offset:1024 sc1
    buffer_load_dwordx4 v[204:207], v2, s[24:27], s54 offen offset:2048 sc1
    buffer_load_dwordx4 v[208:211], v2, s[24:27], s54 offen offset:3072 sc1
    buffer_load_dwordx4 v[212:215], v2, s[24:27], s55 offen sc1
    buffer_load_dwordx4 v[216:219], v2, s[24:27], s44 offen sc1
    buffer_load_dwordx4 v[220:223], v2, s[24:27], s45 offen sc1
    buffer_load_dwordx4 v[224:227], v2, s[24:27], s46 offen sc1
    buffer_load_dwordx4 v[228:231], v2, s[24:27], s47 offen sc1
    s_add_u32 s54, s54, 20480
    s_add_u32 s44, s44, 4096
    s_add_u32 s45, s45, 4096
    s_add_u32 s46, s46, 4096
    s_add_u32 s47, s47, 4096
    s_waitcnt vmcnt(27)
    v_mfma_f32_16x16x32_bf16 v[8:11], v[88:91], v[108:111], v[8:11]
    v_mfma_f32_16x16x32_bf16 v[12:15], v[92:95], v[108:111], v[12:15]
    v_mfma_f32_16x16x32_bf16 v[16:19], v[96:99], v[108:111], v[16:19]
    v_mfma_f32_16x16x32_bf16 v[20:23], v[100:103], v[108:111], v[20:23]
    v_mfma_f32_16x16x32_bf16 v[24:27], v[104:107], v[108:111], v[24:27]
    v_mfma_f32_16x16x32_bf16 v[28:31], v[88:91], v[112:115], v[28:31]
    v_mfma_f32_16x16x32_bf16 v[32:35], v[92:95], v[112:115], v[32:35]
    v_mfma_f32_16x16x32_bf16 v[36:39], v[96:99], v[112:115], v[36:39]
    v_mfma_f32_16x16x32_bf16 v[40:43], v[100:103], v[112:115], v[40:43]
    v_mfma_f32_16x16x32_bf16 v[44:47], v[104:107], v[112:115], v[44:47]
    v_mfma_f32_16x16x32_bf16 v[48:51], v[88:91], v[116:119], v[48:51]
    v_mfma_f32_16x16x32_bf16 v[52:55], v[92:95], v[116:119], v[52:55]
    v_mfma_f32_16x16x32_bf16 v[56:59], v[96:99], v[116:119], v[56:59]
    v_mfma_f32_16x16x32_bf16 v[60:63], v[100:103], v[116:119], v[60:63]
    v_mfma_f32_16x16x32_bf16 v[64:67], v[104:107], v[116:119], v[64:67]
    v_mfma_f32_16x16x32_bf16 v[68:71], v[88:91], v[120:123], v[68:71]
    v_mfma_f32_16x16x32_bf16 v[72:75], v[92:95], v[120:123], v[72:75]
    v_mfma_f32_16x16x32_bf16 v[76:79], v[96:99], v[120:123], v[76:79]
    v_mfma_f32_16x16x32_bf16 v[80:83], v[100:103], v[120:123], v[80:83]
    v_mfma_f32_16x16x32_bf16 v[84:87], v[104:107], v[120:123], v[84:87]
    s_add_u32 s55, s54, 4096
    buffer_load_dwordx4 v[88:91], v2, s[24:27], s54 offen offset:0 sc1
    buffer_load_dwordx4 v[92:95], v2, s[24:27], s54 offen offset:1024 sc1
    buffer_load_dwordx4 v[96:99], v2, s[24:27], s54 offen offset:2048 sc1
    buffer_load_dwordx4 v[100:103], v2, s[24:27], s54 offen offset:3072 sc1
    buffer_load_dwordx4 v[104:107], v2, s[24:27], s55 offen sc1
    buffer_load_dwordx4 v[108:111], v2, s[24:27], s44 offen sc1
    buffer_load_dwordx4 v[112:115], v2, s[24:27], s45 offen sc1
    buffer_load_dwordx4 v[116:119], v2, s[24:27], s46 offen sc1
    buffer_load_dwordx4 v[120:123], v2, s[24:27], s47 offen sc1
    s_add_u32 s54, s54, 20480
    s_add_u32 s44, s44, 4096
    s_add_u32 s45, s45, 4096
    s_add_u32 s46, s46, 4096
    s_add_u32 s47, s47, 4096
    s_waitcnt vmcnt(27)
    v_mfma_f32_16x16x32_bf16 v[8:11], v[124:127], v[144:147], v[8:11]
    v_mfma_f32_16x16x32_bf16 v[12:15], v[128:131], v[144:147], v[12:15]
    v_mfma_f32_16x16x32_bf16 v[16:19], v[132:135], v[144:147], v[16:19]
    v_mfma_f32_16x16x32_bf16 v[20:23], v[136:139], v[144:147], v[20:23]
    v_mfma_f32_16x16x32_bf16 v[24:27], v[140:143], v[144:147], v[24:27]
    v_mfma_f32_16x16x32_bf16 v[28:31], v[124:127], v[148:151], v[28:31]
    v_mfma_f32_16x16x32_bf16 v[32:35], v[128:131], v[148:151], v[32:35]
    v_mfma_f32_16x16x32_bf16 v[36:39], v[132:135], v[148:151], v[36:39]
    v_mfma_f32_16x16x32_bf16 v[40:43], v[136:139], v[148:151], v[40:43]
    v_mfma_f32_16x16x32_bf16 v[44:47], v[140:143], v[148:151], v[44:47]
    v_mfma_f32_16x16x32_bf16 v[48:51], v[124:127], v[152:155], v[48:51]
    v_mfma_f32_16x16x32_bf16 v[52:55], v[128:131], v[152:155], v[52:55]
    v_mfma_f32_16x16x32_bf16 v[56:59], v[132:135], v[152:155], v[56:59]
    v_mfma_f32_16x16x32_bf16 v[60:63], v[136:139], v[152:155], v[60:63]
    v_mfma_f32_16x16x32_bf16 v[64:67], v[140:143], v[152:155], v[64:67]
    v_mfma_f32_16x16x32_bf16 v[68:71], v[124:127], v[156:159], v[68:71]
    v_mfma_f32_16x16x32_bf16 v[72:75], v[128:131], v[156:159], v[72:75]
    v_mfma_f32_16x16x32_bf16 v[76:79], v[132:135], v[156:159], v[76:79]
    v_mfma_f32_16x16x32_bf16 v[80:83], v[136:139], v[156:159], v[80:83]
    v_mfma_f32_16x16x32_bf16 v[84:87], v[140:143], v[156:159], v[84:87]
    s_add_u32 s55, s54, 4096
    buffer_load_dwordx4 v[124:127], v2, s[24:27], s54 offen offset:0 sc1
    buffer_load_dwordx4 v[128:131], v2, s[24:27], s54 offen offset:1024 sc1
    buffer_load_dwordx4 v[132:135], v2, s[24:27], s54 offen offset:2048 sc1
    buffer_load_dwordx4 v[136:139], v2, s[24:27], s54 offen offset:3072 sc1
    buffer_load_dwordx4 v[140:143], v2, s[24:27], s55 offen sc1
    buffer_load_dwordx4 v[144:147], v2, s[24:27], s44 offen sc1
    buffer_load_dwordx4 v[148:151], v2, s[24:27], s45 offen sc1
    buffer_load_dwordx4 v[152:155], v2, s[24:27], s46 offen sc1
    buffer_load_dwordx4 v[156:159], v2, s[24:27], s47 offen sc1
    s_add_u32 s54, s54, 20480
    s_add_u32 s44, s44, 4096
    s_add_u32 s45, s45, 4096
    s_add_u32 s46, s46, 4096
    s_add_u32 s47, s47, 4096
    s_waitcnt vmcnt(27)
    v_mfma_f32_16x16x32_bf16 v[8:11], v[160:163], v[180:183], v[8:11]
    v_mfma_f32_16x16x32_bf16 v[12:15], v[164:167], v[180:183], v[12:15]
    v_mfma_f32_16x16x32_bf16 v[16:19], v[168:171], v[180:183], v[16:19]
    v_mfma_f32_16x16x32_bf16 v[20:23], v[172:175], v[180:183], v[20:23]
    v_mfma_f32_16x16x32_bf16 v[24:27], v[176:179], v[180:183], v[24:27]
    v_mfma_f32_16x16x32_bf16 v[28:31], v[160:163], v[184:187], v[28:31]
    v_mfma_f32_16x16x32_bf16 v[32:35], v[164:167], v[184:187], v[32:35]
    v_mfma_f32_16x16x32_bf16 v[36:39], v[168:171], v[184:187], v[36:39]
    v_mfma_f32_16x16x32_bf16 v[40:43], v[172:175], v[184:187], v[40:43]
    v_mfma_f32_16x16x32_bf16 v[44:47], v[176:179], v[184:187], v[44:47]
    v_mfma_f32_16x16x32_bf16 v[48:51], v[160:163], v[188:191], v[48:51]
    v_mfma_f32_16x16x32_bf16 v[52:55], v[164:167], v[188:191], v[52:55]
    v_mfma_f32_16x16x32_bf16 v[56:59], v[168:171], v[188:191], v[56:59]
    v_mfma_f32_16x16x32_bf16 v[60:63], v[172:175], v[188:191], v[60:63]
    v_mfma_f32_16x16x32_bf16 v[64:67], v[176:179], v[188:191], v[64:67]
    v_mfma_f32_16x16x32_bf16 v[68:71], v[160:163], v[192:195], v[68:71]
    v_mfma_f32_16x16x32_bf16 v[72:75], v[164:167], v[192:195], v[72:75]
    v_mfma_f32_16x16x32_bf16 v[76:79], v[168:171], v[192:195], v[76:79]
    v_mfma_f32_16x16x32_bf16 v[80:83], v[172:175], v[192:195], v[80:83]
    v_mfma_f32_16x16x32_bf16 v[84:87], v[176:179], v[192:195], v[84:87]
    s_add_u32 s55, s54, 4096
    buffer_load_dwordx4 v[160:163], v2, s[24:27], s54 offen offset:0 sc1
    buffer_load_dwordx4 v[164:167], v2, s[24:27], s54 offen offset:1024 sc1
    buffer_load_dwordx4 v[168:171], v2, s[24:27], s54 offen offset:2048 sc1
    buffer_load_dwordx4 v[172:175], v2, s[24:27], s54 offen offset:3072 sc1
    buffer_load_dwordx4 v[176:179], v2, s[24:27], s55 offen sc1
    buffer_load_dwordx4 v[180:183], v2, s[24:27], s44 offen sc1
    buffer_load_dwordx4 v[184:187], v2, s[24:27], s45 offen sc1
    buffer_load_dwordx4 v[188:191], v2, s[24:27], s46 offen sc1
    buffer_load_dwordx4 v[192:195], v2, s[24:27], s47 offen sc1
    s_add_u32 s54, s54, 20480
    s_add_u32 s44, s44, 4096
    s_add_u32 s45, s45, 4096
    s_add_u32 s46, s46, 4096
    s_add_u32 s47, s47, 4096
    s_waitcnt vmcnt(27)
    v_mfma_f32_16x16x32_bf16 v[8:11], v[196:199], v[216:219], v[8:11]
    v_mfma_f32_16x16x32_bf16 v[12:15], v[200:203], v[216:219], v[12:15]
    v_mfma_f32_16x16x32_bf16 v[16:19], v[204:207], v[216:219], v[16:19]
    v_mfma_f32_16x16x32_bf16 v[20:23], v[208:211], v[216:219], v[20:23]
    v_mfma_f32_16x16x32_bf16 v[24:27], v[212:215], v[216:219], v[24:27]
    v_mfma_f32_16x16x32_bf16 v[28:31], v[196:199], v[220:223], v[28:31]
    v_mfma_f32_16x16x32_bf16 v[32:35], v[200:203], v[220:223], v[32:35]
    v_mfma_f32_16x16x32_bf16 v[36:39], v[204:207], v[220:223], v[36:39]
    v_mfma_f32_16x16x32_bf16 v[40:43], v[208:211], v[220:223], v[40:43]
    v_mfma_f32_16x16x32_bf16 v[44:47], v[212:215], v[220:223], v[44:47]
    v_mfma_f32_16x16x32_bf16 v[48:51], v[196:199], v[224:227], v[48:51]
    v_mfma_f32_16x16x32_bf16 v[52:55], v[200:203], v[224:227], v[52:55]
    v_mfma_f32_16x16x32_bf16 v[56:59], v[204:207], v[224:227], v[56:59]
    v_mfma_f32_16x16x32_bf16 v[60:63], v[208:211], v[224:227], v[60:63]
    v_mfma_f32_16x16x32_bf16 v[64:67], v[212:215], v[224:227], v[64:67]
    v_mfma_f32_16x16x32_bf16 v[68:71], v[196:199], v[228:231], v[68:71]
    v_mfma_f32_16x16x32_bf16 v[72:75], v[200:203], v[228:231], v[72:75]
    v_mfma_f32_16x16x32_bf16 v[76:79], v[204:207], v[228:231], v[76:79]
    v_mfma_f32_16x16x32_bf16 v[80:83], v[208:211], v[228:231], v[80:83]
    v_mfma_f32_16x16x32_bf16 v[84:87], v[212:215], v[228:231], v[84:87]
    s_add_u32 s55, s54, 4096
    buffer_load_dwordx4 v[196:199], v2, s[24:27], s54 offen offset:0 sc1
    buffer_load_dwordx4 v[200:203], v2, s[24:27], s54 offen offset:1024 sc1
    buffer_load_dwordx4 v[204:207], v2, s[24:27], s54 offen offset:2048 sc1
    buffer_load_dwordx4 v[208:211], v2, s[24:27], s54 offen offset:3072 sc1
    buffer_load_dwordx4 v[212:215], v2, s[24:27], s55 offen sc1
    buffer_load_dwordx4 v[216:219], v2, s[24:27], s44 offen sc1
    buffer_load_dwordx4 v[220:223], v2, s[24:27], s45 offen sc1
    buffer_load_dwordx4 v[224:227], v2, s[24:27], s46 offen sc1
    buffer_load_dwordx4 v[228:231], v2, s[24:27], s47 offen sc1
    s_add_u32 s54, s54, 20480
    s_add_u32 s44, s44, 4096
    s_add_u32 s45, s45, 4096
    s_add_u32 s46, s46, 4096
    s_add_u32 s47, s47, 4096
    s_waitcnt vmcnt(27)
    v_mfma_f32_16x16x32_bf16 v[8:11], v[88:91], v[108:111], v[8:11]
    v_mfma_f32_16x16x32_bf16 v[12:15], v[92:95], v[108:111], v[12:15]
    v_mfma_f32_16x16x32_bf16 v[16:19], v[96:99], v[108:111], v[16:19]
    v_mfma_f32_16x16x32_bf16 v[20:23], v[100:103], v[108:111], v[20:23]
    v_mfma_f32_16x16x32_bf16 v[24:27], v[104:107], v[108:111], v[24:27]
    v_mfma_f32_16x16x32_bf16 v[28:31], v[88:91], v[112:115], v[28:31]
    v_mfma_f32_16x16x32_bf16 v[32:35], v[92:95], v[112:115], v[32:35]
    v_mfma_f32_16x16x32_bf16 v[36:39], v[96:99], v[112:115], v[36:39]
    v_mfma_f32_16x16x32_bf16 v[40:43], v[100:103], v[112:115], v[40:43]
    v_mfma_f32_16x16x32_bf16 v[44:47], v[104:107], v[112:115], v[44:47]
    v_mfma_f32_16x16x32_bf16 v[48:51], v[88:91], v[116:119], v[48:51]
    v_mfma_f32_16x16x32_bf16 v[52:55], v[92:95], v[116:119], v[52:55]
    v_mfma_f32_16x16x32_bf16 v[56:59], v[96:99], v[116:119], v[56:59]
    v_mfma_f32_16x16x32_bf16 v[60:63], v[100:103], v[116:119], v[60:63]
    v_mfma_f32_16x16x32_bf16 v[64:67], v[104:107], v[116:119], v[64:67]
    v_mfma_f32_16x16x32_bf16 v[68:71], v[88:91], v[120:123], v[68:71]
    v_mfma_f32_16x16x32_bf16 v[72:75], v[92:95], v[120:123], v[72:75]
    v_mfma_f32_16x16x32_bf16 v[76:79], v[96:99], v[120:123], v[76:79]
    v_mfma_f32_16x16x32_bf16 v[80:83], v[100:103], v[120:123], v[80:83]
    v_mfma_f32_16x16x32_bf16 v[84:87], v[104:107], v[120:123], v[84:87]
    s_add_u32 s55, s54, 4096
    buffer_load_dwordx4 v[88:91], v2, s[24:27], s54 offen offset:0 sc1
    buffer_load_dwordx4 v[92:95], v2, s[24:27], s54 offen offset:1024 sc1
    buffer_load_dwordx4 v[96:99], v2, s[24:27], s54 offen offset:2048 sc1
    buffer_load_dwordx4 v[100:103], v2, s[24:27], s54 offen offset:3072 sc1
    buffer_load_dwordx4 v[104:107], v2, s[24:27], s55 offen sc1
    buffer_load_dwordx4 v[108:111], v2, s[24:27], s44 offen sc1
    buffer_load_dwordx4 v[112:115], v2, s[24:27], s45 offen sc1
    buffer_load_dwordx4 v[116:119], v2, s[24:27], s46 offen sc1
    buffer_load_dwordx4 v[120:123], v2, s[24:27], s47 offen sc1
    s_add_u32 s54, s54, 20480
    s_add_u32 s44, s44, 4096
    s_add_u32 s45, s45, 4096
    s_add_u32 s46, s46, 4096
    s_add_u32 s47, s47, 4096
    s_waitcnt vmcnt(27)
    v_mfma_f32_16x16x32_bf16 v[8:11], v[124:127], v[144:147], v[8:11]
    v_mfma_f32_16x16x32_bf16 v[12:15], v[128:131], v[144:147], v[12:15]
    v_mfma_f32_16x16x32_bf16 v[16:19], v[132:135], v[144:147], v[16:19]
    v_mfma_f32_16x16x32_bf16 v[20:23], v[136:139], v[144:147], v[20:23]
    v_mfma_f32_16x16x32_bf16 v[24:27], v[140:143], v[144:147], v[24:27]
    v_mfma_f32_16x16x32_bf16 v[28:31], v[124:127], v[148:151], v[28:31]
    v_mfma_f32_16x16x32_bf16 v[32:35], v[128:131], v[148:151], v[32:35]
    v_mfma_f32_16x16x32_bf16 v[36:39], v[132:135], v[148:151], v[36:39]
    v_mfma_f32_16x16x32_bf16 v[40:43], v[136:139], v[148:151], v[40:43]
    v_mfma_f32_16x16x32_bf16 v[44:47], v[140:143], v[148:151], v[44:47]
    v_mfma_f32_16x16x32_bf16 v[48:51], v[124:127], v[152:155], v[48:51]
    v_mfma_f32_16x16x32_bf16 v[52:55], v[128:131], v[152:155], v[52:55]
    v_mfma_f32_16x16x32_bf16 v[56:59], v[132:135], v[152:155], v[56:59]
    v_mfma_f32_16x16x32_bf16 v[60:63], v[136:139], v[152:155], v[60:63]
    v_mfma_f32_16x16x32_bf16 v[64:67], v[140:143], v[152:155], v[64:67]
    v_mfma_f32_16x16x32_bf16 v[68:71], v[124:127], v[156:159], v[68:71]
    v_mfma_f32_16x16x32_bf16 v[72:75], v[128:131], v[156:159], v[72:75]
    v_mfma_f32_16x16x32_bf16 v[76:79], v[132:135], v[156:159], v[76:79]
    v_mfma_f32_16x16x32_bf16 v[80:83], v[136:139], v[156:159], v[80:83]
    v_mfma_f32_16x16x32_bf16 v[84:87], v[140:143], v[156:159], v[84:87]
    s_add_u32 s55, s54, 4096
    buffer_load_dwordx4 v[124:127], v2, s[24:27], s54 offen offset:0 sc1
    buffer_load_dwordx4 v[128:131], v2, s[24:27], s54 offen offset:1024 sc1
    buffer_load_dwordx4 v[132:135], v2, s[24:27], s54 offen offset:2048 sc1
    buffer_load_dwordx4 v[136:139], v2, s[24:27], s54 offen offset:3072 sc1
    buffer_load_dwordx4 v[140:143], v2, s[24:27], s55 offen sc1
    buffer_load_dwordx4 v[144:147], v2, s[24:27], s44 offen sc1
    buffer_load_dwordx4 v[148:151], v2, s[24:27], s45 offen sc1
    buffer_load_dwordx4 v[152:155], v2, s[24:27], s46 offen sc1
    buffer_load_dwordx4 v[156:159], v2, s[24:27], s47 offen sc1
    s_add_u32 s54, s54, 20480
    s_add_u32 s44, s44, 4096
    s_add_u32 s45, s45, 4096
    s_add_u32 s46, s46, 4096
    s_add_u32 s47, s47, 4096
    s_waitcnt vmcnt(27)
    v_mfma_f32_16x16x32_bf16 v[8:11], v[160:163], v[180:183], v[8:11]
    v_mfma_f32_16x16x32_bf16 v[12:15], v[164:167], v[180:183], v[12:15]
    v_mfma_f32_16x16x32_bf16 v[16:19], v[168:171], v[180:183], v[16:19]
    v_mfma_f32_16x16x32_bf16 v[20:23], v[172:175], v[180:183], v[20:23]
    v_mfma_f32_16x16x32_bf16 v[24:27], v[176:179], v[180:183], v[24:27]
    v_mfma_f32_16x16x32_bf16 v[28:31], v[160:163], v[184:187], v[28:31]
    v_mfma_f32_16x16x32_bf16 v[32:35], v[164:167], v[184:187], v[32:35]
    v_mfma_f32_16x16x32_bf16 v[36:39], v[168:171], v[184:187], v[36:39]
    v_mfma_f32_16x16x32_bf16 v[40:43], v[172:175], v[184:187], v[40:43]
    v_mfma_f32_16x16x32_bf16 v[44:47], v[176:179], v[184:187], v[44:47]
    v_mfma_f32_16x16x32_bf16 v[48:51], v[160:163], v[188:191], v[48:51]
    v_mfma_f32_16x16x32_bf16 v[52:55], v[164:167], v[188:191], v[52:55]
    v_mfma_f32_16x16x32_bf16 v[56:59], v[168:171], v[188:191], v[56:59]
    v_mfma_f32_16x16x32_bf16 v[60:63], v[172:175], v[188:191], v[60:63]
    v_mfma_f32_16x16x32_bf16 v[64:67], v[176:179], v[188:191], v[64:67]
    v_mfma_f32_16x16x32_bf16 v[68:71], v[160:163], v[192:195], v[68:71]
    v_mfma_f32_16x16x32_bf16 v[72:75], v[164:167], v[192:195], v[72:75]
    v_mfma_f32_16x16x32_bf16 v[76:79], v[168:171], v[192:195], v[76:79]
    v_mfma_f32_16x16x32_bf16 v[80:83], v[172:175], v[192:195], v[80:83]
    v_mfma_f32_16x16x32_bf16 v[84:87], v[176:179], v[192:195], v[84:87]
    s_add_u32 s55, s54, 4096
    buffer_load_dwordx4 v[160:163], v2, s[24:27], s54 offen offset:0 sc1
    buffer_load_dwordx4 v[164:167], v2, s[24:27], s54 offen offset:1024 sc1
    buffer_load_dwordx4 v[168:171], v2, s[24:27], s54 offen offset:2048 sc1
    buffer_load_dwordx4 v[172:175], v2, s[24:27], s54 offen offset:3072 sc1
    buffer_load_dwordx4 v[176:179], v2, s[24:27], s55 offen sc1
    buffer_load_dwordx4 v[180:183], v2, s[24:27], s44 offen sc1
    buffer_load_dwordx4 v[184:187], v2, s[24:27], s45 offen sc1
    buffer_load_dwordx4 v[188:191], v2, s[24:27], s46 offen sc1
    buffer_load_dwordx4 v[192:195], v2, s[24:27], s47 offen sc1
    s_add_u32 s54, s54, 20480
    s_add_u32 s44, s44, 4096
    s_add_u32 s45, s45, 4096
    s_add_u32 s46, s46, 4096
    s_add_u32 s47, s47, 4096
    s_waitcnt vmcnt(27)
    v_mfma_f32_16x16x32_bf16 v[8:11], v[196:199], v[216:219], v[8:11]
    v_mfma_f32_16x16x32_bf16 v[12:15], v[200:203], v[216:219], v[12:15]
    v_mfma_f32_16x16x32_bf16 v[16:19], v[204:207], v[216:219], v[16:19]
    v_mfma_f32_16x16x32_bf16 v[20:23], v[208:211], v[216:219], v[20:23]
    v_mfma_f32_16x16x32_bf16 v[24:27], v[212:215], v[216:219], v[24:27]
    v_mfma_f32_16x16x32_bf16 v[28:31], v[196:199], v[220:223], v[28:31]
    v_mfma_f32_16x16x32_bf16 v[32:35], v[200:203], v[220:223], v[32:35]
    v_mfma_f32_16x16x32_bf16 v[36:39], v[204:207], v[220:223], v[36:39]
    v_mfma_f32_16x16x32_bf16 v[40:43], v[208:211], v[220:223], v[40:43]
    v_mfma_f32_16x16x32_bf16 v[44:47], v[212:215], v[220:223], v[44:47]
    v_mfma_f32_16x16x32_bf16 v[48:51], v[196:199], v[224:227], v[48:51]
    v_mfma_f32_16x16x32_bf16 v[52:55], v[200:203], v[224:227], v[52:55]
    v_mfma_f32_16x16x32_bf16 v[56:59], v[204:207], v[224:227], v[56:59]
    v_mfma_f32_16x16x32_bf16 v[60:63], v[208:211], v[224:227], v[60:63]
    v_mfma_f32_16x16x32_bf16 v[64:67], v[212:215], v[224:227], v[64:67]
    v_mfma_f32_16x16x32_bf16 v[68:71], v[196:199], v[228:231], v[68:71]
    v_mfma_f32_16x16x32_bf16 v[72:75], v[200:203], v[228:231], v[72:75]
    v_mfma_f32_16x16x32_bf16 v[76:79], v[204:207], v[228:231], v[76:79]
    v_mfma_f32_16x16x32_bf16 v[80:83], v[208:211], v[228:231], v[80:83]
    v_mfma_f32_16x16x32_bf16 v[84:87], v[212:215], v[228:231], v[84:87]
    s_add_u32 s55, s54, 4096
    buffer_load_dwordx4 v[196:199], v2, s[24:27], s54 offen offset:0 sc1
    buffer_load_dwordx4 v[200:203], v2, s[24:27], s54 offen offset:1024 sc1
    buffer_load_dwordx4 v[204:207], v2, s[24:27], s54 offen offset:2048 sc1
    buffer_load_dwordx4 v[208:211], v2, s[24:27], s54 offen offset:3072 sc1
    buffer_load_dwordx4 v[212:215], v2, s[24:27], s55 offen sc1
    buffer_load_dwordx4 v[216:219], v2, s[24:27], s44 offen sc1
    buffer_load_dwordx4 v[220:223], v2, s[24:27], s45 offen sc1
    buffer_load_dwordx4 v[224:227], v2, s[24:27], s46 offen sc1
    buffer_load_dwordx4 v[228:231], v2, s[24:27], s47 offen sc1
    s_add_u32 s54, s54, 20480
    s_add_u32 s44, s44, 4096
    s_add_u32 s45, s45, 4096
    s_add_u32 s46, s46, 4096
    s_add_u32 s47, s47, 4096
    s_waitcnt vmcnt(27)
    v_mfma_f32_16x16x32_bf16 v[8:11], v[88:91], v[108:111], v[8:11]
    v_mfma_f32_16x16x32_bf16 v[12:15], v[92:95], v[108:111], v[12:15]
    v_mfma_f32_16x16x32_bf16 v[16:19], v[96:99], v[108:111], v[16:19]
    v_mfma_f32_16x16x32_bf16 v[20:23], v[100:103], v[108:111], v[20:23]
    v_mfma_f32_16x16x32_bf16 v[24:27], v[104:107], v[108:111], v[24:27]
    v_mfma_f32_16x16x32_bf16 v[28:31], v[88:91], v[112:115], v[28:31]
    v_mfma_f32_16x16x32_bf16 v[32:35], v[92:95], v[112:115], v[32:35]
    v_mfma_f32_16x16x32_bf16 v[36:39], v[96:99], v[112:115], v[36:39]
    v_mfma_f32_16x16x32_bf16 v[40:43], v[100:103], v[112:115], v[40:43]
    v_mfma_f32_16x16x32_bf16 v[44:47], v[104:107], v[112:115], v[44:47]
    v_mfma_f32_16x16x32_bf16 v[48:51], v[88:91], v[116:119], v[48:51]
    v_mfma_f32_16x16x32_bf16 v[52:55], v[92:95], v[116:119], v[52:55]
    v_mfma_f32_16x16x32_bf16 v[56:59], v[96:99], v[116:119], v[56:59]
    v_mfma_f32_16x16x32_bf16 v[60:63], v[100:103], v[116:119], v[60:63]
    v_mfma_f32_16x16x32_bf16 v[64:67], v[104:107], v[116:119], v[64:67]
    v_mfma_f32_16x16x32_bf16 v[68:71], v[88:91], v[120:123], v[68:71]
    v_mfma_f32_16x16x32_bf16 v[72:75], v[92:95], v[120:123], v[72:75]
    v_mfma_f32_16x16x32_bf16 v[76:79], v[96:99], v[120:123], v[76:79]
    v_mfma_f32_16x16x32_bf16 v[80:83], v[100:103], v[120:123], v[80:83]
    v_mfma_f32_16x16x32_bf16 v[84:87], v[104:107], v[120:123], v[84:87]
    s_mov_b32 s12, s62
    s_mov_b32 s13, s63
    s_mov_b32 s14, 1280
    s_mov_b32 s15, 0x00020000
    s_mov_b32 s16, s64
    s_mov_b32 s17, s65
    s_mov_b32 s18, 2621440
    s_mov_b32 s19, 0x00020000
    s_and_b32 s43, s38, 3
    v_and_b32 v3, 15, v1
    v_lshrrev_b32 v4, 4, v1
    v_mul_u32_u24 v5, 1280, v3
    v_lshl_add_u32 v5, v4, 3, v5
    v_lshlrev_b32 v6, 3, v4
    s_lshl_b32 s39, s36, 2
    s_add_u32 s39, s39, s43
    s_mul_i32 s39, s39, 20480
    s_mul_i32 s40, s37, 160
    s_add_u32 s52, s39, s40
    s_mov_b32 s53, s40
    buffer_load_dwordx2 v[232:233], v5, s[8:11], s52 offen offset:0
    buffer_load_dwordx2 v[234:235], v5, s[8:11], s52 offen offset:32
    buffer_load_dwordx2 v[236:237], v5, s[8:11], s52 offen offset:64
    buffer_load_dwordx2 v[238:239], v5, s[8:11], s52 offen offset:96
    buffer_load_dwordx2 v[240:241], v5, s[8:11], s52 offen offset:128
    buffer_load_dwordx2 v[242:243], v6, s[12:15], s53 offen offset:0
    buffer_load_dwordx2 v[244:245], v6, s[12:15], s53 offen offset:32
    buffer_load_dwordx2 v[246:247], v6, s[12:15], s53 offen offset:64
    buffer_load_dwordx2 v[248:249], v6, s[12:15], s53 offen offset:96
    buffer_load_dwordx2 v[6:7], v6, s[12:15], s53 offen offset:128
    s_barrier
    s_waitcnt vmcnt(28)
    v_mfma_f32_16x16x32_bf16 v[8:11], v[124:127], v[144:147], v[8:11]
    v_mfma_f32_16x16x32_bf16 v[12:15], v[128:131], v[144:147], v[12:15]
    v_mfma_f32_16x16x32_bf16 v[16:19], v[132:135], v[144:147], v[16:19]
    v_mfma_f32_16x16x32_bf16 v[20:23], v[136:139], v[144:147], v[20:23]
    v_mfma_f32_16x16x32_bf16 v[24:27], v[140:143], v[144:147], v[24:27]
    v_mfma_f32_16x16x32_bf16 v[28:31], v[124:127], v[148:151], v[28:31]
    v_mfma_f32_16x16x32_bf16 v[32:35], v[128:131], v[148:151], v[32:35]
    v_mfma_f32_16x16x32_bf16 v[36:39], v[132:135], v[148:151], v[36:39]
    v_mfma_f32_16x16x32_bf16 v[40:43], v[136:139], v[148:151], v[40:43]
    v_mfma_f32_16x16x32_bf16 v[44:47], v[140:143], v[148:151], v[44:47]
    v_mfma_f32_16x16x32_bf16 v[48:51], v[124:127], v[152:155], v[48:51]
    v_mfma_f32_16x16x32_bf16 v[52:55], v[128:131], v[152:155], v[52:55]
    v_mfma_f32_16x16x32_bf16 v[56:59], v[132:135], v[152:155], v[56:59]
    v_mfma_f32_16x16x32_bf16 v[60:63], v[136:139], v[152:155], v[60:63]
    v_mfma_f32_16x16x32_bf16 v[64:67], v[140:143], v[152:155], v[64:67]
    v_mfma_f32_16x16x32_bf16 v[68:71], v[124:127], v[156:159], v[68:71]
    v_mfma_f32_16x16x32_bf16 v[72:75], v[128:131], v[156:159], v[72:75]
    v_mfma_f32_16x16x32_bf16 v[76:79], v[132:135], v[156:159], v[76:79]
    v_mfma_f32_16x16x32_bf16 v[80:83], v[136:139], v[156:159], v[80:83]
    v_mfma_f32_16x16x32_bf16 v[84:87], v[140:143], v[156:159], v[84:87]
    s_waitcnt vmcnt(19)
    v_mfma_f32_16x16x32_bf16 v[8:11], v[160:163], v[180:183], v[8:11]
    v_mfma_f32_16x16x32_bf16 v[12:15], v[164:167], v[180:183], v[12:15]
    v_mfma_f32_16x16x32_bf16 v[16:19], v[168:171], v[180:183], v[16:19]
    v_mfma_f32_16x16x32_bf16 v[20:23], v[172:175], v[180:183], v[20:23]
    v_mfma_f32_16x16x32_bf16 v[24:27], v[176:179], v[180:183], v[24:27]
    v_mfma_f32_16x16x32_bf16 v[28:31], v[160:163], v[184:187], v[28:31]
    v_mfma_f32_16x16x32_bf16 v[32:35], v[164:167], v[184:187], v[32:35]
    v_mfma_f32_16x16x32_bf16 v[36:39], v[168:171], v[184:187], v[36:39]
    v_mfma_f32_16x16x32_bf16 v[40:43], v[172:175], v[184:187], v[40:43]
    v_mfma_f32_16x16x32_bf16 v[44:47], v[176:179], v[184:187], v[44:47]
    v_mfma_f32_16x16x32_bf16 v[48:51], v[160:163], v[188:191], v[48:51]
    v_mfma_f32_16x16x32_bf16 v[52:55], v[164:167], v[188:191], v[52:55]
    v_mfma_f32_16x16x32_bf16 v[56:59], v[168:171], v[188:191], v[56:59]
    v_mfma_f32_16x16x32_bf16 v[60:63], v[172:175], v[188:191], v[60:63]
    v_mfma_f32_16x16x32_bf16 v[64:67], v[176:179], v[188:191], v[64:67]
    v_mfma_f32_16x16x32_bf16 v[68:71], v[160:163], v[192:195], v[68:71]
    v_mfma_f32_16x16x32_bf16 v[72:75], v[164:167], v[192:195], v[72:75]
    v_mfma_f32_16x16x32_bf16 v[76:79], v[168:171], v[192:195], v[76:79]
    v_mfma_f32_16x16x32_bf16 v[80:83], v[172:175], v[192:195], v[80:83]
    v_mfma_f32_16x16x32_bf16 v[84:87], v[176:179], v[192:195], v[84:87]
    s_waitcnt vmcnt(10)
    v_mfma_f32_16x16x32_bf16 v[8:11], v[196:199], v[216:219], v[8:11]
    v_mfma_f32_16x16x32_bf16 v[12:15], v[200:203], v[216:219], v[12:15]
    v_mfma_f32_16x16x32_bf16 v[16:19], v[204:207], v[216:219], v[16:19]
    v_mfma_f32_16x16x32_bf16 v[20:23], v[208:211], v[216:219], v[20:23]
    v_mfma_f32_16x16x32_bf16 v[24:27], v[212:215], v[216:219], v[24:27]
    v_mfma_f32_16x16x32_bf16 v[28:31], v[196:199], v[220:223], v[28:31]
    v_mfma_f32_16x16x32_bf16 v[32:35], v[200:203], v[220:223], v[32:35]
    v_mfma_f32_16x16x32_bf16 v[36:39], v[204:207], v[220:223], v[36:39]
    v_mfma_f32_16x16x32_bf16 v[40:43], v[208:211], v[220:223], v[40:43]
    v_mfma_f32_16x16x32_bf16 v[44:47], v[212:215], v[220:223], v[44:47]
    v_mfma_f32_16x16x32_bf16 v[48:51], v[196:199], v[224:227], v[48:51]
    v_mfma_f32_16x16x32_bf16 v[52:55], v[200:203], v[224:227], v[52:55]
    v_mfma_f32_16x16x32_bf16 v[56:59], v[204:207], v[224:227], v[56:59]
    v_mfma_f32_16x16x32_bf16 v[60:63], v[208:211], v[224:227], v[60:63]
    v_mfma_f32_16x16x32_bf16 v[64:67], v[212:215], v[224:227], v[64:67]
    v_mfma_f32_16x16x32_bf16 v[68:71], v[196:199], v[228:231], v[68:71]
    v_mfma_f32_16x16x32_bf16 v[72:75], v[200:203], v[228:231], v[72:75]
    v_mfma_f32_16x16x32_bf16 v[76:79], v[204:207], v[228:231], v[76:79]
    v_mfma_f32_16x16x32_bf16 v[80:83], v[208:211], v[228:231], v[80:83]
    v_mfma_f32_16x16x32_bf16 v[84:87], v[212:215], v[228:231], v[84:87]
    s_setprio 0
    v_lshlrev_b32 v2, 4, v1
    s_and_b32 s42, s38, 3
    s_lshl_b32 s49, s36, 2
    s_add_u32 s49, s49, s42
    s_mul_i32 s49, s49, 20
    s_add_u32 s49, s49, 10
    s_lshl_b32 s49, s49, 10
    s_add_u32 s49, s49, 9240576
    s_nop 7
    s_add_u32 s39, s42, 1
    s_and_b32 s39, s39, 3
    s_mul_i32 s40, s39, 15360
    s_add_u32 s40, s40, 112640
    v_add_u32 v90, s40, v2
    s_cmp_eq_u32 s39, 0
    s_cbranch_scc0 L_wn_97
    ds_write_b128 v90, v[8:11] offset:0
    ds_write_b128 v90, v[12:15] offset:1024
    ds_write_b128 v90, v[16:19] offset:2048
    ds_write_b128 v90, v[20:23] offset:3072
    ds_write_b128 v90, v[24:27] offset:4096
    s_branch L_wdone_96
L_wn_97:
    s_cmp_eq_u32 s39, 1
    s_cbranch_scc0 L_wn_98
    ds_write_b128 v90, v[28:31] offset:0
    ds_write_b128 v90, v[32:35] offset:1024
    ds_write_b128 v90, v[36:39] offset:2048
    ds_write_b128 v90, v[40:43] offset:3072
    ds_write_b128 v90, v[44:47] offset:4096
    s_branch L_wdone_96
L_wn_98:
    s_cmp_eq_u32 s39, 2
    s_cbranch_scc0 L_wn_99
    ds_write_b128 v90, v[48:51] offset:0
    ds_write_b128 v90, v[52:55] offset:1024
    ds_write_b128 v90, v[56:59] offset:2048
    ds_write_b128 v90, v[60:63] offset:3072
    ds_write_b128 v90, v[64:67] offset:4096
    s_branch L_wdone_96
L_wn_99:
    s_cmp_eq_u32 s39, 3
    s_cbranch_scc0 L_wn_100
    ds_write_b128 v90, v[68:71] offset:0
    ds_write_b128 v90, v[72:75] offset:1024
    ds_write_b128 v90, v[76:79] offset:2048
    ds_write_b128 v90, v[80:83] offset:3072
    ds_write_b128 v90, v[84:87] offset:4096
    s_branch L_wdone_96
L_wn_100:
L_wdone_96:
    s_add_u32 s39, s42, 2
    s_and_b32 s39, s39, 3
    s_mul_i32 s40, s39, 15360
    s_add_u32 s40, s40, 107520
    v_add_u32 v90, s40, v2
    s_cmp_eq_u32 s39, 0
    s_cbranch_scc0 L_wn_102
    ds_write_b128 v90, v[8:11] offset:0
    ds_write_b128 v90, v[12:15] offset:1024
    ds_write_b128 v90, v[16:19] offset:2048
    ds_write_b128 v90, v[20:23] offset:3072
    ds_write_b128 v90, v[24:27] offset:4096
    s_branch L_wdone_101
L_wn_102:
    s_cmp_eq_u32 s39, 1
    s_cbranch_scc0 L_wn_103
    ds_write_b128 v90, v[28:31] offset:0
    ds_write_b128 v90, v[32:35] offset:1024
    ds_write_b128 v90, v[36:39] offset:2048
    ds_write_b128 v90, v[40:43] offset:3072
    ds_write_b128 v90, v[44:47] offset:4096
    s_branch L_wdone_101
L_wn_103:
    s_cmp_eq_u32 s39, 2
    s_cbranch_scc0 L_wn_104
    ds_write_b128 v90, v[48:51] offset:0
    ds_write_b128 v90, v[52:55] offset:1024
    ds_write_b128 v90, v[56:59] offset:2048
    ds_write_b128 v90, v[60:63] offset:3072
    ds_write_b128 v90, v[64:67] offset:4096
    s_branch L_wdone_101
L_wn_104:
    s_cmp_eq_u32 s39, 3
    s_cbranch_scc0 L_wn_105
    ds_write_b128 v90, v[68:71] offset:0
    ds_write_b128 v90, v[72:75] offset:1024
    ds_write_b128 v90, v[76:79] offset:2048
    ds_write_b128 v90, v[80:83] offset:3072
    ds_write_b128 v90, v[84:87] offset:4096
    s_branch L_wdone_101
L_wn_105:
L_wdone_101:
    s_add_u32 s39, s42, 3
    s_and_b32 s39, s39, 3
    s_mul_i32 s40, s39, 15360
    s_add_u32 s40, s40, 102400
    v_add_u32 v90, s40, v2
    s_cmp_eq_u32 s39, 0
    s_cbranch_scc0 L_wn_107
    ds_write_b128 v90, v[8:11] offset:0
    ds_write_b128 v90, v[12:15] offset:1024
    ds_write_b128 v90, v[16:19] offset:2048
    ds_write_b128 v90, v[20:23] offset:3072
    ds_write_b128 v90, v[24:27] offset:4096
    s_branch L_wdone_106
L_wn_107:
    s_cmp_eq_u32 s39, 1
    s_cbranch_scc0 L_wn_108
    ds_write_b128 v90, v[28:31] offset:0
    ds_write_b128 v90, v[32:35] offset:1024
    ds_write_b128 v90, v[36:39] offset:2048
    ds_write_b128 v90, v[40:43] offset:3072
    ds_write_b128 v90, v[44:47] offset:4096
    s_branch L_wdone_106
L_wn_108:
    s_cmp_eq_u32 s39, 2
    s_cbranch_scc0 L_wn_109
    ds_write_b128 v90, v[48:51] offset:0
    ds_write_b128 v90, v[52:55] offset:1024
    ds_write_b128 v90, v[56:59] offset:2048
    ds_write_b128 v90, v[60:63] offset:3072
    ds_write_b128 v90, v[64:67] offset:4096
    s_branch L_wdone_106
L_wn_109:
    s_cmp_eq_u32 s39, 3
    s_cbranch_scc0 L_wn_110
    ds_write_b128 v90, v[68:71] offset:0
    ds_write_b128 v90, v[72:75] offset:1024
    ds_write_b128 v90, v[76:79] offset:2048
    ds_write_b128 v90, v[80:83] offset:3072
    ds_write_b128 v90, v[84:87] offset:4096
    s_branch L_wdone_106
L_wn_110:
L_wdone_106:
    s_cmp_eq_u32 s42, 0
    s_cbranch_scc0 L_mn_112
    v_mov_b32 v112, v8
    v_mov_b32 v113, v9
    v_mov_b32 v114, v10
    v_mov_b32 v115, v11
    v_mov_b32 v116, v12
    v_mov_b32 v117, v13
    v_mov_b32 v118, v14
    v_mov_b32 v119, v15
    v_mov_b32 v120, v16
    v_mov_b32 v121, v17
    v_mov_b32 v122, v18
    v_mov_b32 v123, v19
    v_mov_b32 v124, v20
    v_mov_b32 v125, v21
    v_mov_b32 v126, v22
    v_mov_b32 v127, v23
    v_mov_b32 v128, v24
    v_mov_b32 v129, v25
    v_mov_b32 v130, v26
    v_mov_b32 v131, v27
    s_branch L_mdone_111
L_mn_112:
    s_cmp_eq_u32 s42, 1
    s_cbranch_scc0 L_mn_113
    v_mov_b32 v112, v28
    v_mov_b32 v113, v29
    v_mov_b32 v114, v30
    v_mov_b32 v115, v31
    v_mov_b32 v116, v32
    v_mov_b32 v117, v33
    v_mov_b32 v118, v34
    v_mov_b32 v119, v35
    v_mov_b32 v120, v36
    v_mov_b32 v121, v37
    v_mov_b32 v122, v38
    v_mov_b32 v123, v39
    v_mov_b32 v124, v40
    v_mov_b32 v125, v41
    v_mov_b32 v126, v42
    v_mov_b32 v127, v43
    v_mov_b32 v128, v44
    v_mov_b32 v129, v45
    v_mov_b32 v130, v46
    v_mov_b32 v131, v47
    s_branch L_mdone_111
L_mn_113:
    s_cmp_eq_u32 s42, 2
    s_cbranch_scc0 L_mn_114
    v_mov_b32 v112, v48
    v_mov_b32 v113, v49
    v_mov_b32 v114, v50
    v_mov_b32 v115, v51
    v_mov_b32 v116, v52
    v_mov_b32 v117, v53
    v_mov_b32 v118, v54
    v_mov_b32 v119, v55
    v_mov_b32 v120, v56
    v_mov_b32 v121, v57
    v_mov_b32 v122, v58
    v_mov_b32 v123, v59
    v_mov_b32 v124, v60
    v_mov_b32 v125, v61
    v_mov_b32 v126, v62
    v_mov_b32 v127, v63
    v_mov_b32 v128, v64
    v_mov_b32 v129, v65
    v_mov_b32 v130, v66
    v_mov_b32 v131, v67
    s_branch L_mdone_111
L_mn_114:
    s_cmp_eq_u32 s42, 3
    s_cbranch_scc0 L_mn_115
    v_mov_b32 v112, v68
    v_mov_b32 v113, v69
    v_mov_b32 v114, v70
    v_mov_b32 v115, v71
    v_mov_b32 v116, v72
    v_mov_b32 v117, v73
    v_mov_b32 v118, v74
    v_mov_b32 v119, v75
    v_mov_b32 v120, v76
    v_mov_b32 v121, v77
    v_mov_b32 v122, v78
    v_mov_b32 v123, v79
    v_mov_b32 v124, v80
    v_mov_b32 v125, v81
    v_mov_b32 v126, v82
    v_mov_b32 v127, v83
    v_mov_b32 v128, v84
    v_mov_b32 v129, v85
    v_mov_b32 v130, v86
    v_mov_b32 v131, v87
    s_branch L_mdone_111
L_mn_115:
L_mdone_111:
    s_waitcnt lgkmcnt(0)
    s_barrier
    s_mul_i32 s40, s42, 15360
    s_add_u32 s40, s40, 102400
    v_add_u32 v90, s40, v2
    ds_read_b128 v[172:175], v90 offset:0
    ds_read_b128 v[176:179], v90 offset:1024
    ds_read_b128 v[180:183], v90 offset:2048
    ds_read_b128 v[184:187], v90 offset:3072
    ds_read_b128 v[188:191], v90 offset:4096
    ds_read_b128 v[192:195], v90 offset:5120
    ds_read_b128 v[196:199], v90 offset:6144
    ds_read_b128 v[200:203], v90 offset:7168
    ds_read_b128 v[204:207], v90 offset:8192
    ds_read_b128 v[208:211], v90 offset:9216
    ds_read_b128 v[212:215], v90 offset:10240
    ds_read_b128 v[216:219], v90 offset:11264
    ds_read_b128 v[220:223], v90 offset:12288
    ds_read_b128 v[224:227], v90 offset:13312
    ds_read_b128 v[228:231], v90 offset:14336
    s_waitcnt vmcnt(0) lgkmcnt(0)
    v_add_f32 v112, v112, v172
    v_add_f32 v192, v192, v212
    v_add_f32 v113, v113, v173
    v_add_f32 v193, v193, v213
    v_add_f32 v114, v114, v174
    v_add_f32 v194, v194, v214
    v_add_f32 v115, v115, v175
    v_add_f32 v195, v195, v215
    v_add_f32 v116, v116, v176
    v_add_f32 v196, v196, v216
    v_add_f32 v117, v117, v177
    v_add_f32 v197, v197, v217
    v_add_f32 v118, v118, v178
    v_add_f32 v198, v198, v218
    v_add_f32 v119, v119, v179
    v_add_f32 v199, v199, v219
    v_add_f32 v120, v120, v180
    v_add_f32 v200, v200, v220
    v_add_f32 v121, v121, v181
    v_add_f32 v201, v201, v221
    v_add_f32 v122, v122, v182
    v_add_f32 v202, v202, v222
    v_add_f32 v123, v123, v183
    v_add_f32 v203, v203, v223
    v_add_f32 v124, v124, v184
    v_add_f32 v204, v204, v224
    v_add_f32 v125, v125, v185
    v_add_f32 v205, v205, v225
    v_add_f32 v126, v126, v186
    v_add_f32 v206, v206, v226
    v_add_f32 v127, v127, v187
    v_add_f32 v207, v207, v227
    v_add_f32 v128, v128, v188
    v_add_f32 v208, v208, v228
    v_add_f32 v129, v129, v189
    v_add_f32 v209, v209, v229
    v_add_f32 v130, v130, v190
    v_add_f32 v210, v210, v230
    v_add_f32 v131, v131, v191
    v_add_f32 v211, v211, v231
    v_add_f32 v112, v112, v192
    v_add_f32 v113, v113, v193
    v_add_f32 v114, v114, v194
    v_add_f32 v115, v115, v195
    v_add_f32 v116, v116, v196
    v_add_f32 v117, v117, v197
    v_add_f32 v118, v118, v198
    v_add_f32 v119, v119, v199
    v_add_f32 v120, v120, v200
    v_add_f32 v121, v121, v201
    v_add_f32 v122, v122, v202
    v_add_f32 v123, v123, v203
    v_add_f32 v124, v124, v204
    v_add_f32 v125, v125, v205
    v_add_f32 v126, v126, v206
    v_add_f32 v127, v127, v207
    v_add_f32 v128, v128, v208
    v_add_f32 v129, v129, v209
    v_add_f32 v130, v130, v210
    v_add_f32 v131, v131, v211
    v_lshlrev_b32 v8, 16, v232
    v_and_b32 v9, 0xffff0000, v232
    v_lshlrev_b32 v10, 16, v242
    v_and_b32 v11, 0xffff0000, v242
    v_add_f32 v112, v112, v8
    v_add_f32 v113, v113, v9
    v_add_f32 v112, v112, v10
    v_add_f32 v113, v113, v11
    v_lshlrev_b32 v8, 16, v233
    v_and_b32 v9, 0xffff0000, v233
    v_lshlrev_b32 v10, 16, v243
    v_and_b32 v11, 0xffff0000, v243
    v_add_f32 v114, v114, v8
    v_add_f32 v115, v115, v9
    v_add_f32 v114, v114, v10
    v_add_f32 v115, v115, v11
    v_lshlrev_b32 v8, 16, v234
    v_and_b32 v9, 0xffff0000, v234
    v_lshlrev_b32 v10, 16, v244
    v_and_b32 v11, 0xffff0000, v244
    v_add_f32 v116, v116, v8
    v_add_f32 v117, v117, v9
    v_add_f32 v116, v116, v10
    v_add_f32 v117, v117, v11
    v_lshlrev_b32 v8, 16, v235
    v_and_b32 v9, 0xffff0000, v235
    v_lshlrev_b32 v10, 16, v245
    v_and_b32 v11, 0xffff0000, v245
    v_add_f32 v118, v118, v8
    v_add_f32 v119, v119, v9
    v_add_f32 v118, v118, v10
    v_add_f32 v119, v119, v11
    v_lshlrev_b32 v8, 16, v236
    v_and_b32 v9, 0xffff0000, v236
    v_lshlrev_b32 v10, 16, v246
    v_and_b32 v11, 0xffff0000, v246
    v_add_f32 v120, v120, v8
    v_add_f32 v121, v121, v9
    v_add_f32 v120, v120, v10
    v_add_f32 v121, v121, v11
    v_lshlrev_b32 v8, 16, v237
    v_and_b32 v9, 0xffff0000, v237
    v_lshlrev_b32 v10, 16, v247
    v_and_b32 v11, 0xffff0000, v247
    v_add_f32 v122, v122, v8
    v_add_f32 v123, v123, v9
    v_add_f32 v122, v122, v10
    v_add_f32 v123, v123, v11
    v_lshlrev_b32 v8, 16, v238
    v_and_b32 v9, 0xffff0000, v238
    v_lshlrev_b32 v10, 16, v248
    v_and_b32 v11, 0xffff0000, v248
    v_add_f32 v124, v124, v8
    v_add_f32 v125, v125, v9
    v_add_f32 v124, v124, v10
    v_add_f32 v125, v125, v11
    v_lshlrev_b32 v8, 16, v239
    v_and_b32 v9, 0xffff0000, v239
    v_lshlrev_b32 v10, 16, v249
    v_and_b32 v11, 0xffff0000, v249
    v_add_f32 v126, v126, v8
    v_add_f32 v127, v127, v9
    v_add_f32 v126, v126, v10
    v_add_f32 v127, v127, v11
    v_lshlrev_b32 v8, 16, v240
    v_and_b32 v9, 0xffff0000, v240
    v_lshlrev_b32 v10, 16, v6
    v_and_b32 v11, 0xffff0000, v6
    v_add_f32 v128, v128, v8
    v_add_f32 v129, v129, v9
    v_add_f32 v128, v128, v10
    v_add_f32 v129, v129, v11
    v_lshlrev_b32 v8, 16, v241
    v_and_b32 v9, 0xffff0000, v241
    v_lshlrev_b32 v10, 16, v7
    v_and_b32 v11, 0xffff0000, v7
    v_add_f32 v130, v130, v8
    v_add_f32 v131, v131, v9
    v_add_f32 v130, v130, v10
    v_add_f32 v131, v131, v11
    v_add_u32 v12, 51200, v2
    s_barrier
    s_setprio 0
    s_mov_b32 s41, s49
    buffer_load_dwordx4 v[132:135], v2, s[24:27], s41 offen offset:0 sc1
    buffer_load_dwordx4 v[136:139], v2, s[24:27], s41 offen offset:1024 sc1
    buffer_load_dwordx4 v[140:143], v2, s[24:27], s41 offen offset:2048 sc1
    buffer_load_dwordx4 v[144:147], v2, s[24:27], s41 offen offset:3072 sc1
    s_add_u32 s41, s41, 4096
    buffer_load_dwordx4 v[148:151], v2, s[24:27], s41 offen offset:0 sc1
    buffer_load_dwordx4 v[152:155], v2, s[24:27], s41 offen offset:1024 sc1
    buffer_load_dwordx4 v[156:159], v2, s[24:27], s41 offen offset:2048 sc1
    buffer_load_dwordx4 v[160:163], v2, s[24:27], s41 offen offset:3072 sc1
    s_add_u32 s41, s41, 4096
    buffer_load_dwordx4 v[164:167], v2, s[24:27], s41 offen offset:0 sc1
    buffer_load_dwordx4 v[168:171], v2, s[24:27], s41 offen offset:1024 sc1
    ds_read_b128 v[172:175], v12 offset:0
    ds_read_b128 v[176:179], v12 offset:1024
    ds_read_b128 v[180:183], v12 offset:2048
    ds_read_b128 v[184:187], v12 offset:3072
    ds_read_b128 v[188:191], v12 offset:4096
    ds_read_b128 v[192:195], v12 offset:5120
    ds_read_b128 v[196:199], v12 offset:6144
    ds_read_b128 v[200:203], v12 offset:7168
    ds_read_b128 v[204:207], v12 offset:8192
    ds_read_b128 v[208:211], v12 offset:9216
    s_waitcnt vmcnt(9) lgkmcnt(5)
    v_mfma_f32_16x16x32_bf16 v[112:115], v[172:175], v[132:135], v[112:115]
    v_mfma_f32_16x16x32_bf16 v[116:119], v[176:179], v[132:135], v[116:119]
    v_mfma_f32_16x16x32_bf16 v[120:123], v[180:183], v[132:135], v[120:123]
    v_mfma_f32_16x16x32_bf16 v[124:127], v[184:187], v[132:135], v[124:127]
    v_mfma_f32_16x16x32_bf16 v[128:131], v[188:191], v[132:135], v[128:131]
    ds_read_b128 v[172:175], v12 offset:10240
    ds_read_b128 v[176:179], v12 offset:11264
    ds_read_b128 v[180:183], v12 offset:12288
    ds_read_b128 v[184:187], v12 offset:13312
    ds_read_b128 v[188:191], v12 offset:14336
    s_waitcnt vmcnt(8) lgkmcnt(5)
    v_mfma_f32_16x16x32_bf16 v[112:115], v[192:195], v[136:139], v[112:115]
    v_mfma_f32_16x16x32_bf16 v[116:119], v[196:199], v[136:139], v[116:119]
    v_mfma_f32_16x16x32_bf16 v[120:123], v[200:203], v[136:139], v[120:123]
    v_mfma_f32_16x16x32_bf16 v[124:127], v[204:207], v[136:139], v[124:127]
    v_mfma_f32_16x16x32_bf16 v[128:131], v[208:211], v[136:139], v[128:131]
    ds_read_b128 v[192:195], v12 offset:15360
    ds_read_b128 v[196:199], v12 offset:16384
    ds_read_b128 v[200:203], v12 offset:17408
    ds_read_b128 v[204:207], v12 offset:18432
    ds_read_b128 v[208:211], v12 offset:19456
    s_waitcnt vmcnt(7) lgkmcnt(5)
    v_mfma_f32_16x16x32_bf16 v[112:115], v[172:175], v[140:143], v[112:115]
    v_mfma_f32_16x16x32_bf16 v[116:119], v[176:179], v[140:143], v[116:119]
    v_mfma_f32_16x16x32_bf16 v[120:123], v[180:183], v[140:143], v[120:123]
    v_mfma_f32_16x16x32_bf16 v[124:127], v[184:187], v[140:143], v[124:127]
    v_mfma_f32_16x16x32_bf16 v[128:131], v[188:191], v[140:143], v[128:131]
    ds_read_b128 v[172:175], v12 offset:20480
    ds_read_b128 v[176:179], v12 offset:21504
    ds_read_b128 v[180:183], v12 offset:22528
    ds_read_b128 v[184:187], v12 offset:23552
    ds_read_b128 v[188:191], v12 offset:24576
    s_waitcnt vmcnt(6) lgkmcnt(5)
    v_mfma_f32_16x16x32_bf16 v[112:115], v[192:195], v[144:147], v[112:115]
    v_mfma_f32_16x16x32_bf16 v[116:119], v[196:199], v[144:147], v[116:119]
    v_mfma_f32_16x16x32_bf16 v[120:123], v[200:203], v[144:147], v[120:123]
    v_mfma_f32_16x16x32_bf16 v[124:127], v[204:207], v[144:147], v[124:127]
    v_mfma_f32_16x16x32_bf16 v[128:131], v[208:211], v[144:147], v[128:131]
    ds_read_b128 v[192:195], v12 offset:25600
    ds_read_b128 v[196:199], v12 offset:26624
    ds_read_b128 v[200:203], v12 offset:27648
    ds_read_b128 v[204:207], v12 offset:28672
    ds_read_b128 v[208:211], v12 offset:29696
    s_waitcnt vmcnt(5) lgkmcnt(5)
    v_mfma_f32_16x16x32_bf16 v[112:115], v[172:175], v[148:151], v[112:115]
    v_mfma_f32_16x16x32_bf16 v[116:119], v[176:179], v[148:151], v[116:119]
    v_mfma_f32_16x16x32_bf16 v[120:123], v[180:183], v[148:151], v[120:123]
    v_mfma_f32_16x16x32_bf16 v[124:127], v[184:187], v[148:151], v[124:127]
    v_mfma_f32_16x16x32_bf16 v[128:131], v[188:191], v[148:151], v[128:131]
    ds_read_b128 v[172:175], v12 offset:30720
    ds_read_b128 v[176:179], v12 offset:31744
    ds_read_b128 v[180:183], v12 offset:32768
    ds_read_b128 v[184:187], v12 offset:33792
    ds_read_b128 v[188:191], v12 offset:34816
    s_waitcnt vmcnt(4) lgkmcnt(5)
    v_mfma_f32_16x16x32_bf16 v[112:115], v[192:195], v[152:155], v[112:115]
    v_mfma_f32_16x16x32_bf16 v[116:119], v[196:199], v[152:155], v[116:119]
    v_mfma_f32_16x16x32_bf16 v[120:123], v[200:203], v[152:155], v[120:123]
    v_mfma_f32_16x16x32_bf16 v[124:127], v[204:207], v[152:155], v[124:127]
    v_mfma_f32_16x16x32_bf16 v[128:131], v[208:211], v[152:155], v[128:131]
    ds_read_b128 v[192:195], v12 offset:35840
    ds_read_b128 v[196:199], v12 offset:36864
    ds_read_b128 v[200:203], v12 offset:37888
    ds_read_b128 v[204:207], v12 offset:38912
    ds_read_b128 v[208:211], v12 offset:39936
    s_waitcnt vmcnt(3) lgkmcnt(5)
    v_mfma_f32_16x16x32_bf16 v[112:115], v[172:175], v[156:159], v[112:115]
    v_mfma_f32_16x16x32_bf16 v[116:119], v[176:179], v[156:159], v[116:119]
    v_mfma_f32_16x16x32_bf16 v[120:123], v[180:183], v[156:159], v[120:123]
    v_mfma_f32_16x16x32_bf16 v[124:127], v[184:187], v[156:159], v[124:127]
    v_mfma_f32_16x16x32_bf16 v[128:131], v[188:191], v[156:159], v[128:131]
    ds_read_b128 v[172:175], v12 offset:40960
    ds_read_b128 v[176:179], v12 offset:41984
    ds_read_b128 v[180:183], v12 offset:43008
    ds_read_b128 v[184:187], v12 offset:44032
    ds_read_b128 v[188:191], v12 offset:45056
    s_waitcnt vmcnt(2) lgkmcnt(5)
    v_mfma_f32_16x16x32_bf16 v[112:115], v[192:195], v[160:163], v[112:115]
    v_mfma_f32_16x16x32_bf16 v[116:119], v[196:199], v[160:163], v[116:119]
    v_mfma_f32_16x16x32_bf16 v[120:123], v[200:203], v[160:163], v[120:123]
    v_mfma_f32_16x16x32_bf16 v[124:127], v[204:207], v[160:163], v[124:127]
    v_mfma_f32_16x16x32_bf16 v[128:131], v[208:211], v[160:163], v[128:131]
    ds_read_b128 v[192:195], v12 offset:46080
    ds_read_b128 v[196:199], v12 offset:47104
    ds_read_b128 v[200:203], v12 offset:48128
    ds_read_b128 v[204:207], v12 offset:49152
    ds_read_b128 v[208:211], v12 offset:50176
    s_waitcnt vmcnt(1) lgkmcnt(5)
    v_mfma_f32_16x16x32_bf16 v[112:115], v[172:175], v[164:167], v[112:115]
    v_mfma_f32_16x16x32_bf16 v[116:119], v[176:179], v[164:167], v[116:119]
    v_mfma_f32_16x16x32_bf16 v[120:123], v[180:183], v[164:167], v[120:123]
    v_mfma_f32_16x16x32_bf16 v[124:127], v[184:187], v[164:167], v[124:127]
    v_mfma_f32_16x16x32_bf16 v[128:131], v[188:191], v[164:167], v[128:131]
    s_waitcnt vmcnt(0) lgkmcnt(0)
    v_mfma_f32_16x16x32_bf16 v[112:115], v[192:195], v[168:171], v[112:115]
    v_mfma_f32_16x16x32_bf16 v[116:119], v[196:199], v[168:171], v[116:119]
    v_mfma_f32_16x16x32_bf16 v[120:123], v[200:203], v[168:171], v[120:123]
    v_mfma_f32_16x16x32_bf16 v[124:127], v[204:207], v[168:171], v[124:127]
    v_mfma_f32_16x16x32_bf16 v[128:131], v[208:211], v[168:171], v[128:131]
    s_mul_i32 s40, s42, 5120
    s_add_u32 s40, s40, 102400
    v_add_u32 v90, s40, v2
    s_nop 7
    s_barrier
    ds_read_b128 v[172:175], v90 offset:0
    ds_read_b128 v[176:179], v90 offset:1024
    ds_read_b128 v[180:183], v90 offset:2048
    ds_read_b128 v[184:187], v90 offset:3072
    ds_read_b128 v[188:191], v90 offset:4096
    s_waitcnt lgkmcnt(0)
    v_add_f32 v112, v112, v172
    v_add_f32 v113, v113, v173
    v_add_f32 v114, v114, v174
    v_add_f32 v115, v115, v175
    v_add_f32 v116, v116, v176
    v_add_f32 v117, v117, v177
    v_add_f32 v118, v118, v178
    v_add_f32 v119, v119, v179
    v_add_f32 v120, v120, v180
    v_add_f32 v121, v121, v181
    v_add_f32 v122, v122, v182
    v_add_f32 v123, v123, v183
    v_add_f32 v124, v124, v184
    v_add_f32 v125, v125, v185
    v_add_f32 v126, v126, v186
    v_add_f32 v127, v127, v187
    v_add_f32 v128, v128, v188
    v_add_f32 v129, v129, v189
    v_add_f32 v130, v130, v190
    v_add_f32 v131, v131, v191
    v_cvt_pk_bf16_f32 v192, v112, v113
    v_cvt_pk_bf16_f32 v193, v114, v115
    buffer_store_dwordx2 v[192:193], v5, s[16:19], s52 offen offset:0
    v_cvt_pk_bf16_f32 v194, v116, v117
    v_cvt_pk_bf16_f32 v195, v118, v119
    buffer_store_dwordx2 v[194:195], v5, s[16:19], s52 offen offset:32
    v_cvt_pk_bf16_f32 v196, v120, v121
    v_cvt_pk_bf16_f32 v197, v122, v123
    buffer_store_dwordx2 v[196:197], v5, s[16:19], s52 offen offset:64
    v_cvt_pk_bf16_f32 v198, v124, v125
    v_cvt_pk_bf16_f32 v199, v126, v127
    buffer_store_dwordx2 v[198:199], v5, s[16:19], s52 offen offset:96
    v_cvt_pk_bf16_f32 v200, v128, v129
    v_cvt_pk_bf16_f32 v201, v130, v131
    buffer_store_dwordx2 v[200:201], v5, s[16:19], s52 offen offset:128
    s_endpgm
L_parallel_sum__grouped_kv_mqa__dense_activation_squared_relu__prompt_kernel_end:
    s_endpgm

.section .rodata,"a"
.p2align 6
.amdhsa_kernel parallel_sum__grouped_kv_mqa__dense_activation_squared_relu__prompt_kernel
  .amdhsa_next_free_vgpr 256
  .amdhsa_next_free_sgpr 102
  .amdhsa_accum_offset 256
  .amdhsa_group_segment_fixed_size 0
  .amdhsa_kernarg_size 104
  .amdhsa_user_sgpr_count 2
  .amdhsa_user_sgpr_kernarg_segment_ptr 1
  .amdhsa_system_sgpr_workgroup_id_x 1
.end_amdhsa_kernel
```
